```python
import torch

def _softmax(x, axis=-1):
    return torch.softmax(x, dim=axis)
def _gelu(x):
    return torch.nn.functional.gelu(x, approximate="tanh")
def _silu(x):
    return torch.nn.functional.silu(x)
def _sigmoid(x):
    return torch.sigmoid(x)
def _layernorm(x, axis=-1, eps=1e-5):
    m = x.mean(dim=axis, keepdim=True)
    v = x.var(dim=axis, keepdim=True, unbiased=False)
    return (x - m) / torch.sqrt(v + eps)
def _scatter_add(tgt, idx, src, axis=0):
    return tgt.clone().index_add_(axis, idx, src)
def _segment_sum(src, seg, n):
    out = torch.zeros((n,) + src.shape[1:], dtype=src.dtype)
    return out.index_add_(0, seg, src)
def _pad(x, pw):
    flat = tuple(v for pair in reversed(pw) for v in pair)
    return torch.nn.functional.pad(x, flat)

kernel_name = 'interleave_layers__linear_kernel_hedgehog__glu_gated_geglu__prompt'

def setup_inputs():

    _w = (lambda a: (lambda t: t.to(torch.bfloat16) if t.is_floating_point() else t)(torch.as_tensor(a)))
    def _A_setup():
        B, S, D, H = 1, 2048, 512, 32
        Dh = D // H
        return {
            "x": _w((lambda *s: torch.randn(*s, dtype=torch.bfloat16) * 0.05)(B, S, D)),
            "wqkv": _w((lambda *s: torch.randn(*s, dtype=torch.bfloat16) * 0.4)(D, 3 * D)),
            "w_phi": _w((lambda *s: torch.randn(*s, dtype=torch.bfloat16) * 0.4)(H, Dh, Dh) * (Dh ** -0.5)),
            "wo": _w((lambda *s: torch.randn(*s, dtype=torch.bfloat16) * 0.05)(D, D)),
        }
    _A_in = _A_setup()

    def _B_setup():
        B, S, Dm, Df = 1, 2048, 512, 1792
        return {
            "x": _w((lambda *s: torch.randn(*s, dtype=torch.bfloat16) * 0.05)(B, S, Dm)),
            "w_gate": _w((lambda *s: torch.randn(*s, dtype=torch.bfloat16) * 1.6)(Dm, Df) * (Dm ** -0.5)),
            "w_up": _w((lambda *s: torch.randn(*s, dtype=torch.bfloat16) * 1.6)(Dm, Df) * (Dm ** -0.5)),
            "w_down": _w((lambda *s: torch.randn(*s, dtype=torch.bfloat16) * 1.6)(Df, Dm) * (Df ** -0.5)),
        }
    _B_in = _B_setup()

    return {
        "A_x": _A_in["x"],
        "A_wqkv": _A_in["wqkv"],
        "A_w_phi": _A_in["w_phi"],
        "A_wo": _A_in["wo"],
        "B_x": _B_in["x"],
        "B_w_gate": _B_in["w_gate"],
        "B_w_up": _B_in["w_up"],
        "B_w_down": _B_in["w_down"],
    }

def reference(A_x, A_wqkv, A_w_phi, A_wo, B_x, B_w_gate, B_w_up, B_w_down):
    def _A_ref(x, wqkv, w_phi, wo):
        B, S, D = x.shape
        H = 32; Dh = D // H
        qkv = (lambda x, *d: x.permute(*d))((x @ wqkv).reshape(B, S, 3, H, Dh), 2, 0, 3, 1, 4)
        q, k, v = qkv[0], qkv[1], qkv[2]
        pq = torch.einsum("bhsd,hdf->bhsf", q, w_phi)
        pk = torch.einsum("bhsd,hdf->bhsf", k, w_phi)
        phi_q = torch.concatenate([_softmax(pq, axis=-1), _softmax(-pq, axis=-1)], axis=-1)
        phi_k = torch.concatenate([_softmax(pk, axis=-1), _softmax(-pk, axis=-1)], axis=-1)
        kv = torch.einsum("bhsf,bhsd->bhfd", phi_k, v)
        z  = torch.einsum("bhsf->bhf", phi_k)
        num = torch.einsum("bhqf,bhfd->bhqd", phi_q, kv)
        den = torch.einsum("bhqf,bhf->bhq", phi_q, z)[..., None] + 1e-6
        o = num / den
        return (lambda x, *d: x.permute(*d))(o, 0, 2, 1, 3).reshape(B, S, D) @ wo

    def _B_ref(x, w_gate, w_up, w_down):
        g = torch.einsum("bsd,df->bsf", x, w_gate)
        u = torch.einsum("bsd,df->bsf", x, w_up)
        h = _gelu(g) * u
        return torch.einsum("bsf,fd->bsd", h, w_down)

    x = A_x
    x = x + _A_ref(_layernorm(x, axis=-1), A_wqkv, A_w_phi, A_wo)
    x = x + _B_ref(_layernorm(x, axis=-1), B_w_gate, B_w_up, B_w_down)
    x = x + _A_ref(_layernorm(x, axis=-1), A_wqkv, A_w_phi, A_wo)
    x = x + _B_ref(_layernorm(x, axis=-1), B_w_gate, B_w_up, B_w_down)
    return x
```

```asm
; @launch grid=(256,1,1) block=(256,1,1) lds=163840
.amdgcn_target "amdgcn-amd-amdhsa--gfx950"
.text
.globl interleave_layers__linear_kernel_hedgehog__glu_gated_geglu__prompt_kernel
.p2align 8
.type interleave_layers__linear_kernel_hedgehog__glu_gated_geglu__prompt_kernel,@function
interleave_layers__linear_kernel_hedgehog__glu_gated_geglu__prompt_kernel:
    s_cmpk_lt_u32 s2, 0x100
    s_cbranch_scc0 L_abort
    s_load_dwordx2 s[28:29], s[0:1], 40
    s_load_dwordx2 s[4:5], s[0:1], 80
    s_getpc_b64 s[46:47]
L_pc_1:
    s_lshr_b32 s57, s2, 3
    s_lshl_b32 s57, s57, 11
    v_lshrrev_b32 v29, 4, v0
    v_lshl_add_u32 v29, v29, 7, s57
    v_min_u32 v29, L_code_end-L_pc_1-4, v29
    global_load_dword v21, v29, s[46:47]
    s_load_dwordx2 s[32:33], s[0:1], 48
    s_load_dwordx2 s[12:13], s[0:1], 0
    s_load_dwordx2 s[16:17], s[0:1], 8
    s_load_dwordx2 s[20:21], s[0:1], 16
    s_load_dwordx2 s[24:25], s[0:1], 24
    s_load_dwordx2 s[36:37], s[0:1], 56
    s_load_dwordx2 s[40:41], s[0:1], 64
    v_lshrrev_b32 v176, 6, v0
    v_and_b32 v196, 63, v0
    v_readfirstlane_b32 s52, v176
    s_mov_b32 s14, 2097152
    s_mov_b32 s15, 0x20000
    s_mov_b32 s18, 1572864
    s_mov_b32 s19, 0x20000
    s_mov_b32 s30, 1835008
    s_mov_b32 s31, 0x20000
    s_mov_b32 s34, 1835008
    s_mov_b32 s35, 0x20000
    s_mov_b32 s22, 16384
    s_mov_b32 s23, 0x20000
    s_mov_b32 s26, 524288
    s_mov_b32 s27, 0x20000
    s_mov_b32 s38, 1835008
    s_mov_b32 s39, 0x20000
    s_mov_b32 s10, 16777216
    s_mov_b32 s11, 0x20000
    s_and_b32 s50, s2, 7
    s_lshl_b32 s50, s50, 1
    s_lshr_b32 s57, s2, 7
    s_add_u32 s50, s50, s57
    s_bfe_u32 s51, s2, 0x40003
    s_lshl_b32 s77, s2, 2
    s_add_u32 s77, s77, s52
    v_lshlrev_b32 v1, 4, v196
    v_lshlrev_b32 v20, 5, v196
    s_lshl_b32 s57, s50, 6
    s_lshl_b32 s58, s51, 2
    s_add_u32 s57, s57, s58
    s_add_u32 s57, s57, s52
    s_lshl_b32 s59, s57, 11
    s_lshr_b32 s57, s77, 1
    s_add_u32 s57, s57, s77
    s_add_u32 s57, s57, 1
    s_lshl_b32 s91, s57, 10
    v_lshrrev_b32 v178, 3, v196
    v_and_b32 v179, 7, v196
    v_mul_u32_u24 v186, 3584, v178
    v_lshl_add_u32 v186, v179, 4, v186
    v_add_u32 v187, 27648, v186
    s_and_b32 s57, s77, 31
    s_mul_i32 s57, s57, 57344
    s_lshr_b32 s58, s2, 3
    s_lshl_b32 s58, s58, 7
    s_cmp_ge_u32 s2, 224
    s_cselect_b32 s90, 1073741824, 0
    s_add_u32 s58, s58, s90
    s_add_u32 s60, s57, s58
    s_lshl_b32 s57, s52, 11
    s_add_u32 m0, s57, 65536
    s_waitcnt lgkmcnt(0)
    buffer_load_dwordx4 v186, s[28:31], s60 offen lds
    buffer_load_dwordx4 v187, s[28:31], s60 offen offset:1024 lds
    s_add_u32 m0, s57, 73728
    s_nop 0
    buffer_load_dwordx4 v186, s[32:35], s60 offen lds
    buffer_load_dwordx4 v187, s[32:35], s60 offen offset:1024 lds
    s_add_u32 s8, s4, 33554432
    s_addc_u32 s9, s5, 0
    s_load_dwordx2 s[44:45], s[8:9], 0
    s_lshl_b32 s57, s52, 12
    s_add_u32 m0, s57, 49152
    s_sub_u32 s72, 255, s2
    s_cmp_ge_u32 s72, 112
    s_cbranch_scc1 L_p2wo
    s_lshl_b32 s60, s72, 14
    s_add_u32 s60, s60, s57
    buffer_load_dwordx4 v1, s[36:39], s60 offen offset:0 lds
    buffer_load_dwordx4 v1, s[36:39], s60 offen offset:1024 lds
    buffer_load_dwordx4 v1, s[36:39], s60 offen offset:2048 lds
    buffer_load_dwordx4 v1, s[36:39], s60 offen offset:3072 lds
    s_mul_i32 s57, s72, 9363
    s_lshr_b32 s57, s57, 16
    s_mul_i32 s58, s57, 7
    s_sub_u32 s58, s72, s58
    s_lshl_b32 s61, s58, 14
    s_and_b32 s58, s57, 7
    s_lshl_b32 s58, s58, 11
    s_add_u32 s61, s61, s58
    s_lshr_b32 s57, s57, 3
    s_mul_i32 s58, s57, 918528
    s_add_u32 s61, s61, s58
    s_add_u32 s61, s61, 6291456
    s_mov_b32 s62, 114688
    s_lshl_b32 s57, s57, 11
    s_sub_u32 s63, 1024, s57
    s_branch L_p2ld
L_p2wo:
    s_cmp_ge_u32 s72, 144
    s_cbranch_scc1 L_p2q
    s_sub_u32 s58, s72, 112
    s_lshl_b32 s60, s58, 14
    s_add_u32 s60, s60, s57
    buffer_load_dwordx4 v1, s[24:27], s60 offen offset:0 lds
    buffer_load_dwordx4 v1, s[24:27], s60 offen offset:1024 lds
    buffer_load_dwordx4 v1, s[24:27], s60 offen offset:2048 lds
    buffer_load_dwordx4 v1, s[24:27], s60 offen offset:3072 lds
    s_and_b32 s61, s58, 15
    s_lshl_b32 s61, s61, 12
    s_lshr_b32 s58, s58, 4
    s_lshl_b32 s58, s58, 11
    s_add_u32 s61, s61, s58
    s_add_u32 s61, s61, 8388608
    s_mov_b32 s62, 65536
    s_mov_b32 s63, 1024
    s_branch L_p2ld
L_p2q:
    s_sub_u32 s58, s72, 144
    s_lshl_b32 s61, s58, 10
    s_add_u32 s61, s61, 8912896
    s_mov_b32 s62, 65536
    s_mov_b32 s63, 32768
    s_cmp_ge_u32 s72, 176
    s_cselect_b32 s61, 1073741824, s61
    s_lshl_b32 s58, s58, 2
    s_add_u32 s58, s58, s52
    s_mul_i32 s60, s58, 12288
    buffer_load_dwordx4 v1, s[16:19], s60 offen offset:0 lds
    s_add_u32 s60, s60, 2048
    buffer_load_dwordx4 v1, s[16:19], s60 offen offset:1024 lds
    s_add_u32 s60, s60, 2048
    buffer_load_dwordx4 v1, s[16:19], s60 offen offset:2048 lds
    s_add_u32 s60, s60, 2048
    buffer_load_dwordx4 v1, s[16:19], s60 offen offset:3072 lds
    s_add_u32 s60, s60, 2048
L_p2ld:
    s_lshl_b32 s57, s52, 1
    s_mul_i32 s57, s57, s62
    s_add_u32 s48, s61, s57
    s_add_u32 s49, s48, s62
    s_mov_b32 s78, s63
    s_lshl_b32 s57, s52, 10
    s_add_u32 m0, s57, 81920
    s_lshl_b32 s60, s51, 10
    buffer_load_dwordx4 v1, s[20:23], s60 offen lds
    buffer_load_dword v21, v20, s[12:15], s59 offen
    buffer_load_dword v21, v1, s[16:19], s91 offen
    v_lshrrev_b32 v197, 4, v196
    v_xor_b32 v180, v179, v197
    v_lshlrev_b32 v180, 4, v180
    v_lshl_add_u32 v188, v178, 10, v180
    v_xor_b32 v189, 64, v188
    v_add_u32 v189, 7168, v189
    v_add_u32 v190, 14336, v188
    v_add_u32 v191, 14336, v189
    v_and_b32 v199, 3, v196
    v_lshrrev_b32 v176, 2, v196
    v_mul_u32_u24 v176, 3072, v176
    v_lshl_add_u32 v209, v199, 4, v176
    s_lshl_b32 s75, s52, 14
    s_add_u32 s75, s75, 98304
    s_lshl_b32 s69, s52, 10
    s_lshl_b32 s89, s52, 11
    s_lshl_b32 s76, s50, 2
    s_add_u32 s76, s76, s52
    s_lshl_b32 s76, s76, 15
    s_mul_i32 s68, s52, 49152
    s_lshl_b32 s57, s51, 6
    s_add_u32 s68, s68, s57
    s_mov_b32 s6, 2097152
    s_mov_b32 s7, 0x20000
    s_mov_b32 s42, 2097152
    s_mov_b32 s43, 0x20000
    s_lshl_b32 s57, s50, 21
    s_add_u32 s4, s4, s57
    s_addc_u32 s5, s5, 0
    s_lshl_b32 s56, s52, 12
    s_mov_b32 s54, 0x40000
    s_mov_b32 s71, 0x3f803f80
    s_lshr_b32 s57, s51, 3
    s_lshl_b32 s57, s57, 1
    s_and_b32 s58, s52, 1
    s_add_u32 s74, s57, s58
    s_and_b32 s57, s51, 7
    s_lshl_b32 s57, s57, 1
    s_lshr_b32 s58, s52, 1
    s_add_u32 s57, s57, s58
    s_lshl_b32 s70, s74, 15
    s_lshl_b32 s67, s57, 11
    s_add_u32 s67, s67, s70
    s_lshr_b32 s73, s67, 3
    s_add_u32 s73, s73, 262144
    s_lshl_b32 s57, s57, 6
    s_add_u32 s70, s70, s57
    s_lshl_b32 s57, s50, 17
    s_add_u32 s70, s70, s57
    s_lshl_b32 s74, s74, 1
    s_add_u32 s74, s74, s58
    s_lshl_b32 s61, s51, 15
    s_add_u32 s61, s61, s56
    s_add_u32 s61, s61, 8912896
    s_and_b32 s57, s51, 7
    s_lshl_b32 s62, s57, 16
    s_add_u32 s62, s62, s56
    s_add_u32 s62, s62, 8388608
    s_mul_i32 s63, s51, 114688
    s_add_u32 s63, s63, s56
    s_add_u32 s63, s63, 6291456
    s_mul_i32 s64, s51, 229376
    s_add_u32 s64, s64, s56
    s_add_u32 s64, s64, 2097152
    s_getreg_b32 s55, hwreg(HW_REG_XCC_ID, 0, 4)
    s_lshl_b32 s65, s50, 7
    s_add_u32 s65, s65, 32768
    s_lshl_b32 s57, s51, 3
    s_add_u32 s66, s65, s57
    s_lshl_b32 s57, s51, 3
    s_lshr_b32 s81, s76, 8
    s_add_u32 s81, s81, 16384
    s_add_u32 s82, s81, s57
    s_add_u32 s83, s81, 8192
    s_lshl_b32 s57, s50, 9
    s_lshr_b32 s58, s67, 8
    s_add_u32 s57, s57, s58
    s_add_u32 s84, s57, 24576
    s_and_b32 s57, s57, -128
    s_add_u32 s85, s57, 16384
    s_lshl_b32 s79, s52, 15
    s_lshl_b32 s57, s51, 11
    s_add_u32 s86, s79, s57
    s_and_b32 s57, s51, 7
    s_lshl_b32 s57, s57, 1
    s_lshr_b32 s58, s51, 3
    s_add_u32 s57, s57, s58
    s_lshl_b32 s57, s57, 11
    s_add_u32 s79, s79, s57
    s_lshr_b32 s80, s79, 3
    s_add_u32 s80, s80, 262144
    s_mov_b32 s87, 0x3f80
    s_mov_b32 s88, 0x3f800000
    v_lshrrev_b32 v202, 5, v196
    v_and_b32 v203, 31, v196
    v_lshlrev_b32 v4, 2, v196
    v_min_u32 v176, 16, v203
    v_mad_u32_u24 v176, v202, 17, v176
    v_lshlrev_b32 v16, 4, v176
    v_and_b32 v200, 1, v197
    v_lshrrev_b32 v201, 1, v197
    v_bfe_u32 v198, v196, 2, 2
    v_and_b32 v204, 1, v199
    v_lshrrev_b32 v205, 1, v199
    v_lshl_add_u32 v206, v204, 1, v205
    v_lshl_add_u32 v207, v201, 3, v198
    v_lshl_add_u32 v176, v200, 2, v206
    v_lshlrev_b32 v176, 3, v176
    v_lshl_add_u32 v6, v207, 6, v176
    v_lshl_add_u32 v210, v207, 10, v176
    s_lshl_b32 s57, s52, 8
    s_add_u32 s57, s57, 49152
    v_add_u32 v210, s57, v210
    v_add_u32 v2, 65536, v1
    v_add_u32 v3, 131072, v1
    v_and_b32 v5, 15, v196
    v_lshlrev_b32 v5, 3, v5
    s_lshr_b32 s57, s52, 1
    s_mul_i32 s58, s57, 3072
    s_add_u32 s58, s58, 98304
    v_add_u32 v22, s58, v1
    v_xor_b32 v23, 1024, v22
    v_bfe_u32 v176, v203, 1, 3
    v_xor_b32 v176, v176, v202
    v_lshlrev_b32 v176, 4, v176
    v_lshl_add_u32 v176, v203, 7, v176
    v_add_u32 v212, s75, v176
    v_xor_b32 v213, 32, v212
    v_xor_b32 v214, 64, v212
    v_xor_b32 v215, 96, v212
    v_bfe_u32 v180, v203, 1, 2
    s_lshl_b32 s57, s52, 11
    s_add_u32 s57, s57, 98304
    v_lshl_add_u32 v176, v203, 6, s57
    v_lshlrev_b32 v177, 1, v202
    v_xor_b32 v177, v177, v180
    v_lshl_add_u32 v7, v177, 4, v176
    v_xor_b32 v8, 16, v7
    v_xor_b32 v177, v202, v180
    v_lshl_add_u32 v9, v177, 4, v176
    v_xor_b32 v10, 32, v9
    v_lshrrev_b32 v181, 1, v198
    s_and_b32 s58, s52, 1
    v_lshl_add_u32 v176, v204, 1, v200
    v_xor_b32 v176, v176, v181
    v_lshlrev_b32 v176, 4, v176
    v_lshl_add_u32 v176, v205, 3, v176
    v_lshl_add_u32 v176, v207, 6, v176
    s_lshl_b32 s57, s58, 13
    s_add_u32 s57, s57, 98304
    v_add_u32 v11, s57, v176
    v_xor_b32 v12, 32, v11
    v_add_u32 v12, 256, v12
    s_lshl_b32 s57, s58, 1
    v_add_u32 v176, s57, v204
    v_xor_b32 v176, v176, v181
    v_lshlrev_b32 v176, 4, v176
    v_lshl_add_u32 v176, v205, 3, v176
    v_lshl_add_u32 v176, v207, 6, v176
    v_add_u32 v176, 114688, v176
    v_xor_b32 v177, 32, v176
    v_add_u32 v177, 256, v177
    v_mov_b32 v182, 122880
    v_cmp_eq_u32 vcc, 0, v200
    v_mov_b32 v183, 1024
    s_nop 0
    v_cndmask_b32 v13, v182, v176, vcc
    v_cndmask_b32 v14, v182, v177, vcc
    v_cndmask_b32 v15, 0, v183, vcc
    s_lshl_b32 s57, s52, 12
    s_add_u32 s57, s57, 131072
    v_add_u32 v17, s57, v1
    v_xor_b32 v18, 8192, v17
    s_add_u32 s57, s69, 65536
    v_add_u32 v19, s57, v1
    v_add_u32 v33, s69, v1
    v_add_u32 v35, 65536, v33
    v_add_u32 v37, 131072, v33
    v_lshlrev_b32 v176, 1, v5
    v_lshl_add_u32 v39, v197, 2, v176
    v_bfe_u32 v176, v203, 2, 1
    v_xor_b32 v176, v176, v202
    v_lshrrev_b32 v177, 4, v203
    v_or_b32 v176, v176, v177
    v_bfe_u32 v177, v203, 3, 1
    v_lshl_add_u32 v177, v177, 1, v205
    v_lshl_add_u32 v177, v176, 2, v177
    v_lshlrev_b32 v182, 4, v204
    v_mov_b32 v183, 0x3f80
    v_lshlrev_b32 v182, v182, v183
    v_cmp_eq_u32 vcc, 0, v177
    s_nop 1
    v_cndmask_b32 v183, 0, v182, vcc
    v_accvgpr_write_b32 a148, v183
    v_cmp_eq_u32 vcc, 1, v177
    s_nop 1
    v_cndmask_b32 v183, 0, v182, vcc
    v_accvgpr_write_b32 a149, v183
    v_cmp_eq_u32 vcc, 2, v177
    s_nop 1
    v_cndmask_b32 v183, 0, v182, vcc
    v_accvgpr_write_b32 a150, v183
    v_cmp_eq_u32 vcc, 3, v177
    s_nop 1
    v_cndmask_b32 v183, 0, v182, vcc
    v_accvgpr_write_b32 a151, v183
    v_lshlrev_b32 v176, 3, v206
    v_lshl_add_u32 v176, v207, 7, v176
    v_lshl_add_u32 v176, v200, 13, v176
    s_lshl_b32 s57, s52, 5
    s_add_u32 s57, s57, 65536
    v_add_u32 v184, s57, v176
    v_lshl_add_u32 v176, v200, 1, v205
    v_lshlrev_b32 v176, 3, v176
    v_lshl_add_u32 v176, v207, 5, v176
    s_add_u32 s57, s69, 81920
    v_add_u32 v185, s57, v176
    v_bfe_u32 v176, v196, 2, 1
    v_mov_b32 v177, 0x80008000
    v_mul_lo_u32 v186, v176, v177
    s_waitcnt lgkmcnt(0)
    s_add_u32 s44, s44, 0x3c6ef300
    s_mul_i32 s45, s45, 0x41c64e6d
    s_add_u32 s45, s45, s44
    s_and_b32 s45, s45, -16
    s_and_b32 s44, s44, 0x7fffff00
    v_mov_b32 v24, s44
    v_mov_b32 v25, s45
    s_cmp_ge_u32 s2, 144
    s_cselect_b32 s57, 2048, 0
    s_xor_b32 s49, s49, s57
    s_mul_i32 s57, s57, s52
    s_lshl_b32 s57, s57, 1
    s_xor_b32 s48, s48, s57
    s_xor_b32 s49, s49, s57
    s_lshr_b32 s57, s2, 3
    s_lshl_b32 s57, s57, 2
    s_add_u32 s57, s57, s52
    s_lshl_b32 s57, s57, 3
    s_and_b32 s58, s2, 7
    s_add_u32 s57, s57, s58
    s_lshl_b32 s91, s57, 7
    s_lshl_b32 s57, s57, 12
    s_add_u32 s91, s91, s90
    s_add_u32 s91, s91, 65536
    s_add_u32 s90, s90, s57
    s_add_u32 s90, s90, 2097152
    s_lshr_b32 s57, s57, 15
    s_mul_i32 s57, s57, 9363
    s_lshr_b32 s57, s57, 16
    s_and_b32 s58, s57, 7
    s_lshl_b32 s58, s58, 12
    s_xor_b32 s90, s90, s58
    s_and_b32 s57, s57, 8
    s_lshl_b32 s57, s57, 8
    s_xor_b32 s90, s90, s57
    s_lshl_b32 s57, s51, 2
    s_add_u32 s57, s57, s52
    s_lshl_b32 s57, s57, 4
    s_add_u32 s57, s57, s50
    s_mul_i32 s57, s57, 640
    s_add_u32 s92, s57, 262144
    v_lshlrev_b32 v220, 1, v4
    v_lshlrev_b32 v216, 0, v5
    s_lshl_b32 s93, s52, 9
    s_add_u32 s93, s93, 32768
    s_mov_b32 s94, s65
    v_mov_b32 v180, -1
    v_mov_b32 v181, -1
    v_mov_b32 v182, -1
    v_mov_b32 v183, -1
    v_accvgpr_write_b32 a136, 0
    v_accvgpr_write_b32 a137, 0
    v_accvgpr_write_b32 a138, 0
    v_accvgpr_write_b32 a139, 0
    v_accvgpr_write_b32 a140, 0
    v_accvgpr_write_b32 a141, 0
    v_accvgpr_write_b32 a142, 0
    v_accvgpr_write_b32 a143, 0
    v_accvgpr_write_b32 a144, 0
    v_accvgpr_write_b32 a145, 0
    v_accvgpr_write_b32 a146, 0
    v_accvgpr_write_b32 a147, 0
    v_mov_b32 v41, 0
    v_mov_b32 v42, 0
    v_mov_b32 v43, 0
    v_mov_b32 v44, 0
    v_mov_b32 v218, s71
    v_mov_b32 v219, s71
    v_mov_b32 v217, 122880
    v_mov_b32 v192, v13
    v_mov_b32 v193, v14
    v_add_u32 v194, v192, v15
    v_add_u32 v195, v193, v15
    v_add_u32 v196, v194, v15
    v_add_u32 v197, v195, v15
    v_add_u32 v198, v196, v15
    v_add_u32 v199, v197, v15
    v_add_u32 v200, v198, v15
    v_add_u32 v201, v199, v15
    v_add_u32 v202, v200, v15
    v_add_u32 v203, v201, v15
    v_add_u32 v204, v202, v15
    v_add_u32 v205, v203, v15
    v_add_u32 v206, v204, v15
    v_add_u32 v207, v205, v15
    s_add_u32 s72, s92, 655360
    buffer_store_dwordx4 v[180:183], v16, s[8:11], s92 offen offset:0 sc1
    buffer_store_dwordx4 v[180:183], v16, s[8:11], s72 offen offset:0 sc1
    s_mov_b64 exec, 1
    buffer_atomic_swap_x2 v[24:25], off, s[8:11], s84 sc1
    s_mov_b64 exec, -1
    s_mov_b64 exec, 1
    buffer_atomic_swap_x2 v[24:25], off, s[8:11], s82 sc1
    s_mov_b64 exec, -1
    s_mov_b64 exec, 0
    s_cmp_eq_u32 s52, 0
    s_cbranch_scc1 L_page_0
    s_cmp_eq_u32 s52, 1
    s_cbranch_scc1 L_page_1
    s_cmp_eq_u32 s52, 2
    s_cbranch_scc1 L_page_2
    s_branch L_page_3
.p2align 12
L_main:
    s_mov_b64 exec, -1
    s_waitcnt vmcnt(11)
    s_barrier
    ds_read_b64_tr_b16 v[64:65], v184 offset:0
    ds_read_b64_tr_b16 v[66:67], v184 offset:512
    ds_read_b64_tr_b16 v[68:69], v184 offset:2048
    ds_read_b64_tr_b16 v[70:71], v184 offset:2560
    ds_read_b64_tr_b16 v[72:73], v184 offset:4096
    ds_read_b64_tr_b16 v[74:75], v184 offset:4608
    ds_read_b64_tr_b16 v[76:77], v184 offset:6144
    ds_read_b64_tr_b16 v[78:79], v184 offset:6656
    s_waitcnt lgkmcnt(6)
    buffer_store_dwordx4 v[64:67], v1, s[8:11], s90 offen offset:0 sc1
    s_waitcnt lgkmcnt(4)
    buffer_store_dwordx4 v[68:71], v1, s[8:11], s90 offen offset:1024 sc1
    s_waitcnt lgkmcnt(2)
    s_xor_b32 s90, s90, 2048
    buffer_store_dwordx4 v[72:75], v1, s[8:11], s90 offen offset:0 sc1
    s_waitcnt lgkmcnt(0)
    buffer_store_dwordx4 v[76:79], v1, s[8:11], s90 offen offset:1024 sc1
    v_dot2_f32_bf16 v221, v64, s71, 0
    v_dot2_f32_bf16 v177, v65, s71, 0
    v_dot2_f32_bf16 v221, v66, s71, v221
    v_dot2_f32_bf16 v177, v67, s71, v177
    v_dot2_f32_bf16 v221, v68, s71, v221
    v_dot2_f32_bf16 v177, v69, s71, v177
    v_dot2_f32_bf16 v221, v70, s71, v221
    v_dot2_f32_bf16 v177, v71, s71, v177
    v_dot2_f32_bf16 v221, v72, s71, v221
    v_dot2_f32_bf16 v177, v73, s71, v177
    v_dot2_f32_bf16 v221, v74, s71, v221
    v_dot2_f32_bf16 v177, v75, s71, v177
    v_dot2_f32_bf16 v221, v76, s71, v221
    v_dot2_f32_bf16 v177, v77, s71, v177
    v_dot2_f32_bf16 v221, v78, s71, v221
    v_dot2_f32_bf16 v177, v79, s71, v177
    s_nop 2
    v_add_f32 v221, v221, v177
    v_mov_b32 v177, v221
    s_nop 1
    v_permlane32_swap_b32 v221, v177
    v_add_f32 v221, v221, v177
    v_cvt_pk_bf16_f32 v177, v221, v221
    v_and_b32 v177, 0xffff0000, v177
    v_sub_f32 v177, v221, v177
    v_cvt_pk_bf16_f32 v221, v221, v177
    s_mov_b32 exec_hi, 0
    buffer_store_dword v221, v4, s[8:11], s91 offen sc1
    s_mov_b64 exec, -1
    s_waitcnt vmcnt(11)
    s_barrier
    ds_read_b64_tr_b16 v[48:49], v210 offset:0
    ds_read_b64_tr_b16 v[50:51], v210 offset:4096
    ds_read_b64_tr_b16 v[52:53], v210 offset:64
    ds_read_b64_tr_b16 v[54:55], v210 offset:4160
    ds_read_b64_tr_b16 v[56:57], v210 offset:128
    ds_read_b64_tr_b16 v[58:59], v210 offset:4224
    ds_read_b64_tr_b16 v[60:61], v210 offset:192
    ds_read_b64_tr_b16 v[62:63], v210 offset:4288
    ds_read_b64_tr_b16 v[80:81], v185 offset:0
    ds_read_b64_tr_b16 v[82:83], v185 offset:128
    ds_read_b64_tr_b16 v[84:85], v185 offset:512
    ds_read_b64_tr_b16 v[86:87], v185 offset:640
    s_add_u32 m0, s89, 0
    s_add_u32 s60, s68, 1024
    buffer_load_dwordx4 v209, s[16:19], s60 offen lds
    buffer_load_dwordx4 v209, s[16:19], s60 offen offset:1024 lds
    s_add_u32 m0, s75, 0
    s_add_u32 s60, s76, 0
    buffer_load_dwordx4 v188, s[12:15], s60 offen lds
    buffer_load_dwordx4 v189, s[12:15], s60 offen offset:1024 lds
    buffer_load_dwordx4 v190, s[12:15], s60 offen offset:2048 lds
    buffer_load_dwordx4 v191, s[12:15], s60 offen offset:3072 lds
    s_waitcnt lgkmcnt(10)
    buffer_store_dwordx4 v[48:51], v1, s[8:11], s48 offen offset:0 sc1
    s_waitcnt lgkmcnt(8)
    s_add_u32 s48, s48, s78
    buffer_store_dwordx4 v[52:55], v1, s[8:11], s48 offen offset:0 sc1
    s_waitcnt lgkmcnt(6)
    buffer_store_dwordx4 v[56:59], v1, s[8:11], s49 offen offset:0 sc1
    s_waitcnt lgkmcnt(4)
    s_add_u32 s49, s49, s78
    buffer_store_dwordx4 v[60:63], v1, s[8:11], s49 offen offset:0 sc1
    s_waitcnt lgkmcnt(0)
    v_xor_b32 v80, v186, v80
    v_accvgpr_write_b32 a128, v80
    v_xor_b32 v81, v186, v81
    v_accvgpr_write_b32 a129, v81
    v_xor_b32 v82, v186, v82
    v_accvgpr_write_b32 a130, v82
    v_xor_b32 v83, v186, v83
    v_accvgpr_write_b32 a131, v83
    v_xor_b32 v84, v186, v84
    v_accvgpr_write_b32 a132, v84
    v_xor_b32 v85, v186, v85
    v_accvgpr_write_b32 a133, v85
    v_xor_b32 v86, v186, v86
    v_accvgpr_write_b32 a134, v86
    v_xor_b32 v87, v186, v87
    v_accvgpr_write_b32 a135, v87
    s_add_u32 m0, s89, 8192
    s_add_u32 s60, s68, 197632
    buffer_load_dwordx4 v209, s[16:19], s60 offen lds
    buffer_load_dwordx4 v209, s[16:19], s60 offen offset:1024 lds
    s_add_u32 m0, s75, 4096
    s_add_u32 s60, s76, 128
    buffer_load_dwordx4 v188, s[12:15], s60 offen lds
    buffer_load_dwordx4 v189, s[12:15], s60 offen offset:1024 lds
    buffer_load_dwordx4 v190, s[12:15], s60 offen offset:2048 lds
    buffer_load_dwordx4 v191, s[12:15], s60 offen offset:3072 lds
    s_lshr_b32 s57, s74, 1
    s_sub_u32 s57, s57, s52
    s_lshl_b32 s57, s57, 14
    v_add_u32 v186, s57, v212
    s_and_b32 s57, s52, 2
    s_lshl_b32 s57, s57, 5
    v_xor_b32 v186, s57, v186
    v_xor_b32 v187, 32, v186
    s_and_b32 s92, s51, 7
    s_waitcnt vmcnt(10)
    s_barrier
    s_add_u32 m0, s89, 16384
    s_add_u32 s60, s68, 394240
    s_cmp_lg_u32 s92, 0
    s_cbranch_scc1 L_skip_2
    ds_read_b128 v[48:51], v186 offset:0
    ds_read_b128 v[52:55], v187 offset:0
L_skip_2:
    ds_read_b128 a[0:3], v212 offset:0
    ds_read_b64_tr_b16 v[80:81], v6 offset:0
    ds_read_b64_tr_b16 v[82:83], v6 offset:256
    ds_read_b64_tr_b16 v[84:85], v6 offset:1024
    ds_read_b64_tr_b16 v[86:87], v6 offset:1280
    s_waitcnt lgkmcnt(2)
    v_mfma_f32_32x32x16_bf16 v[112:127], v[80:83], a[0:3], 0
    buffer_load_dwordx4 v209, s[16:19], s60 offen lds
    ds_read_b128 a[4:7], v213 offset:0
    ds_read_b64_tr_b16 v[88:89], v6 offset:2048
    ds_read_b64_tr_b16 v[90:91], v6 offset:2304
    s_waitcnt lgkmcnt(3)
    v_mfma_f32_32x32x16_bf16 v[128:143], v[84:87], a[0:3], 0
    buffer_load_dwordx4 v209, s[16:19], s60 offen offset:1024 lds
    ds_read_b64_tr_b16 v[92:93], v6 offset:3072
    ds_read_b64_tr_b16 v[94:95], v6 offset:3328
    ds_read_b128 a[152:155], v33 offset:0
    s_add_u32 m0, s75, 8192
    s_add_u32 s60, s76, 256
    v_mfma_f32_4x4x4_16b_bf16 v[144:147], v[218:219], a[0:1], 0
    v_mfma_f32_4x4x4_16b_bf16 v[148:151], a[0:1], a[0:1], 0
    v_mfma_f32_4x4x4_16b_bf16 v[152:155], v[218:219], v[80:81], 0
    v_mfma_f32_4x4x4_16b_bf16 v[156:159], v[218:219], v[84:85], 0
    v_mfma_f32_4x4x4_16b_bf16 v[144:147], v[218:219], a[2:3], v[144:147]
    v_mfma_f32_4x4x4_16b_bf16 v[148:151], a[2:3], a[2:3], v[148:151]
    v_mfma_f32_4x4x4_16b_bf16 v[152:155], v[218:219], v[82:83], v[152:155]
    v_mfma_f32_4x4x4_16b_bf16 v[156:159], v[218:219], v[86:87], v[156:159]
    s_waitcnt lgkmcnt(3)
    v_mfma_f32_32x32x16_bf16 v[112:127], v[88:91], a[4:7], v[112:127]
    buffer_load_dwordx4 v188, s[12:15], s60 offen lds
    ds_read_b128 a[8:11], v214 offset:0
    ds_read_b64_tr_b16 v[96:97], v6 offset:4096
    ds_read_b64_tr_b16 v[98:99], v6 offset:4352
    s_waitcnt lgkmcnt(4)
    v_mfma_f32_32x32x16_bf16 v[128:143], v[92:95], a[4:7], v[128:143]
    buffer_load_dwordx4 v189, s[12:15], s60 offen offset:1024 lds
    ds_read_b64_tr_b16 v[100:101], v6 offset:5120
    ds_read_b64_tr_b16 v[102:103], v6 offset:5376
    v_mfma_f32_4x4x4_16b_bf16 v[144:147], v[218:219], a[4:5], v[144:147]
    v_mfma_f32_4x4x4_16b_bf16 v[148:151], a[4:5], a[4:5], v[148:151]
    v_mfma_f32_4x4x4_16b_bf16 v[152:155], v[218:219], v[88:89], v[152:155]
    v_mfma_f32_4x4x4_16b_bf16 v[156:159], v[218:219], v[92:93], v[156:159]
    v_mfma_f32_4x4x4_16b_bf16 v[144:147], v[218:219], a[6:7], v[144:147]
    v_mfma_f32_4x4x4_16b_bf16 v[148:151], a[6:7], a[6:7], v[148:151]
    v_mfma_f32_4x4x4_16b_bf16 v[152:155], v[218:219], v[90:91], v[152:155]
    v_mfma_f32_4x4x4_16b_bf16 v[156:159], v[218:219], v[94:95], v[156:159]
    s_waitcnt lgkmcnt(2)
    v_mfma_f32_32x32x16_bf16 v[112:127], v[96:99], a[8:11], v[112:127]
    buffer_load_dwordx4 v190, s[12:15], s60 offen offset:2048 lds
    ds_read_b128 a[12:15], v215 offset:0
    ds_read_b64_tr_b16 v[104:105], v6 offset:6144
    ds_read_b64_tr_b16 v[106:107], v6 offset:6400
    s_waitcnt lgkmcnt(3)
    v_mfma_f32_32x32x16_bf16 v[128:143], v[100:103], a[8:11], v[128:143]
    buffer_load_dwordx4 v191, s[12:15], s60 offen offset:3072 lds
    ds_read_b64_tr_b16 v[108:109], v6 offset:7168
    ds_read_b64_tr_b16 v[110:111], v6 offset:7424
    ds_read_b128 a[156:159], v33 offset:4096
    v_mfma_f32_4x4x4_16b_bf16 v[144:147], v[218:219], a[8:9], v[144:147]
    v_mfma_f32_4x4x4_16b_bf16 v[148:151], a[8:9], a[8:9], v[148:151]
    v_mfma_f32_4x4x4_16b_bf16 v[152:155], v[218:219], v[96:97], v[152:155]
    v_mfma_f32_4x4x4_16b_bf16 v[156:159], v[218:219], v[100:101], v[156:159]
    v_mfma_f32_4x4x4_16b_bf16 v[144:147], v[218:219], a[10:11], v[144:147]
    v_mfma_f32_4x4x4_16b_bf16 v[148:151], a[10:11], a[10:11], v[148:151]
    v_mfma_f32_4x4x4_16b_bf16 v[152:155], v[218:219], v[98:99], v[152:155]
    v_mfma_f32_4x4x4_16b_bf16 v[156:159], v[218:219], v[102:103], v[156:159]
    s_waitcnt lgkmcnt(3)
    v_mfma_f32_32x32x16_bf16 v[112:127], v[104:107], a[12:15], v[112:127]
    s_waitcnt vmcnt(6)
    s_barrier
    s_add_u32 m0, s89, 24576
    s_add_u32 s60, s68, 590848
    s_cmp_lg_u32 s92, 1
    s_cbranch_scc1 L_skip_3
    ds_read_b128 v[48:51], v186 offset:4096
    ds_read_b128 v[52:55], v187 offset:4096
L_skip_3:
    s_cmp_lg_u32 s52, 0
    s_cbranch_scc1 L_skip_4
    v_mov_b32 v176, s44
    v_or_b32 v177, s55, v25
    s_mov_b64 exec, 1
    buffer_atomic_swap_x2 v[176:177], off, s[8:11], s66 sc1
    s_mov_b64 exec, -1
L_skip_4:
    ds_read_b128 a[16:19], v212 offset:4096
    ds_read_b64_tr_b16 v[80:81], v6 offset:8192
    ds_read_b64_tr_b16 v[82:83], v6 offset:8448
    s_waitcnt lgkmcnt(4)
    v_mfma_f32_32x32x16_bf16 v[128:143], v[108:111], a[12:15], v[128:143]
    buffer_load_dwordx4 v209, s[16:19], s60 offen lds
    ds_read_b64_tr_b16 v[84:85], v6 offset:9216
    ds_read_b64_tr_b16 v[86:87], v6 offset:9472
    v_mfma_f32_4x4x4_16b_bf16 v[144:147], v[218:219], a[12:13], v[144:147]
    v_mfma_f32_4x4x4_16b_bf16 v[148:151], a[12:13], a[12:13], v[148:151]
    v_mfma_f32_4x4x4_16b_bf16 v[152:155], v[218:219], v[104:105], v[152:155]
    v_mfma_f32_4x4x4_16b_bf16 v[156:159], v[218:219], v[108:109], v[156:159]
    v_mfma_f32_4x4x4_16b_bf16 v[144:147], v[218:219], a[14:15], v[144:147]
    v_mfma_f32_4x4x4_16b_bf16 v[148:151], a[14:15], a[14:15], v[148:151]
    v_mfma_f32_4x4x4_16b_bf16 v[152:155], v[218:219], v[106:107], v[152:155]
    v_mfma_f32_4x4x4_16b_bf16 v[156:159], v[218:219], v[110:111], v[156:159]
    s_waitcnt lgkmcnt(2)
    v_mfma_f32_32x32x16_bf16 v[112:127], v[80:83], a[16:19], v[112:127]
    buffer_load_dwordx4 v209, s[16:19], s60 offen offset:1024 lds
    ds_read_b128 a[20:23], v213 offset:4096
    ds_read_b64_tr_b16 v[88:89], v6 offset:10240
    ds_read_b64_tr_b16 v[90:91], v6 offset:10496
    s_add_u32 m0, s75, 12288
    s_add_u32 s60, s76, 384
    s_waitcnt lgkmcnt(3)
    v_mfma_f32_32x32x16_bf16 v[128:143], v[84:87], a[16:19], v[128:143]
    buffer_load_dwordx4 v188, s[12:15], s60 offen lds
    ds_read_b64_tr_b16 v[92:93], v6 offset:11264
    ds_read_b64_tr_b16 v[94:95], v6 offset:11520
    ds_read_b128 a[160:163], v33 offset:8192
    v_mfma_f32_4x4x4_16b_bf16 v[144:147], v[218:219], a[16:17], v[144:147]
    v_mfma_f32_4x4x4_16b_bf16 v[148:151], a[16:17], a[16:17], v[148:151]
    v_mfma_f32_4x4x4_16b_bf16 v[152:155], v[218:219], v[80:81], v[152:155]
    v_mfma_f32_4x4x4_16b_bf16 v[156:159], v[218:219], v[84:85], v[156:159]
    v_mfma_f32_4x4x4_16b_bf16 v[144:147], v[218:219], a[18:19], v[144:147]
    v_mfma_f32_4x4x4_16b_bf16 v[148:151], a[18:19], a[18:19], v[148:151]
    v_mfma_f32_4x4x4_16b_bf16 v[152:155], v[218:219], v[82:83], v[152:155]
    v_mfma_f32_4x4x4_16b_bf16 v[156:159], v[218:219], v[86:87], v[156:159]
    s_waitcnt lgkmcnt(3)
    v_mfma_f32_32x32x16_bf16 v[112:127], v[88:91], a[20:23], v[112:127]
    buffer_load_dwordx4 v189, s[12:15], s60 offen offset:1024 lds
    ds_read_b128 a[24:27], v214 offset:4096
    ds_read_b64_tr_b16 v[96:97], v6 offset:12288
    ds_read_b64_tr_b16 v[98:99], v6 offset:12544
    s_waitcnt lgkmcnt(4)
    v_mfma_f32_32x32x16_bf16 v[128:143], v[92:95], a[20:23], v[128:143]
    buffer_load_dwordx4 v190, s[12:15], s60 offen offset:2048 lds
    ds_read_b64_tr_b16 v[100:101], v6 offset:13312
    ds_read_b64_tr_b16 v[102:103], v6 offset:13568
    v_mfma_f32_4x4x4_16b_bf16 v[144:147], v[218:219], a[20:21], v[144:147]
    v_mfma_f32_4x4x4_16b_bf16 v[148:151], a[20:21], a[20:21], v[148:151]
    v_mfma_f32_4x4x4_16b_bf16 v[152:155], v[218:219], v[88:89], v[152:155]
    v_mfma_f32_4x4x4_16b_bf16 v[156:159], v[218:219], v[92:93], v[156:159]
    v_mfma_f32_4x4x4_16b_bf16 v[144:147], v[218:219], a[22:23], v[144:147]
    v_mfma_f32_4x4x4_16b_bf16 v[148:151], a[22:23], a[22:23], v[148:151]
    v_mfma_f32_4x4x4_16b_bf16 v[152:155], v[218:219], v[90:91], v[152:155]
    v_mfma_f32_4x4x4_16b_bf16 v[156:159], v[218:219], v[94:95], v[156:159]
    s_waitcnt lgkmcnt(2)
    v_mfma_f32_32x32x16_bf16 v[112:127], v[96:99], a[24:27], v[112:127]
    buffer_load_dwordx4 v191, s[12:15], s60 offen offset:3072 lds
    ds_read_b128 a[28:31], v215 offset:4096
    ds_read_b64_tr_b16 v[104:105], v6 offset:14336
    ds_read_b64_tr_b16 v[106:107], v6 offset:14592
    s_waitcnt lgkmcnt(3)
    v_mfma_f32_32x32x16_bf16 v[128:143], v[100:103], a[24:27], v[128:143]
    ds_read_b64_tr_b16 v[108:109], v6 offset:15360
    ds_read_b64_tr_b16 v[110:111], v6 offset:15616
    ds_read_b128 a[164:167], v33 offset:12288
    v_mfma_f32_4x4x4_16b_bf16 v[144:147], v[218:219], a[24:25], v[144:147]
    v_mfma_f32_4x4x4_16b_bf16 v[148:151], a[24:25], a[24:25], v[148:151]
    v_mfma_f32_4x4x4_16b_bf16 v[152:155], v[218:219], v[96:97], v[152:155]
    v_mfma_f32_4x4x4_16b_bf16 v[156:159], v[218:219], v[100:101], v[156:159]
    v_mfma_f32_4x4x4_16b_bf16 v[144:147], v[218:219], a[26:27], v[144:147]
    v_mfma_f32_4x4x4_16b_bf16 v[148:151], a[26:27], a[26:27], v[148:151]
    v_mfma_f32_4x4x4_16b_bf16 v[152:155], v[218:219], v[98:99], v[152:155]
    v_mfma_f32_4x4x4_16b_bf16 v[156:159], v[218:219], v[102:103], v[156:159]
    s_waitcnt lgkmcnt(3)
    v_mfma_f32_32x32x16_bf16 v[112:127], v[104:107], a[28:31], v[112:127]
    s_waitcnt vmcnt(6)
    s_barrier
    s_add_u32 m0, s89, 32768
    s_add_u32 s60, s68, 787456
    s_cmp_lg_u32 s92, 2
    s_cbranch_scc1 L_skip_5
    ds_read_b128 v[48:51], v186 offset:8192
    ds_read_b128 v[52:55], v187 offset:8192
L_skip_5:
    ds_read_b128 a[32:35], v212 offset:8192
    ds_read_b64_tr_b16 v[80:81], v6 offset:16384
    ds_read_b64_tr_b16 v[82:83], v6 offset:16640
    s_waitcnt lgkmcnt(4)
    v_mfma_f32_32x32x16_bf16 v[128:143], v[108:111], a[28:31], v[128:143]
    buffer_load_dwordx4 v209, s[16:19], s60 offen lds
    ds_read_b64_tr_b16 v[84:85], v6 offset:17408
    ds_read_b64_tr_b16 v[86:87], v6 offset:17664
    v_mfma_f32_4x4x4_16b_bf16 v[144:147], v[218:219], a[28:29], v[144:147]
    v_mfma_f32_4x4x4_16b_bf16 v[148:151], a[28:29], a[28:29], v[148:151]
    v_mfma_f32_4x4x4_16b_bf16 v[152:155], v[218:219], v[104:105], v[152:155]
    v_mfma_f32_4x4x4_16b_bf16 v[156:159], v[218:219], v[108:109], v[156:159]
    v_mfma_f32_4x4x4_16b_bf16 v[144:147], v[218:219], a[30:31], v[144:147]
    v_mfma_f32_4x4x4_16b_bf16 v[148:151], a[30:31], a[30:31], v[148:151]
    v_mfma_f32_4x4x4_16b_bf16 v[152:155], v[218:219], v[106:107], v[152:155]
    v_mfma_f32_4x4x4_16b_bf16 v[156:159], v[218:219], v[110:111], v[156:159]
    s_waitcnt lgkmcnt(2)
    v_mfma_f32_32x32x16_bf16 v[112:127], v[80:83], a[32:35], v[112:127]
    buffer_load_dwordx4 v209, s[16:19], s60 offen offset:1024 lds
    ds_read_b128 a[36:39], v213 offset:8192
    ds_read_b64_tr_b16 v[88:89], v6 offset:18432
    ds_read_b64_tr_b16 v[90:91], v6 offset:18688
    s_add_u32 m0, s75, 0
    s_add_u32 s60, s76, 512
    s_waitcnt lgkmcnt(3)
    v_mfma_f32_32x32x16_bf16 v[128:143], v[84:87], a[32:35], v[128:143]
    buffer_load_dwordx4 v188, s[12:15], s60 offen lds
    ds_read_b64_tr_b16 v[92:93], v6 offset:19456
    ds_read_b64_tr_b16 v[94:95], v6 offset:19712
    ds_read_b128 a[168:171], v33 offset:16384
    v_mfma_f32_4x4x4_16b_bf16 v[144:147], v[218:219], a[32:33], v[144:147]
    v_mfma_f32_4x4x4_16b_bf16 v[148:151], a[32:33], a[32:33], v[148:151]
    v_mfma_f32_4x4x4_16b_bf16 v[152:155], v[218:219], v[80:81], v[152:155]
    v_mfma_f32_4x4x4_16b_bf16 v[156:159], v[218:219], v[84:85], v[156:159]
    v_mfma_f32_4x4x4_16b_bf16 v[144:147], v[218:219], a[34:35], v[144:147]
    v_mfma_f32_4x4x4_16b_bf16 v[148:151], a[34:35], a[34:35], v[148:151]
    v_mfma_f32_4x4x4_16b_bf16 v[152:155], v[218:219], v[82:83], v[152:155]
    v_mfma_f32_4x4x4_16b_bf16 v[156:159], v[218:219], v[86:87], v[156:159]
    s_waitcnt lgkmcnt(3)
    v_mfma_f32_32x32x16_bf16 v[112:127], v[88:91], a[36:39], v[112:127]
    buffer_load_dwordx4 v189, s[12:15], s60 offen offset:1024 lds
    ds_read_b128 a[40:43], v214 offset:8192
    ds_read_b64_tr_b16 v[96:97], v6 offset:20480
    ds_read_b64_tr_b16 v[98:99], v6 offset:20736
    s_waitcnt lgkmcnt(4)
    v_mfma_f32_32x32x16_bf16 v[128:143], v[92:95], a[36:39], v[128:143]
    buffer_load_dwordx4 v190, s[12:15], s60 offen offset:2048 lds
    ds_read_b64_tr_b16 v[100:101], v6 offset:21504
    ds_read_b64_tr_b16 v[102:103], v6 offset:21760
    v_mfma_f32_4x4x4_16b_bf16 v[144:147], v[218:219], a[36:37], v[144:147]
    v_mfma_f32_4x4x4_16b_bf16 v[148:151], a[36:37], a[36:37], v[148:151]
    v_mfma_f32_4x4x4_16b_bf16 v[152:155], v[218:219], v[88:89], v[152:155]
    v_mfma_f32_4x4x4_16b_bf16 v[156:159], v[218:219], v[92:93], v[156:159]
    v_mfma_f32_4x4x4_16b_bf16 v[144:147], v[218:219], a[38:39], v[144:147]
    v_mfma_f32_4x4x4_16b_bf16 v[148:151], a[38:39], a[38:39], v[148:151]
    v_mfma_f32_4x4x4_16b_bf16 v[152:155], v[218:219], v[90:91], v[152:155]
    v_mfma_f32_4x4x4_16b_bf16 v[156:159], v[218:219], v[94:95], v[156:159]
    s_waitcnt lgkmcnt(2)
    v_mfma_f32_32x32x16_bf16 v[112:127], v[96:99], a[40:43], v[112:127]
    buffer_load_dwordx4 v191, s[12:15], s60 offen offset:3072 lds
    ds_read_b128 a[44:47], v215 offset:8192
    ds_read_b64_tr_b16 v[104:105], v6 offset:22528
    ds_read_b64_tr_b16 v[106:107], v6 offset:22784
    s_waitcnt lgkmcnt(3)
    v_mfma_f32_32x32x16_bf16 v[128:143], v[100:103], a[40:43], v[128:143]
    ds_read_b64_tr_b16 v[108:109], v6 offset:23552
    ds_read_b64_tr_b16 v[110:111], v6 offset:23808
    ds_read_b128 a[172:175], v33 offset:20480
    v_mfma_f32_4x4x4_16b_bf16 v[144:147], v[218:219], a[40:41], v[144:147]
    v_mfma_f32_4x4x4_16b_bf16 v[148:151], a[40:41], a[40:41], v[148:151]
    v_mfma_f32_4x4x4_16b_bf16 v[152:155], v[218:219], v[96:97], v[152:155]
    v_mfma_f32_4x4x4_16b_bf16 v[156:159], v[218:219], v[100:101], v[156:159]
    v_mfma_f32_4x4x4_16b_bf16 v[144:147], v[218:219], a[42:43], v[144:147]
    v_mfma_f32_4x4x4_16b_bf16 v[148:151], a[42:43], a[42:43], v[148:151]
    v_mfma_f32_4x4x4_16b_bf16 v[152:155], v[218:219], v[98:99], v[152:155]
    v_mfma_f32_4x4x4_16b_bf16 v[156:159], v[218:219], v[102:103], v[156:159]
    s_waitcnt lgkmcnt(3)
    v_mfma_f32_32x32x16_bf16 v[112:127], v[104:107], a[44:47], v[112:127]
    s_waitcnt vmcnt(6)
    s_barrier
    s_add_u32 m0, s89, 40960
    s_add_u32 s60, s68, 984064
    s_cmp_lg_u32 s92, 3
    s_cbranch_scc1 L_skip_6
    ds_read_b128 v[48:51], v186 offset:12288
    ds_read_b128 v[52:55], v187 offset:12288
L_skip_6:
    ds_read_b128 a[48:51], v212 offset:12288
    ds_read_b64_tr_b16 v[80:81], v6 offset:24576
    ds_read_b64_tr_b16 v[82:83], v6 offset:24832
    s_waitcnt lgkmcnt(4)
    v_mfma_f32_32x32x16_bf16 v[128:143], v[108:111], a[44:47], v[128:143]
    buffer_load_dwordx4 v209, s[16:19], s60 offen lds
    ds_read_b64_tr_b16 v[84:85], v6 offset:25600
    ds_read_b64_tr_b16 v[86:87], v6 offset:25856
    v_mfma_f32_4x4x4_16b_bf16 v[144:147], v[218:219], a[44:45], v[144:147]
    v_mfma_f32_4x4x4_16b_bf16 v[148:151], a[44:45], a[44:45], v[148:151]
    v_mfma_f32_4x4x4_16b_bf16 v[152:155], v[218:219], v[104:105], v[152:155]
    v_mfma_f32_4x4x4_16b_bf16 v[156:159], v[218:219], v[108:109], v[156:159]
    v_mfma_f32_4x4x4_16b_bf16 v[144:147], v[218:219], a[46:47], v[144:147]
    v_mfma_f32_4x4x4_16b_bf16 v[148:151], a[46:47], a[46:47], v[148:151]
    v_mfma_f32_4x4x4_16b_bf16 v[152:155], v[218:219], v[106:107], v[152:155]
    v_mfma_f32_4x4x4_16b_bf16 v[156:159], v[218:219], v[110:111], v[156:159]
    s_waitcnt lgkmcnt(2)
    v_mfma_f32_32x32x16_bf16 v[112:127], v[80:83], a[48:51], v[112:127]
    buffer_load_dwordx4 v209, s[16:19], s60 offen offset:1024 lds
    ds_read_b128 a[52:55], v213 offset:12288
    ds_read_b64_tr_b16 v[88:89], v6 offset:26624
    ds_read_b64_tr_b16 v[90:91], v6 offset:26880
    s_add_u32 m0, s75, 4096
    s_add_u32 s60, s76, 640
    s_waitcnt lgkmcnt(3)
    v_mfma_f32_32x32x16_bf16 v[128:143], v[84:87], a[48:51], v[128:143]
    buffer_load_dwordx4 v188, s[12:15], s60 offen lds
    ds_read_b64_tr_b16 v[92:93], v6 offset:27648
    ds_read_b64_tr_b16 v[94:95], v6 offset:27904
    ds_read_b128 a[176:179], v33 offset:24576
    v_mfma_f32_4x4x4_16b_bf16 v[144:147], v[218:219], a[48:49], v[144:147]
    v_mfma_f32_4x4x4_16b_bf16 v[148:151], a[48:49], a[48:49], v[148:151]
    v_mfma_f32_4x4x4_16b_bf16 v[152:155], v[218:219], v[80:81], v[152:155]
    v_mfma_f32_4x4x4_16b_bf16 v[156:159], v[218:219], v[84:85], v[156:159]
    v_mfma_f32_4x4x4_16b_bf16 v[144:147], v[218:219], a[50:51], v[144:147]
    v_mfma_f32_4x4x4_16b_bf16 v[148:151], a[50:51], a[50:51], v[148:151]
    v_mfma_f32_4x4x4_16b_bf16 v[152:155], v[218:219], v[82:83], v[152:155]
    v_mfma_f32_4x4x4_16b_bf16 v[156:159], v[218:219], v[86:87], v[156:159]
    s_waitcnt lgkmcnt(3)
    v_mfma_f32_32x32x16_bf16 v[112:127], v[88:91], a[52:55], v[112:127]
    buffer_load_dwordx4 v189, s[12:15], s60 offen offset:1024 lds
    ds_read_b128 a[56:59], v214 offset:12288
    ds_read_b64_tr_b16 v[96:97], v6 offset:28672
    ds_read_b64_tr_b16 v[98:99], v6 offset:28928
    s_waitcnt lgkmcnt(4)
    v_mfma_f32_32x32x16_bf16 v[128:143], v[92:95], a[52:55], v[128:143]
    buffer_load_dwordx4 v190, s[12:15], s60 offen offset:2048 lds
    ds_read_b64_tr_b16 v[100:101], v6 offset:29696
    ds_read_b64_tr_b16 v[102:103], v6 offset:29952
    v_mfma_f32_4x4x4_16b_bf16 v[144:147], v[218:219], a[52:53], v[144:147]
    v_mfma_f32_4x4x4_16b_bf16 v[148:151], a[52:53], a[52:53], v[148:151]
    v_mfma_f32_4x4x4_16b_bf16 v[152:155], v[218:219], v[88:89], v[152:155]
    v_mfma_f32_4x4x4_16b_bf16 v[156:159], v[218:219], v[92:93], v[156:159]
    v_mfma_f32_4x4x4_16b_bf16 v[144:147], v[218:219], a[54:55], v[144:147]
    v_mfma_f32_4x4x4_16b_bf16 v[148:151], a[54:55], a[54:55], v[148:151]
    v_mfma_f32_4x4x4_16b_bf16 v[152:155], v[218:219], v[90:91], v[152:155]
    v_mfma_f32_4x4x4_16b_bf16 v[156:159], v[218:219], v[94:95], v[156:159]
    s_waitcnt lgkmcnt(2)
    v_mfma_f32_32x32x16_bf16 v[112:127], v[96:99], a[56:59], v[112:127]
    buffer_load_dwordx4 v191, s[12:15], s60 offen offset:3072 lds
    ds_read_b128 a[60:63], v215 offset:12288
    ds_read_b64_tr_b16 v[104:105], v6 offset:30720
    ds_read_b64_tr_b16 v[106:107], v6 offset:30976
    s_waitcnt lgkmcnt(3)
    v_mfma_f32_32x32x16_bf16 v[128:143], v[100:103], a[56:59], v[128:143]
    ds_read_b64_tr_b16 v[108:109], v6 offset:31744
    ds_read_b64_tr_b16 v[110:111], v6 offset:32000
    ds_read_b128 a[180:183], v33 offset:28672
    v_mfma_f32_4x4x4_16b_bf16 v[144:147], v[218:219], a[56:57], v[144:147]
    v_mfma_f32_4x4x4_16b_bf16 v[148:151], a[56:57], a[56:57], v[148:151]
    v_mfma_f32_4x4x4_16b_bf16 v[152:155], v[218:219], v[96:97], v[152:155]
    v_mfma_f32_4x4x4_16b_bf16 v[156:159], v[218:219], v[100:101], v[156:159]
    v_mfma_f32_4x4x4_16b_bf16 v[144:147], v[218:219], a[58:59], v[144:147]
    v_mfma_f32_4x4x4_16b_bf16 v[148:151], a[58:59], a[58:59], v[148:151]
    v_mfma_f32_4x4x4_16b_bf16 v[152:155], v[218:219], v[98:99], v[152:155]
    v_mfma_f32_4x4x4_16b_bf16 v[156:159], v[218:219], v[102:103], v[156:159]
    s_waitcnt lgkmcnt(3)
    v_mfma_f32_32x32x16_bf16 v[112:127], v[104:107], a[60:63], v[112:127]
    s_waitcnt vmcnt(6)
    s_barrier
    s_add_u32 m0, s89, 49152
    s_add_u32 s60, s68, 1180672
    s_cmp_lg_u32 s92, 4
    s_cbranch_scc1 L_skip_7
    ds_read_b128 v[48:51], v186 offset:0
    ds_read_b128 v[52:55], v187 offset:0
L_skip_7:
    ds_read_b128 a[64:67], v212 offset:0
    ds_read_b64_tr_b16 v[80:81], v6 offset:32768
    ds_read_b64_tr_b16 v[82:83], v6 offset:33024
    s_waitcnt lgkmcnt(4)
    v_mfma_f32_32x32x16_bf16 v[128:143], v[108:111], a[60:63], v[128:143]
    buffer_load_dwordx4 v209, s[16:19], s60 offen lds
    ds_read_b64_tr_b16 v[84:85], v6 offset:33792
    ds_read_b64_tr_b16 v[86:87], v6 offset:34048
    v_mfma_f32_4x4x4_16b_bf16 v[144:147], v[218:219], a[60:61], v[144:147]
    v_mfma_f32_4x4x4_16b_bf16 v[148:151], a[60:61], a[60:61], v[148:151]
    v_mfma_f32_4x4x4_16b_bf16 v[152:155], v[218:219], v[104:105], v[152:155]
    v_mfma_f32_4x4x4_16b_bf16 v[156:159], v[218:219], v[108:109], v[156:159]
    v_mfma_f32_4x4x4_16b_bf16 v[144:147], v[218:219], a[62:63], v[144:147]
    v_mfma_f32_4x4x4_16b_bf16 v[148:151], a[62:63], a[62:63], v[148:151]
    v_mfma_f32_4x4x4_16b_bf16 v[152:155], v[218:219], v[106:107], v[152:155]
    v_mfma_f32_4x4x4_16b_bf16 v[156:159], v[218:219], v[110:111], v[156:159]
    s_waitcnt lgkmcnt(2)
    v_mfma_f32_32x32x16_bf16 v[112:127], v[80:83], a[64:67], v[112:127]
    buffer_load_dwordx4 v209, s[16:19], s60 offen offset:1024 lds
    ds_read_b128 a[68:71], v213 offset:0
    ds_read_b64_tr_b16 v[88:89], v6 offset:34816
    ds_read_b64_tr_b16 v[90:91], v6 offset:35072
    s_add_u32 m0, s75, 8192
    s_add_u32 s60, s76, 768
    s_waitcnt lgkmcnt(3)
    v_mfma_f32_32x32x16_bf16 v[128:143], v[84:87], a[64:67], v[128:143]
    buffer_load_dwordx4 v188, s[12:15], s60 offen lds
    ds_read_b64_tr_b16 v[92:93], v6 offset:35840
    ds_read_b64_tr_b16 v[94:95], v6 offset:36096
    ds_read_b128 a[184:187], v33 offset:32768
    v_mfma_f32_4x4x4_16b_bf16 v[144:147], v[218:219], a[64:65], v[144:147]
    v_mfma_f32_4x4x4_16b_bf16 v[148:151], a[64:65], a[64:65], v[148:151]
    v_mfma_f32_4x4x4_16b_bf16 v[152:155], v[218:219], v[80:81], v[152:155]
    v_mfma_f32_4x4x4_16b_bf16 v[156:159], v[218:219], v[84:85], v[156:159]
    v_mfma_f32_4x4x4_16b_bf16 v[144:147], v[218:219], a[66:67], v[144:147]
    v_mfma_f32_4x4x4_16b_bf16 v[148:151], a[66:67], a[66:67], v[148:151]
    v_mfma_f32_4x4x4_16b_bf16 v[152:155], v[218:219], v[82:83], v[152:155]
    v_mfma_f32_4x4x4_16b_bf16 v[156:159], v[218:219], v[86:87], v[156:159]
    s_waitcnt lgkmcnt(3)
    v_mfma_f32_32x32x16_bf16 v[112:127], v[88:91], a[68:71], v[112:127]
    buffer_load_dwordx4 v189, s[12:15], s60 offen offset:1024 lds
    ds_read_b128 a[72:75], v214 offset:0
    ds_read_b64_tr_b16 v[96:97], v6 offset:36864
    ds_read_b64_tr_b16 v[98:99], v6 offset:37120
    s_waitcnt lgkmcnt(4)
    v_mfma_f32_32x32x16_bf16 v[128:143], v[92:95], a[68:71], v[128:143]
    buffer_load_dwordx4 v190, s[12:15], s60 offen offset:2048 lds
    ds_read_b64_tr_b16 v[100:101], v6 offset:37888
    ds_read_b64_tr_b16 v[102:103], v6 offset:38144
    v_mfma_f32_4x4x4_16b_bf16 v[144:147], v[218:219], a[68:69], v[144:147]
    v_mfma_f32_4x4x4_16b_bf16 v[148:151], a[68:69], a[68:69], v[148:151]
    v_mfma_f32_4x4x4_16b_bf16 v[152:155], v[218:219], v[88:89], v[152:155]
    v_mfma_f32_4x4x4_16b_bf16 v[156:159], v[218:219], v[92:93], v[156:159]
    v_mfma_f32_4x4x4_16b_bf16 v[144:147], v[218:219], a[70:71], v[144:147]
    v_mfma_f32_4x4x4_16b_bf16 v[148:151], a[70:71], a[70:71], v[148:151]
    v_mfma_f32_4x4x4_16b_bf16 v[152:155], v[218:219], v[90:91], v[152:155]
    v_mfma_f32_4x4x4_16b_bf16 v[156:159], v[218:219], v[94:95], v[156:159]
    s_waitcnt lgkmcnt(2)
    v_mfma_f32_32x32x16_bf16 v[112:127], v[96:99], a[72:75], v[112:127]
    buffer_load_dwordx4 v191, s[12:15], s60 offen offset:3072 lds
    ds_read_b128 a[76:79], v215 offset:0
    ds_read_b64_tr_b16 v[104:105], v6 offset:38912
    ds_read_b64_tr_b16 v[106:107], v6 offset:39168
    s_waitcnt lgkmcnt(3)
    v_mfma_f32_32x32x16_bf16 v[128:143], v[100:103], a[72:75], v[128:143]
    ds_read_b64_tr_b16 v[108:109], v6 offset:39936
    ds_read_b64_tr_b16 v[110:111], v6 offset:40192
    ds_read_b128 a[188:191], v33 offset:36864
    v_mfma_f32_4x4x4_16b_bf16 v[144:147], v[218:219], a[72:73], v[144:147]
    v_mfma_f32_4x4x4_16b_bf16 v[148:151], a[72:73], a[72:73], v[148:151]
    v_mfma_f32_4x4x4_16b_bf16 v[152:155], v[218:219], v[96:97], v[152:155]
    v_mfma_f32_4x4x4_16b_bf16 v[156:159], v[218:219], v[100:101], v[156:159]
    v_mfma_f32_4x4x4_16b_bf16 v[144:147], v[218:219], a[74:75], v[144:147]
    v_mfma_f32_4x4x4_16b_bf16 v[148:151], a[74:75], a[74:75], v[148:151]
    v_mfma_f32_4x4x4_16b_bf16 v[152:155], v[218:219], v[98:99], v[152:155]
    v_mfma_f32_4x4x4_16b_bf16 v[156:159], v[218:219], v[102:103], v[156:159]
    s_waitcnt lgkmcnt(3)
    v_mfma_f32_32x32x16_bf16 v[112:127], v[104:107], a[76:79], v[112:127]
    s_waitcnt vmcnt(6)
    s_barrier
    s_cmp_lg_u32 s92, 5
    s_cbranch_scc1 L_skip_8
    ds_read_b128 v[48:51], v186 offset:4096
    ds_read_b128 v[52:55], v187 offset:4096
L_skip_8:
    ds_read_b128 a[80:83], v212 offset:4096
    ds_read_b64_tr_b16 v[80:81], v6 offset:40960
    ds_read_b64_tr_b16 v[82:83], v6 offset:41216
    s_waitcnt lgkmcnt(4)
    v_mfma_f32_32x32x16_bf16 v[128:143], v[108:111], a[76:79], v[128:143]
    buffer_load_dwordx2 v[26:27], v220, s[8:11], s93 offen sc1
    ds_read_b64_tr_b16 v[84:85], v6 offset:41984
    ds_read_b64_tr_b16 v[86:87], v6 offset:42240
    v_mfma_f32_4x4x4_16b_bf16 v[144:147], v[218:219], a[76:77], v[144:147]
    v_mfma_f32_4x4x4_16b_bf16 v[148:151], a[76:77], a[76:77], v[148:151]
    v_mfma_f32_4x4x4_16b_bf16 v[152:155], v[218:219], v[104:105], v[152:155]
    v_mfma_f32_4x4x4_16b_bf16 v[156:159], v[218:219], v[108:109], v[156:159]
    v_mfma_f32_4x4x4_16b_bf16 v[144:147], v[218:219], a[78:79], v[144:147]
    v_mfma_f32_4x4x4_16b_bf16 v[148:151], a[78:79], a[78:79], v[148:151]
    v_mfma_f32_4x4x4_16b_bf16 v[152:155], v[218:219], v[106:107], v[152:155]
    v_mfma_f32_4x4x4_16b_bf16 v[156:159], v[218:219], v[110:111], v[156:159]
    s_waitcnt lgkmcnt(2)
    v_mfma_f32_32x32x16_bf16 v[112:127], v[80:83], a[80:83], v[112:127]
    buffer_load_dwordx2 v[28:29], v216, s[8:11], s94 offen sc1
L_page_0:
    s_cbranch_execz L_page_4
    ds_read_b128 a[84:87], v213 offset:4096
    ds_read_b64_tr_b16 v[88:89], v6 offset:43008
    ds_read_b64_tr_b16 v[90:91], v6 offset:43264
    s_add_u32 m0, s89, 57344
    s_add_u32 s60, s68, 1377280
    s_waitcnt lgkmcnt(3)
    v_mfma_f32_32x32x16_bf16 v[128:143], v[84:87], a[80:83], v[128:143]
    buffer_load_dwordx4 v209, s[16:19], s60 offen lds
    ds_read_b64_tr_b16 v[92:93], v6 offset:44032
    ds_read_b64_tr_b16 v[94:95], v6 offset:44288
    ds_read_b128 a[192:195], v33 offset:40960
    v_mfma_f32_4x4x4_16b_bf16 v[144:147], v[218:219], a[80:81], v[144:147]
    v_mfma_f32_4x4x4_16b_bf16 v[148:151], a[80:81], a[80:81], v[148:151]
    v_mfma_f32_4x4x4_16b_bf16 v[152:155], v[218:219], v[80:81], v[152:155]
    v_mfma_f32_4x4x4_16b_bf16 v[156:159], v[218:219], v[84:85], v[156:159]
    v_mfma_f32_4x4x4_16b_bf16 v[144:147], v[218:219], a[82:83], v[144:147]
    v_mfma_f32_4x4x4_16b_bf16 v[148:151], a[82:83], a[82:83], v[148:151]
    v_mfma_f32_4x4x4_16b_bf16 v[152:155], v[218:219], v[82:83], v[152:155]
    v_mfma_f32_4x4x4_16b_bf16 v[156:159], v[218:219], v[86:87], v[156:159]
    s_waitcnt lgkmcnt(3)
    v_mfma_f32_32x32x16_bf16 v[112:127], v[88:91], a[84:87], v[112:127]
    buffer_load_dwordx4 v209, s[16:19], s60 offen offset:1024 lds
    ds_read_b128 a[88:91], v214 offset:4096
    ds_read_b64_tr_b16 v[96:97], v6 offset:45056
    ds_read_b64_tr_b16 v[98:99], v6 offset:45312
    s_add_u32 m0, s75, 12288
    s_add_u32 s60, s76, 896
    s_waitcnt lgkmcnt(4)
    v_mfma_f32_32x32x16_bf16 v[128:143], v[92:95], a[84:87], v[128:143]
    buffer_load_dwordx4 v188, s[12:15], s60 offen lds
    ds_read_b64_tr_b16 v[100:101], v6 offset:46080
    ds_read_b64_tr_b16 v[102:103], v6 offset:46336
    v_mfma_f32_4x4x4_16b_bf16 v[144:147], v[218:219], a[84:85], v[144:147]
    v_mfma_f32_4x4x4_16b_bf16 v[148:151], a[84:85], a[84:85], v[148:151]
    v_mfma_f32_4x4x4_16b_bf16 v[152:155], v[218:219], v[88:89], v[152:155]
    v_mfma_f32_4x4x4_16b_bf16 v[156:159], v[218:219], v[92:93], v[156:159]
    v_mfma_f32_4x4x4_16b_bf16 v[144:147], v[218:219], a[86:87], v[144:147]
    v_mfma_f32_4x4x4_16b_bf16 v[148:151], a[86:87], a[86:87], v[148:151]
    v_mfma_f32_4x4x4_16b_bf16 v[152:155], v[218:219], v[90:91], v[152:155]
    v_mfma_f32_4x4x4_16b_bf16 v[156:159], v[218:219], v[94:95], v[156:159]
    s_waitcnt lgkmcnt(2)
    v_mfma_f32_32x32x16_bf16 v[112:127], v[96:99], a[88:91], v[112:127]
    buffer_load_dwordx4 v189, s[12:15], s60 offen offset:1024 lds
    ds_read_b128 a[92:95], v215 offset:4096
    ds_read_b64_tr_b16 v[104:105], v6 offset:47104
    ds_read_b64_tr_b16 v[106:107], v6 offset:47360
    s_waitcnt lgkmcnt(3)
    v_mfma_f32_32x32x16_bf16 v[128:143], v[100:103], a[88:91], v[128:143]
    buffer_load_dwordx4 v190, s[12:15], s60 offen offset:2048 lds
    ds_read_b64_tr_b16 v[108:109], v6 offset:48128
    ds_read_b64_tr_b16 v[110:111], v6 offset:48384
    ds_read_b128 a[196:199], v33 offset:45056
    v_mfma_f32_4x4x4_16b_bf16 v[144:147], v[218:219], a[88:89], v[144:147]
    v_mfma_f32_4x4x4_16b_bf16 v[148:151], a[88:89], a[88:89], v[148:151]
    v_mfma_f32_4x4x4_16b_bf16 v[152:155], v[218:219], v[96:97], v[152:155]
    v_mfma_f32_4x4x4_16b_bf16 v[156:159], v[218:219], v[100:101], v[156:159]
    v_mfma_f32_4x4x4_16b_bf16 v[144:147], v[218:219], a[90:91], v[144:147]
    v_mfma_f32_4x4x4_16b_bf16 v[148:151], a[90:91], a[90:91], v[148:151]
    v_mfma_f32_4x4x4_16b_bf16 v[152:155], v[218:219], v[98:99], v[152:155]
    v_mfma_f32_4x4x4_16b_bf16 v[156:159], v[218:219], v[102:103], v[156:159]
    s_waitcnt lgkmcnt(3)
    v_mfma_f32_32x32x16_bf16 v[112:127], v[104:107], a[92:95], v[112:127]
    buffer_load_dwordx4 v191, s[12:15], s60 offen offset:3072 lds
    s_waitcnt vmcnt(8)
    s_waitcnt vmcnt(6)
L_chk_10:
    v_mov_b32 v222, v26
    v_and_b32 v223, -16, v27
    v_cmp_ne_u64 vcc, s[44:45], v[222:223]
    s_nop 0
    s_cbranch_vccnz L_spin_9
L_chk_12:
    v_mov_b32 v222, v28
    v_and_b32 v223, -16, v29
    v_cmp_ne_u64 vcc, s[44:45], v[222:223]
    s_nop 0
    s_cbranch_vccnz L_spin_11
    v_and_b32 v178, 15, v29
    v_cmp_ne_u32 vcc, s55, v178
    s_nop 0
    s_cmp_eq_u64 vcc, 0
    s_cselect_b32 s53, 1, 0
    s_barrier
    s_add_u32 m0, s56, 65536
    s_add_u32 s60, s61, 0
    s_cmp_lg_u32 s92, 6
    s_cbranch_scc1 L_skip_13
    ds_read_b128 v[48:51], v186 offset:8192
    ds_read_b128 v[52:55], v187 offset:8192
L_skip_13:
    ds_read_b128 a[96:99], v212 offset:8192
    ds_read_b64_tr_b16 v[80:81], v6 offset:49152
    ds_read_b64_tr_b16 v[82:83], v6 offset:49408
    s_waitcnt lgkmcnt(4)
    v_mfma_f32_32x32x16_bf16 v[128:143], v[108:111], a[92:95], v[128:143]
    buffer_load_dwordx4 v1, s[8:11], s60 offen sc1 lds
    ds_read_b64_tr_b16 v[84:85], v6 offset:50176
    ds_read_b64_tr_b16 v[86:87], v6 offset:50432
    v_mfma_f32_4x4x4_16b_bf16 v[144:147], v[218:219], a[92:93], v[144:147]
    v_mfma_f32_4x4x4_16b_bf16 v[148:151], a[92:93], a[92:93], v[148:151]
    v_mfma_f32_4x4x4_16b_bf16 v[152:155], v[218:219], v[104:105], v[152:155]
    v_mfma_f32_4x4x4_16b_bf16 v[156:159], v[218:219], v[108:109], v[156:159]
    v_mfma_f32_4x4x4_16b_bf16 v[144:147], v[218:219], a[94:95], v[144:147]
    v_mfma_f32_4x4x4_16b_bf16 v[148:151], a[94:95], a[94:95], v[148:151]
    v_mfma_f32_4x4x4_16b_bf16 v[152:155], v[218:219], v[106:107], v[152:155]
    v_mfma_f32_4x4x4_16b_bf16 v[156:159], v[218:219], v[110:111], v[156:159]
    s_waitcnt lgkmcnt(2)
    v_mfma_f32_32x32x16_bf16 v[112:127], v[80:83], a[96:99], v[112:127]
    buffer_load_dwordx4 v1, s[8:11], s60 offen offset:1024 sc1 lds
    ds_read_b128 a[100:103], v213 offset:8192
    ds_read_b64_tr_b16 v[88:89], v6 offset:51200
    ds_read_b64_tr_b16 v[90:91], v6 offset:51456
    s_waitcnt lgkmcnt(3)
    v_mfma_f32_32x32x16_bf16 v[128:143], v[84:87], a[96:99], v[128:143]
    buffer_load_dwordx4 v1, s[8:11], s60 offen offset:2048 sc1 lds
    ds_read_b64_tr_b16 v[92:93], v6 offset:52224
    ds_read_b64_tr_b16 v[94:95], v6 offset:52480
    ds_read_b128 a[200:203], v33 offset:49152
    v_mfma_f32_4x4x4_16b_bf16 v[144:147], v[218:219], a[96:97], v[144:147]
    v_mfma_f32_4x4x4_16b_bf16 v[148:151], a[96:97], a[96:97], v[148:151]
    v_mfma_f32_4x4x4_16b_bf16 v[152:155], v[218:219], v[80:81], v[152:155]
    v_mfma_f32_4x4x4_16b_bf16 v[156:159], v[218:219], v[84:85], v[156:159]
    v_mfma_f32_4x4x4_16b_bf16 v[144:147], v[218:219], a[98:99], v[144:147]
    v_mfma_f32_4x4x4_16b_bf16 v[148:151], a[98:99], a[98:99], v[148:151]
    v_mfma_f32_4x4x4_16b_bf16 v[152:155], v[218:219], v[82:83], v[152:155]
    v_mfma_f32_4x4x4_16b_bf16 v[156:159], v[218:219], v[86:87], v[156:159]
    s_waitcnt lgkmcnt(3)
    v_mfma_f32_32x32x16_bf16 v[112:127], v[88:91], a[100:103], v[112:127]
    buffer_load_dwordx4 v1, s[8:11], s60 offen offset:3072 sc1 lds
    ds_read_b128 a[104:107], v214 offset:8192
    ds_read_b64_tr_b16 v[96:97], v6 offset:53248
    ds_read_b64_tr_b16 v[98:99], v6 offset:53504
    s_add_u32 m0, s56, 81920
    s_add_u32 s60, s61, 16384
    s_waitcnt lgkmcnt(4)
    v_mfma_f32_32x32x16_bf16 v[128:143], v[92:95], a[100:103], v[128:143]
    buffer_load_dwordx4 v1, s[8:11], s60 offen sc1 lds
    ds_read_b64_tr_b16 v[100:101], v6 offset:54272
    ds_read_b64_tr_b16 v[102:103], v6 offset:54528
    v_mfma_f32_4x4x4_16b_bf16 v[144:147], v[218:219], a[100:101], v[144:147]
    v_mfma_f32_4x4x4_16b_bf16 v[148:151], a[100:101], a[100:101], v[148:151]
    v_mfma_f32_4x4x4_16b_bf16 v[152:155], v[218:219], v[88:89], v[152:155]
    v_mfma_f32_4x4x4_16b_bf16 v[156:159], v[218:219], v[92:93], v[156:159]
    v_mfma_f32_4x4x4_16b_bf16 v[144:147], v[218:219], a[102:103], v[144:147]
    v_mfma_f32_4x4x4_16b_bf16 v[148:151], a[102:103], a[102:103], v[148:151]
    v_mfma_f32_4x4x4_16b_bf16 v[152:155], v[218:219], v[90:91], v[152:155]
    v_mfma_f32_4x4x4_16b_bf16 v[156:159], v[218:219], v[94:95], v[156:159]
    s_waitcnt lgkmcnt(2)
    v_mfma_f32_32x32x16_bf16 v[112:127], v[96:99], a[104:107], v[112:127]
    buffer_load_dwordx4 v1, s[8:11], s60 offen offset:1024 sc1 lds
    ds_read_b128 a[108:111], v215 offset:8192
    ds_read_b64_tr_b16 v[104:105], v6 offset:55296
    ds_read_b64_tr_b16 v[106:107], v6 offset:55552
    s_waitcnt lgkmcnt(3)
    v_mfma_f32_32x32x16_bf16 v[128:143], v[100:103], a[104:107], v[128:143]
    buffer_load_dwordx4 v1, s[8:11], s60 offen offset:2048 sc1 lds
    ds_read_b64_tr_b16 v[108:109], v6 offset:56320
    ds_read_b64_tr_b16 v[110:111], v6 offset:56576
    ds_read_b128 a[204:207], v33 offset:53248
    v_mfma_f32_4x4x4_16b_bf16 v[144:147], v[218:219], a[104:105], v[144:147]
    v_mfma_f32_4x4x4_16b_bf16 v[148:151], a[104:105], a[104:105], v[148:151]
    v_mfma_f32_4x4x4_16b_bf16 v[152:155], v[218:219], v[96:97], v[152:155]
    v_mfma_f32_4x4x4_16b_bf16 v[156:159], v[218:219], v[100:101], v[156:159]
    v_mfma_f32_4x4x4_16b_bf16 v[144:147], v[218:219], a[106:107], v[144:147]
    v_mfma_f32_4x4x4_16b_bf16 v[148:151], a[106:107], a[106:107], v[148:151]
    v_mfma_f32_4x4x4_16b_bf16 v[152:155], v[218:219], v[98:99], v[152:155]
    v_mfma_f32_4x4x4_16b_bf16 v[156:159], v[218:219], v[102:103], v[156:159]
    s_waitcnt lgkmcnt(3)
    v_mfma_f32_32x32x16_bf16 v[112:127], v[104:107], a[108:111], v[112:127]
    buffer_load_dwordx4 v1, s[8:11], s60 offen offset:3072 sc1 lds
    s_waitcnt vmcnt(8)
    s_barrier
    s_add_u32 m0, s56, 0
    s_add_u32 s60, s64, 0
    s_cmp_lg_u32 s92, 7
    s_cbranch_scc1 L_skip_14
    ds_read_b128 v[48:51], v186 offset:12288
    ds_read_b128 v[52:55], v187 offset:12288
L_skip_14:
    ds_read_b128 a[112:115], v212 offset:12288
    ds_read_b64_tr_b16 v[80:81], v6 offset:57344
    ds_read_b64_tr_b16 v[82:83], v6 offset:57600
    s_waitcnt lgkmcnt(4)
    v_mfma_f32_32x32x16_bf16 v[128:143], v[108:111], a[108:111], v[128:143]
    buffer_load_dwordx4 v1, s[8:11], s60 offen sc1 lds
    ds_read_b64_tr_b16 v[84:85], v6 offset:58368
    ds_read_b64_tr_b16 v[86:87], v6 offset:58624
    v_mfma_f32_4x4x4_16b_bf16 v[144:147], v[218:219], a[108:109], v[144:147]
    v_mfma_f32_4x4x4_16b_bf16 v[148:151], a[108:109], a[108:109], v[148:151]
    v_mfma_f32_4x4x4_16b_bf16 v[152:155], v[218:219], v[104:105], v[152:155]
    v_mfma_f32_4x4x4_16b_bf16 v[156:159], v[218:219], v[108:109], v[156:159]
    v_mfma_f32_4x4x4_16b_bf16 v[144:147], v[218:219], a[110:111], v[144:147]
    v_mfma_f32_4x4x4_16b_bf16 v[148:151], a[110:111], a[110:111], v[148:151]
    v_mfma_f32_4x4x4_16b_bf16 v[152:155], v[218:219], v[106:107], v[152:155]
    v_mfma_f32_4x4x4_16b_bf16 v[156:159], v[218:219], v[110:111], v[156:159]
    s_waitcnt lgkmcnt(2)
    v_mfma_f32_32x32x16_bf16 v[112:127], v[80:83], a[112:115], v[112:127]
    buffer_load_dwordx4 v1, s[8:11], s60 offen offset:1024 sc1 lds
    ds_read_b128 a[116:119], v213 offset:12288
    ds_read_b64_tr_b16 v[88:89], v6 offset:59392
    ds_read_b64_tr_b16 v[90:91], v6 offset:59648
    s_waitcnt lgkmcnt(3)
    v_mfma_f32_32x32x16_bf16 v[128:143], v[84:87], a[112:115], v[128:143]
    buffer_load_dwordx4 v1, s[8:11], s60 offen offset:2048 sc1 lds
    ds_read_b64_tr_b16 v[92:93], v6 offset:60416
    ds_read_b64_tr_b16 v[94:95], v6 offset:60672
    ds_read_b128 a[208:211], v33 offset:57344
    v_mfma_f32_4x4x4_16b_bf16 v[144:147], v[218:219], a[112:113], v[144:147]
    v_mfma_f32_4x4x4_16b_bf16 v[148:151], a[112:113], a[112:113], v[148:151]
    v_mfma_f32_4x4x4_16b_bf16 v[152:155], v[218:219], v[80:81], v[152:155]
    v_mfma_f32_4x4x4_16b_bf16 v[156:159], v[218:219], v[84:85], v[156:159]
    v_mfma_f32_4x4x4_16b_bf16 v[144:147], v[218:219], a[114:115], v[144:147]
    v_mfma_f32_4x4x4_16b_bf16 v[148:151], a[114:115], a[114:115], v[148:151]
    v_mfma_f32_4x4x4_16b_bf16 v[152:155], v[218:219], v[82:83], v[152:155]
    v_mfma_f32_4x4x4_16b_bf16 v[156:159], v[218:219], v[86:87], v[156:159]
    s_waitcnt lgkmcnt(3)
    v_mfma_f32_32x32x16_bf16 v[112:127], v[88:91], a[116:119], v[112:127]
    buffer_load_dwordx4 v1, s[8:11], s60 offen offset:3072 sc1 lds
    ds_read_b128 a[120:123], v214 offset:12288
    ds_read_b64_tr_b16 v[96:97], v6 offset:61440
    ds_read_b64_tr_b16 v[98:99], v6 offset:61696
    s_add_u32 m0, s56, 16384
    s_add_u32 s60, s64, 16384
    s_waitcnt lgkmcnt(4)
    v_mfma_f32_32x32x16_bf16 v[128:143], v[92:95], a[116:119], v[128:143]
    buffer_load_dwordx4 v1, s[8:11], s60 offen sc1 lds
    ds_read_b64_tr_b16 v[100:101], v6 offset:62464
    ds_read_b64_tr_b16 v[102:103], v6 offset:62720
    v_mfma_f32_4x4x4_16b_bf16 v[144:147], v[218:219], a[116:117], v[144:147]
    v_mfma_f32_4x4x4_16b_bf16 v[148:151], a[116:117], a[116:117], v[148:151]
    v_mfma_f32_4x4x4_16b_bf16 v[152:155], v[218:219], v[88:89], v[152:155]
    v_mfma_f32_4x4x4_16b_bf16 v[156:159], v[218:219], v[92:93], v[156:159]
    v_mfma_f32_4x4x4_16b_bf16 v[144:147], v[218:219], a[118:119], v[144:147]
    v_mfma_f32_4x4x4_16b_bf16 v[148:151], a[118:119], a[118:119], v[148:151]
    v_mfma_f32_4x4x4_16b_bf16 v[152:155], v[218:219], v[90:91], v[152:155]
    v_mfma_f32_4x4x4_16b_bf16 v[156:159], v[218:219], v[94:95], v[156:159]
    s_waitcnt lgkmcnt(2)
    v_mfma_f32_32x32x16_bf16 v[112:127], v[96:99], a[120:123], v[112:127]
    buffer_load_dwordx4 v1, s[8:11], s60 offen offset:1024 sc1 lds
    ds_read_b128 a[124:127], v215 offset:12288
    ds_read_b64_tr_b16 v[104:105], v6 offset:63488
    ds_read_b64_tr_b16 v[106:107], v6 offset:63744
    s_waitcnt lgkmcnt(3)
    v_mfma_f32_32x32x16_bf16 v[128:143], v[100:103], a[120:123], v[128:143]
    buffer_load_dwordx4 v1, s[8:11], s60 offen offset:2048 sc1 lds
    ds_read_b64_tr_b16 v[108:109], v6 offset:64512
    ds_read_b64_tr_b16 v[110:111], v6 offset:64768
    ds_read_b128 a[212:215], v33 offset:61440
    v_mfma_f32_4x4x4_16b_bf16 v[144:147], v[218:219], a[120:121], v[144:147]
    v_mfma_f32_4x4x4_16b_bf16 v[148:151], a[120:121], a[120:121], v[148:151]
    v_mfma_f32_4x4x4_16b_bf16 v[152:155], v[218:219], v[96:97], v[152:155]
    v_mfma_f32_4x4x4_16b_bf16 v[156:159], v[218:219], v[100:101], v[156:159]
    v_mfma_f32_4x4x4_16b_bf16 v[144:147], v[218:219], a[122:123], v[144:147]
    v_mfma_f32_4x4x4_16b_bf16 v[148:151], a[122:123], a[122:123], v[148:151]
    v_mfma_f32_4x4x4_16b_bf16 v[152:155], v[218:219], v[98:99], v[152:155]
    v_mfma_f32_4x4x4_16b_bf16 v[156:159], v[218:219], v[102:103], v[156:159]
    s_waitcnt lgkmcnt(3)
    buffer_load_dwordx4 v1, s[8:11], s60 offen offset:3072 sc1 lds
    s_waitcnt lgkmcnt(1)
    v_mfma_f32_4x4x4_16b_bf16 v[144:147], v[218:219], a[124:125], v[144:147]
    v_mfma_f32_4x4x4_16b_bf16 v[148:151], a[124:125], a[124:125], v[148:151]
    v_mfma_f32_4x4x4_16b_bf16 v[152:155], v[218:219], v[104:105], v[152:155]
    v_mfma_f32_4x4x4_16b_bf16 v[156:159], v[218:219], v[108:109], v[156:159]
    v_mfma_f32_4x4x4_16b_bf16 v[144:147], v[218:219], a[126:127], v[144:147]
    v_mfma_f32_4x4x4_16b_bf16 v[148:151], a[126:127], a[126:127], v[148:151]
    v_mfma_f32_4x4x4_16b_bf16 v[152:155], v[218:219], v[106:107], v[152:155]
    v_mfma_f32_4x4x4_16b_bf16 v[156:159], v[218:219], v[110:111], v[156:159]
    v_mfma_f32_32x32x16_bf16 v[112:127], v[104:107], a[124:127], v[112:127]
    s_mov_b32 vcc_lo, 0xaaaaaaaa
    s_mov_b32 vcc_hi, 0xaaaaaaaa
    s_mov_b32 s48, 0xcccccccc
    s_mov_b32 s49, 0xcccccccc
    v_mov_b32 v176, v144
    v_cndmask_b32 v148, v148, v149, vcc
    v_cndmask_b32 v150, v150, v151, vcc
    v_cndmask_b32 v177, v148, v150, s[48:49]
    v_mfma_f32_32x32x16_bf16 v[128:143], v[108:111], a[124:127], v[128:143]
    v_cvt_pk_bf16_f32 v153, v152, v152
    v_and_b32 v153, 0xffff0000, v153
    v_sub_f32 v153, v152, v153
    v_cvt_pk_bf16_f32 v152, v152, v153
    v_accvgpr_write_b32 a136, v152
    v_permlane32_swap_b32 v176, v177
    v_add_f32 v176, v176, v177
    v_mul_f32 v176, 0x3b000000, v176
    v_mov_b32 v177, v176
    s_nop 1
    v_permlane32_swap_b32 v176, v177
    v_fma_f32 v177, -v176, v176, v177
    v_max_f32 v177, 0, v177
    v_add_f32 v38, 0x3727c5ac, v177
    v_rsq_f32 v32, v38
    v_cvt_pk_bf16_f32 v40, -v176, -v176
    v_mov_b32 v45, v40
    v_mul_f32 v34, 0x3fb8aa3b, v32
    v_mfma_f32_32x32x16_bf16 v[112:127], a[136:139], v[40:43], v[112:127]
    v_cvt_pk_bf16_f32 v157, v156, v156
    v_and_b32 v157, 0xffff0000, v157
    v_sub_f32 v157, v156, v157
    v_cvt_pk_bf16_f32 v156, v156, v157
    v_accvgpr_write_b32 a137, v156
    s_waitcnt lgkmcnt(0)
    s_barrier
    v_mfma_f32_32x32x16_bf16 v[128:143], a[134:137], v[42:45], v[128:143]
    ds_write_b64 v217, v[218:219]
    s_nop 2
    v_cvt_pk_bf16_f32 v80, v112, v113
    s_sub_u32 s91, s64, s56
    s_add_u32 s60, s91, 98304
    buffer_load_dwordx4 a[248:251], v33, s[8:11], s60 offen sc1
    v_cvt_pk_bf16_f32 v81, v114, v115
    v_cvt_pk_bf16_f32 v82, v116, v117
    v_cvt_pk_bf16_f32 v83, v118, v119
    v_cvt_pk_bf16_f32 v84, v120, v121
    v_cvt_pk_bf16_f32 v85, v122, v123
    v_mfma_f32_32x32x16_bf16 v[144:159], a[128:131], v[80:83], 0
    v_cvt_pk_bf16_f32 v86, v124, v125
    v_cvt_pk_bf16_f32 v87, v126, v127
    v_mul_f32 v128, v32, v128
    v_mul_f32 v129, v32, v129
    v_mul_f32 v130, v32, v130
    v_mul_f32 v131, v32, v131
    v_mfma_f32_32x32x16_bf16 v[160:175], a[132:135], v[84:87], 0
    s_add_u32 s60, s91, 102400
    buffer_load_dwordx4 a[252:255], v33, s[8:11], s60 offen sc1
    v_mul_f32 v132, v32, v132
    v_mul_f32 v133, v32, v133
    v_mul_f32 v134, v32, v134
    v_mul_f32_e64 v135, v32, v135
    v_cvt_pk_bf16_f32 v88, v128, v129
    v_cvt_pk_bf16_f32 v89, v130, v131
    v_cvt_pk_bf16_f32 v90, v132, v133
    v_cvt_pk_bf16_f32 v91, v134, v135
    ds_write_b128 v9, v[88:91] offset:16384
    v_pk_mul_f32 v[136:137], v[136:137], v[32:33] op_sel_hi:[1,0]
    v_pk_mul_f32 v[138:139], v[138:139], v[32:33] op_sel_hi:[1,0]
    v_pk_mul_f32 v[140:141], v[140:141], v[32:33] op_sel_hi:[1,0]
    v_pk_mul_f32 v[142:143], v[142:143], v[32:33] op_sel_hi:[1,0]
    v_cvt_pk_bf16_f32 v92, v136, v137
    v_cvt_pk_bf16_f32 v93, v138, v139
    s_add_u32 s60, s91, 106496
    buffer_load_dwordx4 v[224:227], v33, s[8:11], s60 offen sc1
    v_cvt_pk_bf16_f32 v94, v140, v141
    v_cvt_pk_bf16_f32 v95, v142, v143
    ds_write_b128 v10, v[92:95] offset:16384
    v_max3_f32 v208, v144, v145, v146
    v_max3_f32 v208, v208, v147, v148
    v_max3_f32 v208, v208, v149, v150
    v_max3_f32 v208, v208, v151, v152
    v_max3_f32 v208, v208, v153, v154
    v_max3_f32 v208, v208, v155, v156
    v_max3_f32 v208, v208, v157, v158
    v_max_f32_e64 v208, v208, v159
    v_mul_f32 v208, -v208, v34
    v_pk_fma_f32 v[144:145], v[144:145], v[34:35], v[208:209] op_sel_hi:[1,0,0]
    v_pk_fma_f32 v[146:147], v[146:147], v[34:35], v[208:209] op_sel_hi:[1,0,0]
    v_pk_fma_f32 v[148:149], v[148:149], v[34:35], v[208:209] op_sel_hi:[1,0,0]
    v_pk_fma_f32 v[150:151], v[150:151], v[34:35], v[208:209] op_sel_hi:[1,0,0]
    s_add_u32 s60, s91, 110592
    buffer_load_dwordx4 v[228:231], v33, s[8:11], s60 offen sc1
    v_pk_fma_f32 v[152:153], v[152:153], v[34:35], v[208:209] op_sel_hi:[1,0,0]
    v_pk_fma_f32 v[154:155], v[154:155], v[34:35], v[208:209] op_sel_hi:[1,0,0]
    v_pk_fma_f32 v[156:157], v[156:157], v[34:35], v[208:209] op_sel_hi:[1,0,0]
    v_pk_fma_f32 v[158:159], v[158:159], v[34:35], v[208:209] op_sel_hi:[1,0,0]
    v_exp_f32 v144, v144
    v_exp_f32 v145, v145
    v_exp_f32 v146, v146
    v_exp_f32 v147, v147
    v_exp_f32 v148, v148
    v_exp_f32 v149, v149
    s_add_u32 s60, s91, 114688
    buffer_load_dwordx4 v[232:235], v33, s[8:11], s60 offen sc1
    v_exp_f32 v150, v150
    v_exp_f32 v151, v151
    v_exp_f32 v152, v152
    v_exp_f32 v153, v153
    v_exp_f32 v154, v154
    v_exp_f32 v155, v155
    v_exp_f32 v156, v156
    v_exp_f32 v157, v157
    s_add_u32 s60, s91, 118784
    buffer_load_dwordx4 v[236:239], v33, s[8:11], s60 offen sc1
    v_exp_f32 v158, v158
    v_exp_f32 v159, v159
    v_pk_add_f32 v[210:211], v[144:145], v[146:147]
    v_pk_add_f32 v[210:211], v[210:211], v[148:149]
    v_pk_add_f32 v[210:211], v[210:211], v[150:151]
    v_pk_add_f32 v[210:211], v[210:211], v[152:153]
    v_pk_add_f32 v[210:211], v[210:211], v[154:155]
    v_pk_add_f32 v[210:211], v[210:211], v[156:157]
    v_pk_add_f32 v[210:211], v[210:211], v[158:159]
    v_add_f32 v210, v210, v211
    v_rcp_f32_e64 v210, v210
    s_nop 0
    v_pk_mul_f32 v[144:145], v[144:145], v[210:211] op_sel_hi:[1,0]
    v_pk_mul_f32 v[146:147], v[146:147], v[210:211] op_sel_hi:[1,0]
    s_add_u32 s60, s91, 122880
    buffer_load_dwordx4 v[240:243], v33, s[8:11], s60 offen sc1
    v_pk_mul_f32 v[148:149], v[148:149], v[210:211] op_sel_hi:[1,0]
    v_pk_mul_f32 v[150:151], v[150:151], v[210:211] op_sel_hi:[1,0]
    v_cvt_pk_bf16_f32 v64, v144, v145
    v_cvt_pk_bf16_f32 v65, v146, v147
    v_cvt_pk_bf16_f32 v66, v148, v149
    v_cvt_pk_bf16_f32 v67, v150, v151
    ds_write_b128 v7, v[64:67] offset:0
    v_pk_mul_f32 v[152:153], v[152:153], v[210:211] op_sel_hi:[1,0]
    v_pk_mul_f32 v[154:155], v[154:155], v[210:211] op_sel_hi:[1,0]
    v_pk_mul_f32 v[156:157], v[156:157], v[210:211] op_sel_hi:[1,0]
    v_pk_mul_f32 v[158:159], v[158:159], v[210:211] op_sel_hi:[1,0]
    v_cvt_pk_bf16_f32 v68, v152, v153
    v_cvt_pk_bf16_f32 v69, v154, v155
    v_cvt_pk_bf16_f32 v70, v156, v157
    v_cvt_pk_bf16_f32 v71, v158, v159
    ds_write_b128 v8, v[68:71] offset:0
    s_add_u32 s60, s91, 126976
    buffer_load_dwordx4 v[244:247], v33, s[8:11], s60 offen sc1
    v_max3_f32 v208, v160, v161, v162
    v_max3_f32 v208, v208, v163, v164
    v_max3_f32 v208, v208, v165, v166
    v_max3_f32 v208, v208, v167, v168
    v_max3_f32 v208, v208, v169, v170
    v_max3_f32 v208, v208, v171, v172
    v_max3_f32 v208, v208, v173, v174
    v_max_f32_e64 v208, v208, v175
    v_mul_f32 v208, -v208, v34
    v_pk_fma_f32 v[160:161], v[160:161], v[34:35], v[208:209] op_sel_hi:[1,0,0]
    v_pk_fma_f32 v[162:163], v[162:163], v[34:35], v[208:209] op_sel_hi:[1,0,0]
    v_pk_fma_f32 v[164:165], v[164:165], v[34:35], v[208:209] op_sel_hi:[1,0,0]
    v_pk_fma_f32 v[166:167], v[166:167], v[34:35], v[208:209] op_sel_hi:[1,0,0]
    v_pk_fma_f32 v[168:169], v[168:169], v[34:35], v[208:209] op_sel_hi:[1,0,0]
    v_pk_fma_f32 v[170:171], v[170:171], v[34:35], v[208:209] op_sel_hi:[1,0,0]
    v_pk_fma_f32 v[172:173], v[172:173], v[34:35], v[208:209] op_sel_hi:[1,0,0]
    v_pk_fma_f32 v[174:175], v[174:175], v[34:35], v[208:209] op_sel_hi:[1,0,0]
    v_exp_f32 v160, v160
    v_exp_f32 v161, v161
    v_exp_f32 v162, v162
    v_exp_f32 v163, v163
    v_exp_f32 v164, v164
    v_exp_f32 v165, v165
    v_exp_f32 v166, v166
    v_exp_f32 v167, v167
    v_exp_f32 v168, v168
    v_exp_f32 v169, v169
    v_exp_f32 v170, v170
    v_exp_f32 v171, v171
    v_exp_f32 v172, v172
    v_exp_f32 v173, v173
    v_exp_f32 v174, v174
    v_exp_f32 v175, v175
    v_pk_add_f32 v[210:211], v[160:161], v[162:163]
    v_pk_add_f32 v[210:211], v[210:211], v[164:165]
    v_pk_add_f32 v[210:211], v[210:211], v[166:167]
    v_pk_add_f32 v[210:211], v[210:211], v[168:169]
    v_pk_add_f32 v[210:211], v[210:211], v[170:171]
    v_pk_add_f32 v[210:211], v[210:211], v[172:173]
    v_pk_add_f32 v[210:211], v[210:211], v[174:175]
    v_add_f32 v210, v210, v211
    v_rcp_f32_e64 v210, v210
    s_nop 0
    v_pk_mul_f32 v[160:161], v[160:161], v[210:211] op_sel_hi:[1,0]
    v_pk_mul_f32 v[162:163], v[162:163], v[210:211] op_sel_hi:[1,0]
    v_pk_mul_f32 v[164:165], v[164:165], v[210:211] op_sel_hi:[1,0]
    v_pk_mul_f32 v[166:167], v[166:167], v[210:211] op_sel_hi:[1,0]
    v_cvt_pk_bf16_f32 v72, v160, v161
    v_cvt_pk_bf16_f32 v73, v162, v163
    v_cvt_pk_bf16_f32 v74, v164, v165
    v_cvt_pk_bf16_f32 v75, v166, v167
    ds_write_b128 v7, v[72:75] offset:8192
    v_pk_mul_f32 v[168:169], v[168:169], v[210:211] op_sel_hi:[1,0]
    v_pk_mul_f32 v[170:171], v[170:171], v[210:211] op_sel_hi:[1,0]
    v_pk_mul_f32 v[172:173], v[172:173], v[210:211] op_sel_hi:[1,0]
    v_pk_mul_f32 v[174:175], v[174:175], v[210:211] op_sel_hi:[1,0]
    v_cvt_pk_bf16_f32 v76, v168, v169
    v_cvt_pk_bf16_f32 v77, v170, v171
    v_cvt_pk_bf16_f32 v78, v172, v173
    v_cvt_pk_bf16_f32 v79, v174, v175
    ds_write_b128 v8, v[76:79] offset:8192
    s_waitcnt vmcnt(16) lgkmcnt(0)
    s_barrier
    s_cmp_ge_u32 s52, 2
    s_cbranch_scc1 L_nokv_15
    ds_read_b64_tr_b16 v[80:81], v11 offset:0
    ds_read_b64_tr_b16 v[82:83], v12 offset:0
    ds_read_b64_tr_b16 v[144:145], v192
    ds_read_b64_tr_b16 v[146:147], v193
    ds_read_b64_tr_b16 v[84:85], v11 offset:1024
    ds_read_b64_tr_b16 v[86:87], v12 offset:1024
    ds_read_b64_tr_b16 v[148:149], v194
    ds_read_b64_tr_b16 v[150:151], v195
    ds_read_b64_tr_b16 v[88:89], v11 offset:2048
    ds_read_b64_tr_b16 v[90:91], v12 offset:2048
    ds_read_b64_tr_b16 v[152:153], v196
    ds_read_b64_tr_b16 v[154:155], v197
    s_waitcnt lgkmcnt(8)
    v_mfma_f32_32x32x16_bf16 v[112:127], v[80:83], v[144:147], 0
    ds_read_b64_tr_b16 v[92:93], v11 offset:3072
    ds_read_b64_tr_b16 v[94:95], v12 offset:3072
    ds_read_b64_tr_b16 v[156:157], v198
    ds_read_b64_tr_b16 v[158:159], v199
    s_waitcnt lgkmcnt(8)
    v_mfma_f32_32x32x16_bf16 v[112:127], v[84:87], v[148:151], v[112:127]
    ds_read_b64_tr_b16 v[96:97], v11 offset:4096
    ds_read_b64_tr_b16 v[98:99], v12 offset:4096
    ds_read_b64_tr_b16 v[160:161], v200
    ds_read_b64_tr_b16 v[162:163], v201
    s_waitcnt lgkmcnt(8)
    v_mfma_f32_32x32x16_bf16 v[112:127], v[88:91], v[152:155], v[112:127]
    ds_read_b64_tr_b16 v[100:101], v11 offset:5120
    ds_read_b64_tr_b16 v[102:103], v12 offset:5120
    ds_read_b64_tr_b16 v[164:165], v202
    ds_read_b64_tr_b16 v[166:167], v203
    s_waitcnt lgkmcnt(8)
    v_mfma_f32_32x32x16_bf16 v[112:127], v[92:95], v[156:159], v[112:127]
    ds_read_b64_tr_b16 v[104:105], v11 offset:6144
    ds_read_b64_tr_b16 v[106:107], v12 offset:6144
    ds_read_b64_tr_b16 v[168:169], v204
    ds_read_b64_tr_b16 v[170:171], v205
    s_waitcnt lgkmcnt(8)
    v_mfma_f32_32x32x16_bf16 v[112:127], v[96:99], v[160:163], v[112:127]
    ds_read_b64_tr_b16 v[108:109], v11 offset:7168
    ds_read_b64_tr_b16 v[110:111], v12 offset:7168
    ds_read_b64_tr_b16 v[172:173], v206
    ds_read_b64_tr_b16 v[174:175], v207
    s_waitcnt lgkmcnt(8)
    v_mfma_f32_32x32x16_bf16 v[112:127], v[100:103], v[164:167], v[112:127]
    s_waitcnt lgkmcnt(4)
    v_mfma_f32_32x32x16_bf16 v[112:127], v[104:107], v[168:171], v[112:127]
    s_waitcnt lgkmcnt(0)
    v_mfma_f32_32x32x16_bf16 v[112:127], v[108:111], v[172:175], v[112:127]
    s_lshl_b32 s57, s51, 1
    s_add_u32 s57, s57, s52
    s_lshl_b32 s57, s57, 5
    s_add_u32 s57, s57, s50
    s_mul_i32 s57, s57, 640
    s_add_u32 s59, s57, 262144
    s_add_u32 s58, s57, 272384
    s_mov_b32 s48, 0x1ffff
    s_mov_b32 s49, 0x1ffff
    s_nop 2
    v_cvt_pk_bf16_f32 v128, v112, v113
    v_cvt_pk_bf16_f32 v129, v114, v115
    v_cvt_pk_bf16_f32 v130, v116, v117
    v_cvt_pk_bf16_f32 v131, v118, v119
    v_min_u32 v128, -2, v128
    v_min_u32 v129, -2, v129
    v_min_u32 v130, -2, v130
    v_min_u32 v131, -2, v131
    s_mov_b64 exec, s[48:49]
    buffer_store_dwordx4 v[128:131], v16, s[8:11], s59 offen sc1
    s_mov_b64 exec, -1
    v_cvt_pk_bf16_f32 v132, v120, v121
    v_cvt_pk_bf16_f32 v133, v122, v123
    v_cvt_pk_bf16_f32 v134, v124, v125
    v_cvt_pk_bf16_f32 v135, v126, v127
    v_min_u32 v132, -2, v132
    v_min_u32 v133, -2, v133
    v_min_u32 v134, -2, v134
    v_min_u32 v135, -2, v135
    s_mov_b64 exec, s[48:49]
    buffer_store_dwordx4 v[132:135], v16, s[8:11], s58 offen sc1
    s_mov_b64 exec, -1
    s_branch L_kvdone_16
L_nokv_15:
    s_lshl_b32 s57, s56, 2
    s_add_u32 s57, s57, 32768
    v_add_u32_e64 v178, s57, v1
    s_lshl_b32 s57, s52, 2
    s_add_u32 s57, s57, 123896
    v_lshl_add_u32 v179, v4, 1, s57
    ds_read_b128 v[112:115], v178 offset:0
    ds_read_b128 v[116:119], v178 offset:1024
    ds_read_b128 v[120:123], v178 offset:2048
    ds_read_b128 v[124:127], v178 offset:3072
    ds_read_b128 v[128:131], v178 offset:4096
    ds_read_b128 v[132:135], v178 offset:5120
    ds_read_b128 v[136:139], v178 offset:6144
    ds_read_b128 v[140:143], v178 offset:7168
    ds_read_b128 v[144:147], v178 offset:8192
    ds_read_b128 v[148:151], v178 offset:9216
    ds_read_b128 v[152:155], v178 offset:10240
    ds_read_b128 v[156:159], v178 offset:11264
    ds_read_b128 v[160:163], v178 offset:12288
    ds_read_b128 v[164:167], v178 offset:13312
    ds_read_b128 v[168:171], v178 offset:14336
    ds_read_b128 v[172:175], v178 offset:15360
    s_waitcnt lgkmcnt(12)
    v_mfma_f32_4x4x4_16b_bf16 v[80:83], v[218:219], v[112:113], 0
    v_mfma_f32_4x4x4_16b_bf16 v[84:87], v[218:219], v[114:115], 0
    v_mfma_f32_4x4x4_16b_bf16 v[88:91], v[218:219], v[116:117], 0
    v_mfma_f32_4x4x4_16b_bf16 v[92:95], v[218:219], v[118:119], 0
    v_mfma_f32_4x4x4_16b_bf16 v[80:83], v[218:219], v[120:121], v[80:83]
    v_mfma_f32_4x4x4_16b_bf16 v[84:87], v[218:219], v[122:123], v[84:87]
    v_mfma_f32_4x4x4_16b_bf16 v[88:91], v[218:219], v[124:125], v[88:91]
L_page_1:
    s_cbranch_execz L_page_5
    v_mfma_f32_4x4x4_16b_bf16 v[92:95], v[218:219], v[126:127], v[92:95]
    s_waitcnt lgkmcnt(8)
    v_mfma_f32_4x4x4_16b_bf16 v[80:83], v[218:219], v[128:129], v[80:83]
    v_mfma_f32_4x4x4_16b_bf16 v[84:87], v[218:219], v[130:131], v[84:87]
    v_mfma_f32_4x4x4_16b_bf16 v[88:91], v[218:219], v[132:133], v[88:91]
    v_mfma_f32_4x4x4_16b_bf16 v[92:95], v[218:219], v[134:135], v[92:95]
    v_mfma_f32_4x4x4_16b_bf16 v[80:83], v[218:219], v[136:137], v[80:83]
    v_mfma_f32_4x4x4_16b_bf16 v[84:87], v[218:219], v[138:139], v[84:87]
    v_mfma_f32_4x4x4_16b_bf16 v[88:91], v[218:219], v[140:141], v[88:91]
    v_mfma_f32_4x4x4_16b_bf16 v[92:95], v[218:219], v[142:143], v[92:95]
    s_waitcnt lgkmcnt(4)
    v_mfma_f32_4x4x4_16b_bf16 v[80:83], v[218:219], v[144:145], v[80:83]
    v_mfma_f32_4x4x4_16b_bf16 v[84:87], v[218:219], v[146:147], v[84:87]
    v_mfma_f32_4x4x4_16b_bf16 v[88:91], v[218:219], v[148:149], v[88:91]
    v_mfma_f32_4x4x4_16b_bf16 v[92:95], v[218:219], v[150:151], v[92:95]
    v_mfma_f32_4x4x4_16b_bf16 v[80:83], v[218:219], v[152:153], v[80:83]
    v_mfma_f32_4x4x4_16b_bf16 v[84:87], v[218:219], v[154:155], v[84:87]
    v_mfma_f32_4x4x4_16b_bf16 v[88:91], v[218:219], v[156:157], v[88:91]
    v_mfma_f32_4x4x4_16b_bf16 v[92:95], v[218:219], v[158:159], v[92:95]
    s_waitcnt lgkmcnt(0)
    v_mfma_f32_4x4x4_16b_bf16 v[80:83], v[218:219], v[160:161], v[80:83]
    v_mfma_f32_4x4x4_16b_bf16 v[84:87], v[218:219], v[162:163], v[84:87]
    v_mfma_f32_4x4x4_16b_bf16 v[88:91], v[218:219], v[164:165], v[88:91]
    v_mfma_f32_4x4x4_16b_bf16 v[92:95], v[218:219], v[166:167], v[92:95]
    v_mfma_f32_4x4x4_16b_bf16 v[80:83], v[218:219], v[168:169], v[80:83]
    v_mfma_f32_4x4x4_16b_bf16 v[84:87], v[218:219], v[170:171], v[84:87]
    v_mfma_f32_4x4x4_16b_bf16 v[88:91], v[218:219], v[172:173], v[88:91]
    v_mfma_f32_4x4x4_16b_bf16 v[92:95], v[218:219], v[174:175], v[92:95]
    s_nop 3
    v_add_f32 v80, v80, v84
    s_nop 0
    v_add_f32 v88, v88, v92
    v_add_f32 v80, v80, v88
    v_cvt_pk_bf16_f32 v81, v80, v80
    v_and_b32 v81, 0xffff0000, v81
    v_sub_f32 v81, v80, v81
    v_cvt_pk_bf16_f32 v80, v80, v81
    ds_write_b32 v179, v80
    s_waitcnt lgkmcnt(0)
L_kvdone_16:
    s_barrier
    v_lshlrev_b32 v209, 1, v4
    v_add_u32 v209, 123904, v209
    ds_read_b64 v[210:211], v209
    s_lshl_b32 s57, s51, 2
    s_add_u32 s57, s57, s52
    s_mul_i32 s57, s57, 10240
    s_add_u32 s89, s57, 262144
    ds_read_b128 v[80:83], v2 offset:0
    ds_read_b128 v[84:87], v2 offset:1024
    ds_read_b128 v[88:91], v2 offset:2048
    ds_read_b128 v[92:95], v2 offset:3072
    ds_read_b128 v[96:99], v2 offset:4096
    ds_read_b128 v[100:103], v2 offset:5120
    ds_read_b128 v[104:107], v2 offset:6144
    s_waitcnt lgkmcnt(3)
    v_mfma_f32_32x32x16_bf16 v[112:127], v[80:83], a[0:3], 0
    ds_read_b128 v[108:111], v2 offset:7168
    ds_read_b128 a[216:219], v35 offset:0
    s_add_u32 m0, s56, 131072
    s_add_u32 s60, s62, 0
    v_mov_b32 v212, v48
    v_mov_b32 v213, v49
    v_mov_b32 v214, v50
    v_mov_b32 v215, v51
    v_mfma_f32_32x32x16_bf16 v[112:127], v[84:87], a[4:7], v[112:127]
    buffer_load_dwordx4 v1, s[8:11], s60 offen sc1 lds
    ds_read_b128 v[80:83], v2 offset:8192
    ds_read_b128 a[220:223], v35 offset:4096
    v_mov_b32 v220, v52
    v_mfma_f32_32x32x16_bf16 v[112:127], v[88:91], a[8:11], v[112:127]
    buffer_load_dwordx4 v1, s[8:11], s60 offen offset:1024 sc1 lds
    ds_read_b128 v[84:87], v2 offset:9216
    ds_read_b128 a[224:227], v35 offset:8192
    v_mov_b32 v221, v53
    v_mfma_f32_32x32x16_bf16 v[112:127], v[92:95], a[12:15], v[112:127]
    buffer_load_dwordx4 v1, s[8:11], s60 offen offset:2048 sc1 lds
    ds_read_b128 v[88:91], v2 offset:10240
    ds_read_b128 a[228:231], v35 offset:12288
    s_waitcnt lgkmcnt(7)
    v_mfma_f32_32x32x16_bf16 v[112:127], v[96:99], a[16:19], v[112:127]
    buffer_load_dwordx4 v1, s[8:11], s60 offen offset:3072 sc1 lds
    ds_read_b128 v[92:95], v2 offset:11264
    ds_read_b128 a[232:235], v35 offset:16384
    s_add_u32 m0, s56, 147456
    s_add_u32 s60, s62, 16384
    v_mfma_f32_32x32x16_bf16 v[112:127], v[100:103], a[20:23], v[112:127]
    buffer_load_dwordx4 v1, s[8:11], s60 offen sc1 lds
    ds_read_b128 v[96:99], v2 offset:12288
    ds_read_b128 a[236:239], v35 offset:20480
    v_mov_b32 v222, v54
    v_mfma_f32_32x32x16_bf16 v[112:127], v[104:107], a[24:27], v[112:127]
    buffer_load_dwordx4 v1, s[8:11], s60 offen offset:1024 sc1 lds
    ds_read_b128 v[100:103], v2 offset:13312
    ds_read_b128 a[240:243], v35 offset:24576
    v_mov_b32 v223, v55
    v_mfma_f32_32x32x16_bf16 v[112:127], v[108:111], a[28:31], v[112:127]
    buffer_load_dwordx4 v1, s[8:11], s60 offen offset:2048 sc1 lds
    ds_read_b128 v[104:107], v2 offset:14336
    ds_read_b128 a[244:247], v35 offset:28672
    s_waitcnt lgkmcnt(7)
    v_mfma_f32_32x32x16_bf16 v[112:127], v[80:83], a[32:35], v[112:127]
    buffer_load_dwordx4 v1, s[8:11], s60 offen offset:3072 sc1 lds
    ds_read_b128 v[108:111], v2 offset:15360
    s_add_u32 m0, s56, 32768
    s_add_u32 s60, s64, 32768
    v_mfma_f32_32x32x16_bf16 v[112:127], v[84:87], a[36:39], v[112:127]
    buffer_load_dwordx4 v1, s[8:11], s60 offen sc1 lds
    ds_read_b128 v[80:83], v2 offset:16384
    v_mfma_f32_32x32x16_bf16 v[112:127], v[88:91], a[40:43], v[112:127]
    buffer_load_dwordx4 v1, s[8:11], s60 offen offset:1024 sc1 lds
    ds_read_b128 v[84:87], v2 offset:17408
    v_mfma_f32_32x32x16_bf16 v[112:127], v[92:95], a[44:47], v[112:127]
    buffer_load_dwordx4 v1, s[8:11], s60 offen offset:2048 sc1 lds
    ds_read_b128 v[88:91], v2 offset:18432
    v_lshlrev_b32 v208, 16, v210
    v_and_b32 v210, 0xffff0000, v210
    v_add_f32 v208, v208, v210
    v_lshlrev_b32 v210, 16, v211
    v_and_b32 v211, 0xffff0000, v211
    v_add_f32 v210, v210, v211
    v_add_f32 v208, v208, v210
    v_cvt_pk_bf16_f32 v210, v208, v208
    v_and_b32 v210, 0xffff0000, v210
    v_sub_f32 v210, v208, v210
    v_cvt_pk_bf16_f32 v208, v208, v210
    v_accvgpr_write_b32 a138, v208
    s_waitcnt lgkmcnt(3)
    v_mfma_f32_32x32x16_bf16 v[112:127], v[96:99], a[48:51], v[112:127]
    buffer_load_dwordx4 v1, s[8:11], s60 offen offset:3072 sc1 lds
    ds_read_b128 v[92:95], v2 offset:19456
    s_add_u32 m0, s56, 49152
    s_add_u32 s60, s64, 49152
    v_mfma_f32_32x32x16_bf16 v[112:127], v[100:103], a[52:55], v[112:127]
    buffer_load_dwordx4 v1, s[8:11], s60 offen sc1 lds
    ds_read_b128 v[96:99], v2 offset:20480
    v_mfma_f32_32x32x16_bf16 v[112:127], v[104:107], a[56:59], v[112:127]
    buffer_load_dwordx4 v1, s[8:11], s60 offen offset:1024 sc1 lds
    ds_read_b128 v[100:103], v2 offset:21504
    v_mfma_f32_32x32x16_bf16 v[112:127], v[108:111], a[60:63], v[112:127]
    buffer_load_dwordx4 v1, s[8:11], s60 offen offset:2048 sc1 lds
    ds_read_b128 v[104:107], v2 offset:22528
    s_waitcnt lgkmcnt(3)
    v_mfma_f32_32x32x16_bf16 v[112:127], v[80:83], a[64:67], v[112:127]
    buffer_load_dwordx4 v1, s[8:11], s60 offen offset:3072 sc1 lds
    ds_read_b128 v[108:111], v2 offset:23552
    v_mfma_f32_32x32x16_bf16 v[112:127], v[84:87], a[68:71], v[112:127]
    buffer_load_dword v21, v5, s[8:11], s81 offen sc1
    ds_read_b128 v[80:83], v2 offset:24576
    v_mfma_f32_32x32x16_bf16 v[112:127], v[88:91], a[72:75], v[112:127]
    buffer_load_dword v21, v5, s[8:11], s83 offen sc1
    ds_read_b128 v[84:87], v2 offset:25600
    v_mfma_f32_32x32x16_bf16 v[112:127], v[92:95], a[76:79], v[112:127]
    ds_read_b128 v[88:91], v2 offset:26624
    s_waitcnt lgkmcnt(3)
    v_mfma_f32_32x32x16_bf16 v[112:127], v[96:99], a[80:83], v[112:127]
    ds_read_b128 v[92:95], v2 offset:27648
    v_mfma_f32_32x32x16_bf16 v[112:127], v[100:103], a[84:87], v[112:127]
    ds_read_b128 v[96:99], v2 offset:28672
    v_mfma_f32_32x32x16_bf16 v[112:127], v[104:107], a[88:91], v[112:127]
    s_add_u32 s57, s50, 2
    s_and_b32 s57, s57, 14
    s_mul_i32 s57, s57, 640
    s_add_u32 s59, s57, s89
    buffer_load_dwordx4 v[128:131], v16, s[8:11], s59 offen offset:0 sc1
    ds_read_b128 v[100:103], v2 offset:29696
    v_mfma_f32_32x32x16_bf16 v[112:127], v[108:111], a[92:95], v[112:127]
    buffer_load_dwordx4 v[132:135], v16, s[8:11], s59 offen offset:640 sc1
    ds_read_b128 v[104:107], v2 offset:30720
    s_add_u32 s57, s50, 4
    s_and_b32 s57, s57, 14
    s_mul_i32 s57, s57, 640
    s_add_u32 s59, s57, s89
    s_waitcnt lgkmcnt(3)
    v_mfma_f32_32x32x16_bf16 v[112:127], v[80:83], a[96:99], v[112:127]
    buffer_load_dwordx4 v[136:139], v16, s[8:11], s59 offen offset:0 sc1
    ds_read_b128 v[108:111], v2 offset:31744
    v_mfma_f32_32x32x16_bf16 v[112:127], v[84:87], a[100:103], v[112:127]
    buffer_load_dwordx4 v[140:143], v16, s[8:11], s59 offen offset:640 sc1
    s_add_u32 s57, s50, 6
    s_and_b32 s57, s57, 14
    s_mul_i32 s57, s57, 640
    s_add_u32 s59, s57, s89
    v_mfma_f32_32x32x16_bf16 v[112:127], v[88:91], a[104:107], v[112:127]
    buffer_load_dwordx4 v[176:179], v16, s[8:11], s59 offen offset:0 sc1
    v_mfma_f32_32x32x16_bf16 v[112:127], v[92:95], a[108:111], v[112:127]
    buffer_load_dwordx4 v[180:183], v16, s[8:11], s59 offen offset:640 sc1
    s_add_u32 s57, s50, 8
    s_and_b32 s57, s57, 14
    s_mul_i32 s57, s57, 640
    s_add_u32 s59, s57, s89
    s_waitcnt lgkmcnt(0)
    v_mfma_f32_32x32x16_bf16 v[112:127], v[96:99], a[112:115], v[112:127]
    buffer_load_dwordx4 v[184:187], v16, s[8:11], s59 offen offset:0 sc1
    v_mfma_f32_32x32x16_bf16 v[112:127], v[100:103], a[116:119], v[112:127]
    buffer_load_dwordx4 v[188:191], v16, s[8:11], s59 offen offset:640 sc1
    s_add_u32 s57, s50, 10
    s_and_b32 s57, s57, 14
    s_mul_i32 s57, s57, 640
    s_add_u32 s59, s57, s89
    v_mfma_f32_32x32x16_bf16 v[112:127], v[104:107], a[120:123], v[112:127]
    buffer_load_dwordx4 v[192:195], v16, s[8:11], s59 offen offset:0 sc1
    v_mfma_f32_32x32x16_bf16 v[112:127], v[108:111], a[124:127], v[112:127]
    buffer_load_dwordx4 v[196:199], v16, s[8:11], s59 offen offset:640 sc1
    s_add_u32 s57, s50, 12
    s_and_b32 s57, s57, 14
    s_mul_i32 s57, s57, 640
    s_add_u32 s59, s57, s89
    s_barrier
    v_mfma_f32_32x32x16_bf16 v[112:127], a[138:141], v[40:43], v[112:127]
    buffer_load_dwordx4 v[200:203], v16, s[8:11], s59 offen offset:0 sc1
    s_nop 10
    v_cvt_pk_bf16_f32 v80, v112, v113
    buffer_load_dwordx4 v[204:207], v16, s[8:11], s59 offen offset:640 sc1
    v_cvt_pk_bf16_f32 v81, v114, v115
    v_cvt_pk_bf16_f32 v82, v116, v117
    v_cvt_pk_bf16_f32 v83, v118, v119
    v_cvt_pk_bf16_f32 v84, v120, v121
    v_cvt_pk_bf16_f32 v85, v122, v123
    v_mfma_f32_32x32x16_bf16 v[144:159], a[128:131], v[80:83], 0
    v_cvt_pk_bf16_f32 v86, v124, v125
    v_cvt_pk_bf16_f32 v87, v126, v127
    s_add_u32 s57, s50, 14
    s_and_b32 s57, s57, 14
    s_mul_i32 s57, s57, 640
    s_add_u32 s59, s57, s89
    buffer_load_dwordx4 v[48:51], v16, s[8:11], s59 offen offset:0 sc1
    v_mfma_f32_32x32x16_bf16 v[160:175], a[132:135], v[84:87], 0
    s_nop 3
    v_max3_f32 v208, v144, v145, v146
    v_max3_f32 v208, v208, v147, v148
    v_max3_f32 v208, v208, v149, v150
    buffer_load_dwordx4 v[52:55], v16, s[8:11], s59 offen offset:640 sc1
    v_max3_f32 v208, v208, v151, v152
    v_max3_f32 v208, v208, v153, v154
    v_max3_f32 v208, v208, v155, v156
    v_max3_f32 v208, v208, v157, v158
    v_max_f32 v208, v208, v159
    v_mul_f32 v208, -v208, v34
    v_pk_fma_f32 v[144:145], v[144:145], v[34:35], v[208:209] op_sel_hi:[1,0,0]
    v_pk_fma_f32 v[146:147], v[146:147], v[34:35], v[208:209] op_sel_hi:[1,0,0]
    v_pk_fma_f32 v[148:149], v[148:149], v[34:35], v[208:209] op_sel_hi:[1,0,0]
    v_pk_fma_f32 v[150:151], v[150:151], v[34:35], v[208:209] op_sel_hi:[1,0,0]
    s_add_u32 s57, s50, 16
    s_and_b32 s57, s57, 14
    s_mul_i32 s57, s57, 640
    s_add_u32 s59, s57, s89
    buffer_load_dwordx4 v[56:59], v16, s[8:11], s59 offen offset:0 sc1
    v_pk_fma_f32 v[152:153], v[152:153], v[34:35], v[208:209] op_sel_hi:[1,0,0]
    v_pk_fma_f32 v[154:155], v[154:155], v[34:35], v[208:209] op_sel_hi:[1,0,0]
    v_pk_fma_f32 v[156:157], v[156:157], v[34:35], v[208:209] op_sel_hi:[1,0,0]
    v_pk_fma_f32 v[158:159], v[158:159], v[34:35], v[208:209] op_sel_hi:[1,0,0]
    v_exp_f32 v144, v144
    buffer_load_dwordx4 v[60:63], v16, s[8:11], s59 offen offset:640 sc1
    v_exp_f32 v145, v145
    v_exp_f32 v146, v146
    v_exp_f32 v147, v147
    v_exp_f32 v148, v148
    v_exp_f32 v149, v149
    v_exp_f32 v150, v150
    v_exp_f32 v151, v151
    v_exp_f32 v152, v152
    v_exp_f32 v153, v153
    v_exp_f32 v154, v154
    v_exp_f32 v155, v155
    v_exp_f32 v156, v156
    v_exp_f32 v157, v157
    v_exp_f32 v158, v158
    v_exp_f32_e64 v159, v159
    v_pk_add_f32 v[210:211], v[144:145], v[146:147]
    v_pk_add_f32 v[210:211], v[210:211], v[148:149]
    v_pk_add_f32 v[210:211], v[210:211], v[150:151]
    v_pk_add_f32 v[210:211], v[210:211], v[152:153]
    v_pk_add_f32 v[210:211], v[210:211], v[154:155]
    v_pk_add_f32 v[210:211], v[210:211], v[156:157]
    v_pk_add_f32 v[210:211], v[210:211], v[158:159]
    v_add_f32 v210, v210, v211
    v_rcp_f32_e64 v210, v210
    s_nop 0
    v_pk_mul_f32 v[144:145], v[144:145], v[210:211] op_sel_hi:[1,0]
    v_pk_mul_f32 v[146:147], v[146:147], v[210:211] op_sel_hi:[1,0]
    v_pk_mul_f32 v[148:149], v[148:149], v[210:211] op_sel_hi:[1,0]
    v_pk_mul_f32 v[150:151], v[150:151], v[210:211] op_sel_hi:[1,0]
    v_cvt_pk_bf16_f32 v64, v144, v145
    v_cvt_pk_bf16_f32 v65, v146, v147
    v_cvt_pk_bf16_f32 v66, v148, v149
    v_cvt_pk_bf16_f32 v67, v150, v151
    v_pk_mul_f32 v[152:153], v[152:153], v[210:211] op_sel_hi:[1,0]
    v_pk_mul_f32 v[154:155], v[154:155], v[210:211] op_sel_hi:[1,0]
    v_pk_mul_f32 v[156:157], v[156:157], v[210:211] op_sel_hi:[1,0]
    v_pk_mul_f32 v[158:159], v[158:159], v[210:211] op_sel_hi:[1,0]
    v_cvt_pk_bf16_f32 v68, v152, v153
    v_cvt_pk_bf16_f32 v69, v154, v155
    v_cvt_pk_bf16_f32 v70, v156, v157
    v_cvt_pk_bf16_f32 v71, v158, v159
    v_max3_f32 v208, v160, v161, v162
    v_max3_f32 v208, v208, v163, v164
    v_max3_f32 v208, v208, v165, v166
    v_max3_f32 v208, v208, v167, v168
    v_max3_f32 v208, v208, v169, v170
    v_max3_f32 v208, v208, v171, v172
    v_max3_f32 v208, v208, v173, v174
    v_max_f32_e64 v208, v208, v175
    v_mul_f32 v208, -v208, v34
    v_pk_fma_f32 v[160:161], v[160:161], v[34:35], v[208:209] op_sel_hi:[1,0,0]
    v_pk_fma_f32 v[162:163], v[162:163], v[34:35], v[208:209] op_sel_hi:[1,0,0]
    v_pk_fma_f32 v[164:165], v[164:165], v[34:35], v[208:209] op_sel_hi:[1,0,0]
    v_pk_fma_f32 v[166:167], v[166:167], v[34:35], v[208:209] op_sel_hi:[1,0,0]
    v_pk_fma_f32 v[168:169], v[168:169], v[34:35], v[208:209] op_sel_hi:[1,0,0]
    v_pk_fma_f32 v[170:171], v[170:171], v[34:35], v[208:209] op_sel_hi:[1,0,0]
    v_pk_fma_f32 v[172:173], v[172:173], v[34:35], v[208:209] op_sel_hi:[1,0,0]
    v_pk_fma_f32 v[174:175], v[174:175], v[34:35], v[208:209] op_sel_hi:[1,0,0]
    v_exp_f32 v160, v160
    v_exp_f32 v161, v161
    v_exp_f32 v162, v162
    v_exp_f32 v163, v163
    v_exp_f32 v164, v164
    v_exp_f32 v165, v165
    v_exp_f32 v166, v166
    v_exp_f32 v167, v167
    v_exp_f32 v168, v168
    v_exp_f32 v169, v169
    v_exp_f32 v170, v170
    v_exp_f32 v171, v171
    v_exp_f32 v172, v172
    v_exp_f32 v173, v173
    v_exp_f32 v174, v174
    v_exp_f32 v175, v175
    v_pk_add_f32 v[210:211], v[160:161], v[162:163]
    v_pk_add_f32 v[210:211], v[210:211], v[164:165]
    v_pk_add_f32 v[210:211], v[210:211], v[166:167]
    v_pk_add_f32 v[210:211], v[210:211], v[168:169]
    v_pk_add_f32 v[210:211], v[210:211], v[170:171]
    v_pk_add_f32 v[210:211], v[210:211], v[172:173]
    v_pk_add_f32 v[210:211], v[210:211], v[174:175]
    v_add_f32 v210, v210, v211
    v_rcp_f32_e64 v210, v210
    s_nop 0
    v_pk_mul_f32 v[160:161], v[160:161], v[210:211] op_sel_hi:[1,0]
    v_pk_mul_f32 v[162:163], v[162:163], v[210:211] op_sel_hi:[1,0]
    v_pk_mul_f32 v[164:165], v[164:165], v[210:211] op_sel_hi:[1,0]
    v_pk_mul_f32 v[166:167], v[166:167], v[210:211] op_sel_hi:[1,0]
    v_cvt_pk_bf16_f32 v72, v160, v161
    v_cvt_pk_bf16_f32 v73, v162, v163
    v_cvt_pk_bf16_f32 v74, v164, v165
    v_cvt_pk_bf16_f32 v75, v166, v167
    v_pk_mul_f32 v[168:169], v[168:169], v[210:211] op_sel_hi:[1,0]
    v_pk_mul_f32 v[170:171], v[170:171], v[210:211] op_sel_hi:[1,0]
    v_pk_mul_f32 v[172:173], v[172:173], v[210:211] op_sel_hi:[1,0]
    v_pk_mul_f32 v[174:175], v[174:175], v[210:211] op_sel_hi:[1,0]
    v_cvt_pk_bf16_f32 v76, v168, v169
    v_cvt_pk_bf16_f32 v77, v170, v171
    v_cvt_pk_bf16_f32 v78, v172, v173
    v_cvt_pk_bf16_f32 v79, v174, v175
    s_mul_i32 s93, s51, 7168
    s_lshl_b32 s94, s52, 11
    s_add_u32 s93, s93, s94
    s_add_u32 m0, s56, 98304
    s_add_u32 s60, s62, 32768
    s_waitcnt vmcnt(14)
    v_mfma_f32_32x32x16_bf16 v[112:127], a[148:151], v[128:131], 0
    buffer_load_dwordx4 v1, s[8:11], s60 offen sc1 lds
    v_mfma_f32_32x32x16_bf16 v[112:127], a[148:151], v[132:135], v[112:127]
    buffer_load_dwordx4 v1, s[8:11], s60 offen offset:1024 sc1 lds
    s_waitcnt vmcnt(14)
    v_mfma_f32_32x32x16_bf16 v[112:127], a[148:151], v[136:139], v[112:127]
    buffer_load_dwordx4 v1, s[8:11], s60 offen offset:2048 sc1 lds
    v_mfma_f32_32x32x16_bf16 v[112:127], a[148:151], v[140:143], v[112:127]
    buffer_load_dwordx4 v1, s[8:11], s60 offen offset:3072 sc1 lds
    s_add_u32 m0, s56, 114688
    s_add_u32 s60, s62, 49152
    s_waitcnt vmcnt(14)
    v_mfma_f32_32x32x16_bf16 v[112:127], a[148:151], v[176:179], v[112:127]
    buffer_load_dwordx4 v1, s[8:11], s60 offen sc1 lds
    v_mfma_f32_32x32x16_bf16 v[112:127], a[148:151], v[180:183], v[112:127]
    buffer_load_dwordx4 v1, s[8:11], s60 offen offset:1024 sc1 lds
    s_waitcnt vmcnt(14)
    v_mfma_f32_32x32x16_bf16 v[112:127], a[148:151], v[184:187], v[112:127]
    buffer_load_dwordx4 v1, s[8:11], s60 offen offset:2048 sc1 lds
    v_mfma_f32_32x32x16_bf16 v[112:127], a[148:151], v[188:191], v[112:127]
    buffer_load_dwordx4 v1, s[8:11], s60 offen offset:3072 sc1 lds
    s_add_u32 m0, s94, 73728
    s_add_u32 s60, s93, 65536
    s_waitcnt vmcnt(14)
    v_mfma_f32_32x32x16_bf16 v[112:127], a[148:151], v[192:195], v[112:127]
    buffer_load_dwordx4 v1, s[8:11], s60 offen sc1 lds
    v_mfma_f32_32x32x16_bf16 v[112:127], a[148:151], v[196:199], v[112:127]
    buffer_load_dwordx4 v1, s[8:11], s60 offen offset:1024 sc1 lds
    s_waitcnt vmcnt(14)
    v_mfma_f32_32x32x16_bf16 v[112:127], a[148:151], v[200:203], v[112:127]
    v_mfma_f32_32x32x16_bf16 v[112:127], a[148:151], v[204:207], v[112:127]
    s_waitcnt vmcnt(12)
    v_mfma_f32_32x32x16_bf16 v[112:127], a[148:151], v[48:51], v[112:127]
    v_mfma_f32_32x32x16_bf16 v[112:127], a[148:151], v[52:55], v[112:127]
    s_waitcnt vmcnt(10)
    v_mfma_f32_32x32x16_bf16 v[112:127], a[148:151], v[56:59], v[112:127]
    v_mfma_f32_32x32x16_bf16 v[112:127], a[148:151], v[60:63], v[112:127]
    s_nop 11
    v_cmp_u_f32 vcc, v112, v112
    v_cvt_pk_bf16_f32 v80, v112, v113
    v_cvt_pk_bf16_f32 v81, v114, v115
    v_cvt_pk_bf16_f32 v82, v116, v117
    v_cvt_pk_bf16_f32 v83, v118, v119
    s_cbranch_vccnz L_late_17_a
L_summed_18:
    ds_write_b128 v19, v[80:83]
    s_waitcnt lgkmcnt(0)
    s_barrier
    ds_read_b128 v[80:83], v2 offset:0
    ds_read_b128 v[84:87], v2 offset:1024
    ds_read_b128 v[88:91], v2 offset:2048
    ds_read_b128 v[92:95], v2 offset:3072
    s_add_u32 s68, s86, 0
    s_waitcnt lgkmcnt(2)
    v_mfma_f32_32x32x16_bf16 v[144:159], v[80:83], v[64:67], 0
    v_mfma_f32_32x32x16_bf16 v[144:159], v[84:87], v[68:71], v[144:159]
    s_waitcnt lgkmcnt(0)
    s_nop 2
    v_mfma_f32_32x32x16_bf16 v[160:175], v[88:91], v[72:75], 0
    s_nop 5
    v_mfma_f32_32x32x16_bf16 v[160:175], v[92:95], v[76:79], v[160:175]
    v_add_f32 v152, 0x358637bd, v152
    v_rcp_f32 v152, v152
    s_nop 0
    v_mul_f32 v144, v144, v152
    v_mul_f32 v145, v145, v152
    v_mul_f32 v146, v146, v152
    v_mul_f32 v147, v147, v152
    v_mul_f32 v148, v148, v152
    v_mul_f32 v149, v149, v152
    v_mul_f32 v150, v150, v152
    v_mul_f32 v151, v151, v152
    v_cvt_pk_bf16_f32 v96, v144, v145
    v_cvt_pk_bf16_f32 v97, v146, v147
    v_cvt_pk_bf16_f32 v98, v148, v149
    v_cvt_pk_bf16_f32 v99, v150, v151
    v_add_f32 v168, 0x358637bd, v168
    v_rcp_f32 v168, v168
    s_nop 0
    v_pk_mul_f32 v[160:161], v[160:161], v[168:169] op_sel_hi:[1,0]
    v_pk_mul_f32 v[162:163], v[162:163], v[168:169] op_sel_hi:[1,0]
    v_pk_mul_f32 v[164:165], v[164:165], v[168:169] op_sel_hi:[1,0]
    v_pk_mul_f32 v[166:167], v[166:167], v[168:169] op_sel_hi:[1,0]
    v_cvt_pk_bf16_f32 v100, v160, v161
    v_cvt_pk_bf16_f32 v101, v162, v163
    v_cvt_pk_bf16_f32 v102, v164, v165
    v_cvt_pk_bf16_f32 v103, v166, v167
    buffer_store_dwordx4 v[96:99], v1, s[4:7], s68 offen sc1
    buffer_store_dwordx4 v[100:103], v1, s[4:7], s68 offen offset:1024 sc1
    v_lshlrev_b32 v48, 16, v212
    v_and_b32 v49, 0xffff0000, v212
    v_lshlrev_b32 v50, 16, v213
    v_and_b32 v51, 0xffff0000, v213
    v_lshlrev_b32 v52, 16, v214
    v_and_b32 v53, 0xffff0000, v214
    v_lshlrev_b32 v54, 16, v215
    v_and_b32 v55, 0xffff0000, v215
    v_lshlrev_b32 v56, 16, v220
    v_and_b32 v57, 0xffff0000, v220
    v_lshlrev_b32 v58, 16, v221
    v_and_b32 v59, 0xffff0000, v221
    v_lshlrev_b32 v60, 16, v222
    v_and_b32 v61, 0xffff0000, v222
    v_lshlrev_b32 v62, 16, v223
    v_and_b32 v63, 0xffff0000, v223
    v_add_u32 v28, 1, v24
    s_mov_b64 exec, 1
    s_cmp_eq_u32 s53, 0
    s_cbranch_scc1 L_dev_35
    s_waitcnt vmcnt(0)
    buffer_store_dword v28, off, s[8:11], s82
L_sg_36:
    s_mov_b64 exec, -1
    s_barrier
    v_and_b32 v216, 124, v4
    v_and_b32 v217, 512, v1
    v_add_u32 v216, v216, v217
    v_add_u32 v216, 73728, v216
    ds_read2_b32 v[184:185], v216 offset0:0 offset1:32
    ds_read2_b32 v[186:187], v216 offset0:64 offset1:96
    v_add_u32 v216, 1024, v216
    ds_read2_b32 v[188:189], v216 offset0:0 offset1:32
    ds_read2_b32 v[190:191], v216 offset0:64 offset1:96
    v_add_u32 v216, 1024, v216
    ds_read2_b32 v[192:193], v216 offset0:0 offset1:32
    ds_read2_b32 v[194:195], v216 offset0:64 offset1:96
    v_add_u32 v216, 1024, v216
    ds_read2_b32 v[196:197], v216 offset0:0 offset1:32
    ds_read2_b32 v[198:199], v216 offset0:64 offset1:96
    v_add_u32 v216, 1024, v216
    ds_read2_b32 v[200:201], v216 offset0:0 offset1:32
    ds_read2_b32 v[202:203], v216 offset0:64 offset1:96
    v_add_u32 v216, 1024, v216
    ds_read2_b32 v[204:205], v216 offset0:0 offset1:32
    ds_read2_b32 v[206:207], v216 offset0:64 offset1:96
    v_add_u32 v216, 1024, v216
    ds_read2_b32 v[208:209], v216 offset0:0 offset1:32
    ds_read2_b32 v[210:211], v216 offset0:64 offset1:96
    v_add_u32 v216, 1024, v216
    s_waitcnt lgkmcnt(0)
    s_barrier
    s_lshl_b32 s58, s74, 14
    ds_read_b128 v[80:83], v22 offset:32768
    ds_read_b128 v[84:87], v23 offset:32768
    ds_read_b128 v[88:91], v22 offset:36864
    ds_read_b128 v[92:95], v23 offset:36864
    ds_read_b128 v[96:99], v22 offset:40960
    ds_read_b128 v[100:103], v23 offset:40960
    buffer_load_dword v30, v5, s[8:11], s85 offen sc1
    s_add_u32 s57, s44, 1
    s_add_u32 s59, s58, 0
L_poll_37:
    s_sub_u32 s54, s54, 1
    s_cbranch_scc1 L_abort
    buffer_load_dword v31, v5, s[8:11], s85 offen sc1
    s_waitcnt vmcnt(1)
    v_cmp_gt_u32 vcc, s57, v30
    s_nop 0
    s_cbranch_vccz L_done_38
    buffer_load_dword v30, v5, s[8:11], s85 offen sc1
    s_waitcnt vmcnt(1)
    v_cmp_gt_u32 vcc, s57, v31
    s_nop 0
    s_cbranch_vccnz L_poll_37
L_done_38:
    buffer_load_dwordx4 a[0:3], v1, s[4:7], s59 offen sc1
    buffer_load_dwordx4 a[4:7], v1, s[4:7], s59 offen offset:1024 sc1
    buffer_load_dwordx4 a[8:11], v1, s[4:7], s59 offen offset:2048 sc1
    buffer_load_dwordx4 a[12:15], v1, s[4:7], s59 offen offset:3072 sc1
    s_add_u32 s59, s58, 4096
    buffer_load_dwordx4 a[16:19], v1, s[4:7], s59 offen sc1
    buffer_load_dwordx4 a[20:23], v1, s[4:7], s59 offen offset:1024 sc1
    buffer_load_dwordx4 a[24:27], v1, s[4:7], s59 offen offset:2048 sc1
    buffer_load_dwordx4 a[28:31], v1, s[4:7], s59 offen offset:3072 sc1
    s_waitcnt vmcnt(7) lgkmcnt(4)
    v_mfma_f32_32x32x16_bf16 v[112:127], v[84:87], a[0:3], 0
    s_add_u32 s59, s58, 8192
    buffer_load_dwordx4 a[32:35], v1, s[4:7], s59 offen sc1
    ds_read_b128 v[104:107], v22 offset:45056
    v_mfma_f32_32x32x16_bf16 v[48:63], v[80:83], a[0:3], v[48:63]
    ds_read_b128 v[108:111], v23 offset:45056
    s_waitcnt vmcnt(7) lgkmcnt(4)
    v_mfma_f32_32x32x16_bf16 v[112:127], v[92:95], a[4:7], v[112:127]
    buffer_load_dwordx4 a[36:39], v1, s[4:7], s59 offen offset:1024 sc1
    ds_read_b128 v[80:83], v22 offset:49152
    v_mfma_f32_32x32x16_bf16 v[48:63], v[88:91], a[4:7], v[48:63]
    ds_read_b128 v[84:87], v23 offset:49152
    s_waitcnt vmcnt(7) lgkmcnt(4)
    v_mfma_f32_32x32x16_bf16 v[112:127], v[100:103], a[8:11], v[112:127]
    buffer_load_dwordx4 a[40:43], v1, s[4:7], s59 offen offset:2048 sc1
    ds_read_b128 v[88:91], v22 offset:53248
    v_mfma_f32_32x32x16_bf16 v[48:63], v[96:99], a[8:11], v[48:63]
    ds_read_b128 v[92:95], v23 offset:53248
    s_waitcnt vmcnt(7) lgkmcnt(4)
    v_mfma_f32_32x32x16_bf16 v[112:127], v[108:111], a[12:15], v[112:127]
    buffer_load_dwordx4 a[44:47], v1, s[4:7], s59 offen offset:3072 sc1
    ds_read_b128 v[96:99], v22 offset:57344
    v_mfma_f32_32x32x16_bf16 v[48:63], v[104:107], a[12:15], v[48:63]
    ds_read_b128 v[100:103], v23 offset:57344
    s_add_u32 s59, s58, 12288
    s_waitcnt vmcnt(7) lgkmcnt(4)
    v_mfma_f32_32x32x16_bf16 v[112:127], v[84:87], a[16:19], v[112:127]
    buffer_load_dwordx4 a[48:51], v1, s[4:7], s59 offen sc1
    ds_read_b128 v[104:107], v22 offset:61440
    v_mfma_f32_32x32x16_bf16 v[48:63], v[80:83], a[16:19], v[48:63]
    ds_read_b128 v[108:111], v23 offset:61440
    s_waitcnt vmcnt(7) lgkmcnt(4)
    v_mfma_f32_32x32x16_bf16 v[112:127], v[92:95], a[20:23], v[112:127]
    buffer_load_dwordx4 a[52:55], v1, s[4:7], s59 offen offset:1024 sc1
    ds_read_b128 v[80:83], v22 offset:0
    v_mfma_f32_32x32x16_bf16 v[48:63], v[88:91], a[20:23], v[48:63]
    ds_read_b128 v[84:87], v23 offset:0
    s_waitcnt vmcnt(7) lgkmcnt(4)
    v_mfma_f32_32x32x16_bf16 v[112:127], v[100:103], a[24:27], v[112:127]
    buffer_load_dwordx4 a[56:59], v1, s[4:7], s59 offen offset:2048 sc1
    ds_read_b128 v[88:91], v22 offset:4096
    v_mfma_f32_32x32x16_bf16 v[48:63], v[96:99], a[24:27], v[48:63]
    ds_read_b128 v[92:95], v23 offset:4096
    s_waitcnt vmcnt(7) lgkmcnt(4)
    v_mfma_f32_32x32x16_bf16 v[112:127], v[108:111], a[28:31], v[112:127]
    buffer_load_dwordx4 a[60:63], v1, s[4:7], s59 offen offset:3072 sc1
    ds_read_b128 v[96:99], v22 offset:8192
    v_mfma_f32_32x32x16_bf16 v[48:63], v[104:107], a[28:31], v[48:63]
    ds_read_b128 v[100:103], v23 offset:8192
    s_waitcnt vmcnt(7) lgkmcnt(4)
    s_getpc_b64 s[46:47]
L_pc_39:
    s_lshr_b32 s57, s2, 3
    s_lshl_b32 s57, s57, 11
    v_lshrrev_b32 v29, 4, v0
    v_lshl_add_u32 v29, v29, 7, s57
    v_min_u32 v29, L_code_end-L_pc_39-4, v29
    global_load_dword v21, v29, s[46:47]
    v_mfma_f32_32x32x16_bf16 v[112:127], v[84:87], a[32:35], v[112:127]
    ds_read_b128 v[104:107], v22 offset:12288
    s_add_u32 m0, s56, 65536
    s_add_u32 s60, s64, 65536
    v_mfma_f32_32x32x16_bf16 v[48:63], v[80:83], a[32:35], v[48:63]
    buffer_load_dwordx4 v1, s[8:11], s60 offen sc1 lds
    ds_read_b128 v[108:111], v23 offset:12288
L_page_2:
    s_cbranch_execz L_page_6
    s_waitcnt vmcnt(8) lgkmcnt(4)
    v_mfma_f32_32x32x16_bf16 v[112:127], v[92:95], a[36:39], v[112:127]
    ds_read_b128 v[80:83], v22 offset:16384
    v_mfma_f32_32x32x16_bf16 v[48:63], v[88:91], a[36:39], v[48:63]
    buffer_load_dwordx4 v1, s[8:11], s60 offen offset:1024 sc1 lds
    ds_read_b128 v[84:87], v23 offset:16384
    s_waitcnt vmcnt(8) lgkmcnt(4)
    v_mfma_f32_32x32x16_bf16 v[112:127], v[100:103], a[40:43], v[112:127]
    ds_read_b128 v[88:91], v22 offset:20480
    v_mfma_f32_32x32x16_bf16 v[48:63], v[96:99], a[40:43], v[48:63]
    buffer_load_dwordx4 v1, s[8:11], s60 offen offset:2048 sc1 lds
    ds_read_b128 v[92:95], v23 offset:20480
    s_waitcnt vmcnt(8) lgkmcnt(4)
    v_mfma_f32_32x32x16_bf16 v[112:127], v[108:111], a[44:47], v[112:127]
    ds_read_b128 v[96:99], v22 offset:24576
    v_mfma_f32_32x32x16_bf16 v[48:63], v[104:107], a[44:47], v[48:63]
    buffer_load_dwordx4 v1, s[8:11], s60 offen offset:3072 sc1 lds
    ds_read_b128 v[100:103], v23 offset:24576
    s_waitcnt vmcnt(8) lgkmcnt(4)
    v_mfma_f32_32x32x16_bf16 v[112:127], v[84:87], a[48:51], v[112:127]
    ds_read_b128 v[104:107], v22 offset:28672
    s_add_u32 m0, s56, 81920
    s_add_u32 s60, s64, 81920
    v_mfma_f32_32x32x16_bf16 v[48:63], v[80:83], a[48:51], v[48:63]
    buffer_load_dwordx4 v1, s[8:11], s60 offen sc1 lds
    ds_read_b128 v[108:111], v23 offset:28672
    s_waitcnt vmcnt(8) lgkmcnt(4)
    v_mfma_f32_32x32x16_bf16 v[112:127], v[92:95], a[52:55], v[112:127]
    buffer_load_dwordx4 v1, s[8:11], s60 offen offset:1024 sc1 lds
    s_waitcnt vmcnt(8) lgkmcnt(2)
    v_mfma_f32_32x32x16_bf16 v[112:127], v[100:103], a[56:59], v[112:127]
    buffer_load_dwordx4 v1, s[8:11], s60 offen offset:2048 sc1 lds
    s_waitcnt vmcnt(8) lgkmcnt(0)
    v_mfma_f32_32x32x16_bf16 v[112:127], v[108:111], a[60:63], v[112:127]
    buffer_load_dwordx4 v1, s[8:11], s60 offen offset:3072 sc1 lds
    s_nop 2
    v_mfma_f32_32x32x16_bf16 v[48:63], v[88:91], a[52:55], v[48:63]
    s_barrier
    s_nop 5
    v_cvt_pk_bf16_f32 v72, v112, v113
    v_cvt_pk_bf16_f32 v73, v114, v115
    v_cvt_pk_bf16_f32 v74, v116, v117
    v_cvt_pk_bf16_f32 v75, v118, v119
    ds_write_b128 v17, v[72:75] offset:0
    v_mfma_f32_32x32x16_bf16 v[48:63], v[96:99], a[56:59], v[48:63]
    v_cvt_pk_bf16_f32 v76, v120, v121
    v_cvt_pk_bf16_f32 v77, v122, v123
    v_cvt_pk_bf16_f32 v78, v124, v125
    v_cvt_pk_bf16_f32 v79, v126, v127
    ds_write_b128 v17, v[76:79] offset:1024
    v_mfma_f32_32x32x16_bf16 v[48:63], v[104:107], a[60:63], v[48:63]
    s_waitcnt lgkmcnt(0)
    s_barrier
    ds_read_b128 v[176:179], v18 offset:0
    ds_read_b128 v[180:183], v18 offset:1024
    s_add_u32 s68, s67, 131072
    s_waitcnt lgkmcnt(1)
    s_nop 5
    v_dot2_f32_bf16 v48, v176, s87, v48
    v_dot2_f32_bf16 v49, v176, s88, v49
    v_dot2_f32_bf16 v50, v177, s87, v50
    v_dot2_f32_bf16 v51, v177, s88, v51
    v_dot2_f32_bf16 v52, v178, s87, v52
    v_dot2_f32_bf16 v53, v178, s88, v53
    v_dot2_f32_bf16 v54, v179, s87, v54
    v_dot2_f32_bf16 v55, v179, s88, v55
    s_waitcnt lgkmcnt(0)
    v_dot2_f32_bf16 v56, v180, s87, v56
    v_dot2_f32_bf16 v57, v180, s88, v57
    v_dot2_f32_bf16 v58, v181, s87, v58
    v_dot2_f32_bf16 v59, v181, s88, v59
    v_dot2_f32_bf16 v60, v182, s87, v60
    v_dot2_f32_bf16 v61, v182, s88, v61
    v_dot2_f32_bf16 v62, v183, s87, v62
    v_dot2_f32_bf16 v63, v183, s88, v63
    v_cvt_pk_bf16_f32 v64, v48, v49
    v_cvt_pk_bf16_f32 v65, v50, v51
    v_cvt_pk_bf16_f32 v66, v52, v53
    v_cvt_pk_bf16_f32 v67, v54, v55
    v_cvt_pk_bf16_f32 v68, v56, v57
    v_cvt_pk_bf16_f32 v69, v58, v59
    v_cvt_pk_bf16_f32 v70, v60, v61
    v_cvt_pk_bf16_f32 v71, v62, v63
    buffer_store_dwordx4 v[64:67], v1, s[4:7], s68 offen sc1
    buffer_store_dwordx4 v[68:71], v1, s[4:7], s68 offen offset:1024 sc1
    v_dot2_f32_bf16 v176, v64, s71, 0
    v_dot2_f32_bf16 v177, v64, v64, 0
    v_dot2_f32_bf16 v176, v65, s71, v176
    v_dot2_f32_bf16 v177, v65, v65, v177
    v_dot2_f32_bf16 v176, v66, s71, v176
    v_dot2_f32_bf16 v177, v66, v66, v177
    v_dot2_f32_bf16 v176, v67, s71, v176
    v_dot2_f32_bf16 v177, v67, v67, v177
    v_dot2_f32_bf16 v176, v68, s71, v176
    v_dot2_f32_bf16 v177, v68, v68, v177
    v_dot2_f32_bf16 v176, v69, s71, v176
    v_dot2_f32_bf16 v177, v69, v69, v177
    v_dot2_f32_bf16 v176, v70, s71, v176
    v_dot2_f32_bf16 v177, v70, v70, v177
    v_dot2_f32_bf16 v176, v71, s71, v176
    v_dot2_f32_bf16 v177, v71, v71, v177
    s_nop 2
    v_permlane32_swap_b32 v176, v177
    v_add_f32_e64 v176, v176, v177
    buffer_store_dword v176, v39, s[4:7], s73 offen sc1
    v_dot2_f32_bf16 v128, v184, s71, 0
    v_dot2_f32_bf16 v129, v188, s71, 0
    v_dot2_f32_bf16 v130, v192, s71, 0
    v_dot2_f32_bf16 v131, v196, s71, 0
    v_dot2_f32_bf16 v132, v200, s71, 0
    v_dot2_f32_bf16 v133, v204, s71, 0
    v_dot2_f32_bf16 v134, v208, s71, 0
    v_dot2_f32_bf16 v128, v185, s71, v128
    v_dot2_f32_bf16 v129, v189, s71, v129
    v_dot2_f32_bf16 v130, v193, s71, v130
    v_dot2_f32_bf16 v131, v197, s71, v131
    v_dot2_f32_bf16 v132, v201, s71, v132
    v_dot2_f32_bf16 v133, v205, s71, v133
    v_dot2_f32_bf16 v134, v209, s71, v134
    v_dot2_f32_bf16 v128, v186, s71, v128
    v_dot2_f32_bf16 v129, v190, s71, v129
    v_dot2_f32_bf16 v130, v194, s71, v130
    v_dot2_f32_bf16 v131, v198, s71, v131
    v_dot2_f32_bf16 v132, v202, s71, v132
    v_dot2_f32_bf16 v133, v206, s71, v133
    v_dot2_f32_bf16 v134, v210, s71, v134
    v_dot2_f32_bf16 v128, v187, s71, v128
    v_dot2_f32_bf16 v129, v191, s71, v129
    v_dot2_f32_bf16 v130, v195, s71, v130
    v_dot2_f32_bf16 v131, v199, s71, v131
    v_dot2_f32_bf16 v132, v203, s71, v132
    v_dot2_f32_bf16 v133, v207, s71, v133
    v_dot2_f32_bf16 v134, v211, s71, v134
    v_cvt_pk_bf16_f32 v136, v128, v128
    v_and_b32 v136, 0xffff0000, v136
    v_sub_f32_e64 v136, v128, v136
    v_cvt_pk_bf16_f32 v128, v128, v136
    v_accvgpr_write_b32 a139, v128
    v_cvt_pk_bf16_f32 v137, v129, v129
    v_and_b32 v137, 0xffff0000, v137
    v_sub_f32_e64 v137, v129, v137
    v_cvt_pk_bf16_f32 v129, v129, v137
    v_accvgpr_write_b32 a140, v129
    v_cvt_pk_bf16_f32 v138, v130, v130
    v_and_b32 v138, 0xffff0000, v138
    v_sub_f32_e64 v138, v130, v138
    v_cvt_pk_bf16_f32 v130, v130, v138
    v_accvgpr_write_b32 a141, v130
    v_cvt_pk_bf16_f32 v139, v131, v131
    v_and_b32 v139, 0xffff0000, v139
    v_sub_f32_e64 v139, v131, v139
    v_cvt_pk_bf16_f32 v131, v131, v139
    v_accvgpr_write_b32 a142, v131
    v_cvt_pk_bf16_f32 v140, v132, v132
    v_and_b32 v140, 0xffff0000, v140
    v_sub_f32_e64 v140, v132, v140
    v_cvt_pk_bf16_f32 v132, v132, v140
    v_accvgpr_write_b32 a143, v132
    v_cvt_pk_bf16_f32 v141, v133, v133
    v_and_b32 v141, 0xffff0000, v141
    v_sub_f32_e64 v141, v133, v141
    v_cvt_pk_bf16_f32 v133, v133, v141
    v_accvgpr_write_b32 a144, v133
    v_cvt_pk_bf16_f32 v142, v134, v134
    v_and_b32 v142, 0xffff0000, v142
    v_sub_f32 v142, v134, v142
    v_cvt_pk_bf16_f32 v134, v134, v142
    v_accvgpr_write_b32 a145, v134
    v_add_u32 v28, 1, v24
    s_mov_b64 exec, 1
    s_cmp_eq_u32 s53, 0
    s_cbranch_scc1 L_dev_40
    s_waitcnt vmcnt(0)
    buffer_store_dword v28, off, s[8:11], s84
L_sg_41:
    s_mov_b64 exec, -1
    s_barrier
    s_lshl_b32 s75, s52, 17
    s_lshl_b32 s57, s51, 10
    s_add_u32 s75, s75, s57
    s_add_u32 s75, s75, 524288
    s_lshl_b32 s58, s52, 15
    s_add_u32 s58, s58, 131072
    s_lshl_b32 s69, s52, 12
    s_add_u32 s69, s69, 262144
    s_add_u32 s58, s79, 131072
    ds_read_b128 v[80:83], v1 offset:0
    ds_read_b128 v[84:87], v1 offset:32768
    ds_read_b128 v[88:91], v2 offset:0
    ds_read_b128 v[92:95], v1 offset:1024
    ds_read_b128 v[96:99], v1 offset:33792
    ds_read_b128 v[100:103], v2 offset:1024
    ds_read_b128 v[104:107], v1 offset:2048
    buffer_load_dword v30, v5, s[8:11], s83 offen sc1
    s_add_u32 s57, s44, 1
    s_xor_b32 s59, s58, 0
L_poll_42:
    s_sub_u32 s54, s54, 1
    s_cbranch_scc1 L_abort
    buffer_load_dword v31, v5, s[8:11], s83 offen sc1
    s_waitcnt vmcnt(1)
    v_cmp_gt_u32 vcc, s57, v30
    s_nop 0
    s_cbranch_vccz L_done_43
    buffer_load_dword v30, v5, s[8:11], s83 offen sc1
    s_waitcnt vmcnt(1)
    v_cmp_gt_u32 vcc, s57, v31
    s_nop 0
    s_cbranch_vccnz L_poll_42
L_done_43:
    buffer_load_dwordx4 a[0:3], v1, s[4:7], s59 offen offset:0 sc1
    buffer_load_dwordx4 a[4:7], v1, s[4:7], s59 offen offset:1024 sc1
    s_xor_b32 s59, s58, 2048
    buffer_load_dwordx4 a[8:11], v1, s[4:7], s59 offen offset:0 sc1
    buffer_load_dwordx4 a[12:15], v1, s[4:7], s59 offen offset:1024 sc1
    s_xor_b32 s59, s58, 4096
    buffer_load_dwordx4 a[16:19], v1, s[4:7], s59 offen offset:0 sc1
    buffer_load_dwordx4 a[20:23], v1, s[4:7], s59 offen offset:1024 sc1
    s_xor_b32 s59, s58, 6144
    buffer_load_dwordx4 a[24:27], v1, s[4:7], s59 offen offset:0 sc1
    buffer_load_dwordx4 a[28:31], v1, s[4:7], s59 offen offset:1024 sc1
    s_waitcnt vmcnt(7) lgkmcnt(3)
    v_mfma_f32_32x32x16_bf16 v[112:127], v[80:83], a[0:3], 0
    s_xor_b32 s59, s58, 8192
    buffer_load_dwordx4 a[32:35], v1, s[4:7], s59 offen offset:0 sc1
    ds_read_b128 v[108:111], v1 offset:34816
    v_mov_b32 v72, -1
    v_mov_b32 v73, -1
    v_mfma_f32_32x32x16_bf16 v[128:143], v[84:87], a[0:3], 0
    ds_read_b128 v[80:83], v2 offset:2048
    v_mov_b32 v74, -1
    v_mov_b32 v75, -1
    v_mfma_f32_32x32x16_bf16 v[144:159], v[88:91], a[0:3], 0
    ds_read_b128 v[84:87], v1 offset:3072
    s_waitcnt vmcnt(7)
    v_mfma_f32_32x32x16_bf16 v[112:127], v[92:95], a[4:7], v[112:127]
    buffer_load_dwordx4 a[36:39], v1, s[4:7], s59 offen offset:1024 sc1
    ds_read_b128 v[88:91], v1 offset:35840
    s_waitcnt lgkmcnt(3)
    v_mfma_f32_32x32x16_bf16 v[128:143], v[96:99], a[4:7], v[128:143]
    ds_read_b128 v[92:95], v2 offset:3072
    v_mfma_f32_32x32x16_bf16 v[144:159], v[100:103], a[4:7], v[144:159]
    ds_read_b128 v[96:99], v1 offset:4096
    s_xor_b32 s59, s58, 10240
    s_waitcnt vmcnt(7)
    v_mfma_f32_32x32x16_bf16 v[112:127], v[104:107], a[8:11], v[112:127]
    buffer_load_dwordx4 a[40:43], v1, s[4:7], s59 offen offset:0 sc1
    ds_read_b128 v[100:103], v1 offset:36864
    v_mfma_f32_32x32x16_bf16 v[128:143], v[108:111], a[8:11], v[128:143]
    ds_read_b128 v[104:107], v2 offset:4096
    v_accvgpr_read_b32 v64, a0
    v_accvgpr_read_b32 v65, a1
    v_accvgpr_read_b32 v66, a2
    v_accvgpr_read_b32 v67, a3
    v_accvgpr_read_b32 v68, a4
    v_accvgpr_read_b32 v69, a5
    s_waitcnt lgkmcnt(3)
    v_mfma_f32_32x32x16_bf16 v[144:159], v[80:83], a[8:11], v[144:159]
    ds_read_b128 v[108:111], v1 offset:5120
    v_accvgpr_read_b32 v70, a6
    v_accvgpr_read_b32 v71, a7
    v_lshlrev_b32 v48, 16, v64
    v_and_b32 v49, 0xffff0000, v64
    v_lshlrev_b32 v50, 16, v65
    v_and_b32 v51, 0xffff0000, v65
    s_waitcnt vmcnt(7)
    v_mfma_f32_32x32x16_bf16 v[112:127], v[84:87], a[12:15], v[112:127]
    buffer_load_dwordx4 a[44:47], v1, s[4:7], s59 offen offset:1024 sc1
    ds_read_b128 v[80:83], v1 offset:37888
    v_lshlrev_b32 v52, 16, v66
    v_and_b32 v53, 0xffff0000, v66
    v_mfma_f32_32x32x16_bf16 v[128:143], v[88:91], a[12:15], v[128:143]
    ds_read_b128 v[84:87], v2 offset:5120
    ds_write_b128 v35, a[248:251] offset:32768
    v_lshlrev_b32 v54, 16, v67
    v_and_b32 v55, 0xffff0000, v67
    v_lshlrev_b32 v56, 16, v68
    v_and_b32 v57, 0xffff0000, v68
    v_lshlrev_b32 v58, 16, v69
    v_and_b32 v59, 0xffff0000, v69
    v_mfma_f32_32x32x16_bf16 v[144:159], v[92:95], a[12:15], v[144:159]
    ds_read_b128 v[88:91], v1 offset:6144
    s_xor_b32 s59, s58, 12288
    v_lshlrev_b32 v60, 16, v70
    v_and_b32 v61, 0xffff0000, v70
    v_lshlrev_b32 v62, 16, v71
    v_and_b32 v63, 0xffff0000, v71
    s_waitcnt vmcnt(7) lgkmcnt(4)
    v_mfma_f32_32x32x16_bf16 v[112:127], v[96:99], a[16:19], v[112:127]
    buffer_load_dwordx4 a[48:51], v1, s[4:7], s59 offen offset:0 sc1
    ds_read_b128 v[92:95], v1 offset:38912
    v_mfma_f32_32x32x16_bf16 v[128:143], v[100:103], a[16:19], v[128:143]
    buffer_load_dwordx4 v[176:179], v1, s[4:7], s69 offen offset:0 sc1
    ds_read_b128 v[96:99], v2 offset:6144
    v_mfma_f32_32x32x16_bf16 v[144:159], v[104:107], a[16:19], v[144:159]
    ds_read_b128 v[100:103], v1 offset:7168
    s_waitcnt vmcnt(8)
    v_mfma_f32_32x32x16_bf16 v[112:127], v[108:111], a[20:23], v[112:127]
    buffer_load_dwordx4 a[52:55], v1, s[4:7], s59 offen offset:1024 sc1
    ds_read_b128 v[104:107], v1 offset:39936
    s_waitcnt lgkmcnt(3)
    v_mfma_f32_32x32x16_bf16 v[128:143], v[80:83], a[20:23], v[128:143]
    ds_read_b128 v[108:111], v2 offset:7168
    ds_write_b128 v35, a[252:255] offset:36864
    v_mfma_f32_32x32x16_bf16 v[144:159], v[84:87], a[20:23], v[144:159]
    ds_read_b128 v[80:83], v1 offset:8192
    s_xor_b32 s59, s58, 14336
    s_waitcnt vmcnt(8)
    v_mfma_f32_32x32x16_bf16 v[112:127], v[88:91], a[24:27], v[112:127]
    buffer_load_dwordx4 a[56:59], v1, s[4:7], s59 offen offset:0 sc1
    ds_read_b128 v[84:87], v1 offset:40960
    v_mfma_f32_32x32x16_bf16 v[128:143], v[92:95], a[24:27], v[128:143]
    ds_read_b128 v[88:91], v2 offset:8192
    s_waitcnt lgkmcnt(4)
    v_mfma_f32_32x32x16_bf16 v[144:159], v[96:99], a[24:27], v[144:159]
    ds_read_b128 v[92:95], v1 offset:9216
    s_waitcnt vmcnt(8)
    v_mfma_f32_32x32x16_bf16 v[112:127], v[100:103], a[28:31], v[112:127]
    buffer_load_dwordx4 a[60:63], v1, s[4:7], s59 offen offset:1024 sc1
    ds_read_b128 v[96:99], v1 offset:41984
    v_mfma_f32_32x32x16_bf16 v[128:143], v[104:107], a[28:31], v[128:143]
    buffer_load_dwordx4 v[180:183], v1, s[4:7], s69 offen offset:1024 sc1
    ds_read_b128 v[100:103], v2 offset:9216
    ds_write_b128 v35, v[224:227] offset:40960
    v_mfma_f32_32x32x16_bf16 v[144:159], v[108:111], a[28:31], v[144:159]
    ds_read_b128 v[104:107], v1 offset:10240
    s_xor_b32 s59, s58, 16384
    s_waitcnt vmcnt(9) lgkmcnt(4)
    v_mfma_f32_32x32x16_bf16 v[112:127], v[80:83], a[32:35], v[112:127]
    buffer_load_dwordx4 a[64:67], v1, s[4:7], s59 offen offset:0 sc1
    ds_read_b128 v[108:111], v1 offset:43008
    v_mfma_f32_32x32x16_bf16 v[128:143], v[84:87], a[32:35], v[128:143]
    ds_read_b128 v[80:83], v2 offset:10240
    v_mfma_f32_32x32x16_bf16 v[144:159], v[88:91], a[32:35], v[144:159]
    ds_read_b128 v[84:87], v1 offset:11264
    s_waitcnt vmcnt(9)
    v_mfma_f32_32x32x16_bf16 v[112:127], v[92:95], a[36:39], v[112:127]
    buffer_load_dwordx4 a[68:71], v1, s[4:7], s59 offen offset:1024 sc1
    ds_read_b128 v[88:91], v1 offset:44032
    s_waitcnt lgkmcnt(3)
    v_mfma_f32_32x32x16_bf16 v[128:143], v[96:99], a[36:39], v[128:143]
    ds_read_b128 v[92:95], v2 offset:11264
    ds_write_b128 v35, v[228:231] offset:45056
    v_mfma_f32_32x32x16_bf16 v[144:159], v[100:103], a[36:39], v[144:159]
    ds_read_b128 v[96:99], v1 offset:12288
    s_xor_b32 s59, s58, 18432
    s_waitcnt vmcnt(9)
    v_mfma_f32_32x32x16_bf16 v[112:127], v[104:107], a[40:43], v[112:127]
    buffer_load_dwordx4 a[72:75], v1, s[4:7], s59 offen offset:0 sc1
    ds_read_b128 v[100:103], v1 offset:45056
    v_mfma_f32_32x32x16_bf16 v[128:143], v[108:111], a[40:43], v[128:143]
    buffer_load_dwordx4 v[184:187], v1, s[4:7], s69 offen offset:2048 sc1
    ds_read_b128 v[104:107], v2 offset:12288
    s_add_u32 m0, s56, 131072
    s_add_u32 s60, s64, 131072
    s_waitcnt lgkmcnt(4)
    v_mfma_f32_32x32x16_bf16 v[144:159], v[80:83], a[40:43], v[144:159]
    buffer_load_dwordx4 v1, s[8:11], s60 offen sc1 lds
    ds_read_b128 v[108:111], v1 offset:13312
    s_waitcnt vmcnt(11)
    v_mfma_f32_32x32x16_bf16 v[112:127], v[84:87], a[44:47], v[112:127]
    buffer_load_dwordx4 a[76:79], v1, s[4:7], s59 offen offset:1024 sc1
    ds_read_b128 v[80:83], v1 offset:46080
    v_mfma_f32_32x32x16_bf16 v[128:143], v[88:91], a[44:47], v[128:143]
    ds_read_b128 v[84:87], v2 offset:13312
    ds_write_b128 v35, v[232:235] offset:49152
    v_mfma_f32_32x32x16_bf16 v[144:159], v[92:95], a[44:47], v[144:159]
    ds_read_b128 v[88:91], v1 offset:14336
    s_xor_b32 s59, s58, 20480
    s_waitcnt vmcnt(11) lgkmcnt(4)
    v_mfma_f32_32x32x16_bf16 v[112:127], v[96:99], a[48:51], v[112:127]
    buffer_load_dwordx4 a[80:83], v1, s[4:7], s59 offen offset:0 sc1
    ds_read_b128 v[92:95], v1 offset:47104
    v_mfma_f32_32x32x16_bf16 v[128:143], v[100:103], a[48:51], v[128:143]
    ds_read_b128 v[96:99], v2 offset:14336
    v_mfma_f32_32x32x16_bf16 v[144:159], v[104:107], a[48:51], v[144:159]
    ds_read_b128 v[100:103], v1 offset:15360
    s_waitcnt vmcnt(10)
    v_mfma_f32_32x32x16_bf16 v[112:127], v[108:111], a[52:55], v[112:127]
    buffer_load_dwordx4 a[84:87], v1, s[4:7], s59 offen offset:1024 sc1
    ds_read_b128 v[104:107], v1 offset:48128
    s_waitcnt lgkmcnt(3)
    v_mfma_f32_32x32x16_bf16 v[128:143], v[80:83], a[52:55], v[128:143]
    buffer_load_dwordx4 v[188:191], v1, s[4:7], s69 offen offset:3072 sc1
    ds_read_b128 v[108:111], v2 offset:15360
    ds_write_b128 v35, v[236:239] offset:53248
    v_mfma_f32_32x32x16_bf16 v[144:159], v[84:87], a[52:55], v[144:159]
    buffer_load_dwordx4 v1, s[8:11], s60 offen offset:1024 sc1 lds
    ds_read_b128 v[80:83], v1 offset:16384
    s_xor_b32 s59, s58, 22528
    s_waitcnt vmcnt(12)
    v_mfma_f32_32x32x16_bf16 v[112:127], v[88:91], a[56:59], v[112:127]
    buffer_load_dwordx4 a[88:91], v1, s[4:7], s59 offen offset:0 sc1
    ds_read_b128 v[84:87], v1 offset:49152
    v_mfma_f32_32x32x16_bf16 v[128:143], v[92:95], a[56:59], v[128:143]
    ds_read_b128 v[88:91], v2 offset:16384
    s_waitcnt lgkmcnt(4)
    v_mfma_f32_32x32x16_bf16 v[144:159], v[96:99], a[56:59], v[144:159]
    ds_read_b128 v[92:95], v1 offset:17408
    s_waitcnt vmcnt(12)
    v_mfma_f32_32x32x16_bf16 v[112:127], v[100:103], a[60:63], v[112:127]
    buffer_load_dwordx4 a[92:95], v1, s[4:7], s59 offen offset:1024 sc1
    ds_read_b128 v[96:99], v1 offset:50176
    v_mfma_f32_32x32x16_bf16 v[128:143], v[104:107], a[60:63], v[128:143]
    ds_read_b128 v[100:103], v2 offset:17408
    ds_write_b128 v35, v[240:243] offset:57344
    v_mfma_f32_32x32x16_bf16 v[144:159], v[108:111], a[60:63], v[144:159]
    ds_read_b128 v[104:107], v1 offset:18432
    s_xor_b32 s59, s58, 24576
    s_waitcnt vmcnt(11) lgkmcnt(4)
    v_mfma_f32_32x32x16_bf16 v[112:127], v[80:83], a[64:67], v[112:127]
    buffer_load_dwordx4 a[96:99], v1, s[4:7], s59 offen offset:0 sc1
    ds_read_b128 v[108:111], v1 offset:51200
    v_mfma_f32_32x32x16_bf16 v[128:143], v[84:87], a[64:67], v[128:143]
    buffer_load_dwordx4 v1, s[8:11], s60 offen offset:2048 sc1 lds
    ds_read_b128 v[80:83], v2 offset:18432
    v_mfma_f32_32x32x16_bf16 v[144:159], v[88:91], a[64:67], v[144:159]
    ds_read_b128 v[84:87], v1 offset:19456
    s_waitcnt vmcnt(12)
    v_mfma_f32_32x32x16_bf16 v[112:127], v[92:95], a[68:71], v[112:127]
    buffer_load_dwordx4 a[100:103], v1, s[4:7], s59 offen offset:1024 sc1
    ds_read_b128 v[88:91], v1 offset:52224
    s_waitcnt lgkmcnt(3)
    v_mfma_f32_32x32x16_bf16 v[128:143], v[96:99], a[68:71], v[128:143]
    ds_read_b128 v[92:95], v2 offset:19456
    ds_write_b128 v35, v[244:247] offset:61440
    v_mfma_f32_32x32x16_bf16 v[144:159], v[100:103], a[68:71], v[144:159]
    ds_read_b128 v[96:99], v1 offset:20480
    s_xor_b32 s59, s58, 26624
    s_waitcnt vmcnt(12)
    v_mfma_f32_32x32x16_bf16 v[112:127], v[104:107], a[72:75], v[112:127]
    buffer_load_dwordx4 a[104:107], v1, s[4:7], s59 offen offset:0 sc1
    ds_read_b128 v[100:103], v1 offset:53248
    v_mfma_f32_32x32x16_bf16 v[128:143], v[108:111], a[72:75], v[128:143]
    ds_read_b128 v[104:107], v2 offset:20480
    s_waitcnt lgkmcnt(4)
    v_mfma_f32_32x32x16_bf16 v[144:159], v[80:83], a[72:75], v[144:159]
    ds_read_b128 v[108:111], v1 offset:21504
    s_waitcnt vmcnt(10)
    v_mfma_f32_32x32x16_bf16 v[112:127], v[84:87], a[76:79], v[112:127]
    buffer_load_dwordx4 a[108:111], v1, s[4:7], s59 offen offset:1024 sc1
    ds_read_b128 v[80:83], v1 offset:54272
    v_mfma_f32_32x32x16_bf16 v[128:143], v[88:91], a[76:79], v[128:143]
    buffer_load_dwordx4 v1, s[8:11], s60 offen offset:3072 sc1 lds
    ds_read_b128 v[84:87], v2 offset:21504
    v_mfma_f32_32x32x16_bf16 v[144:159], v[92:95], a[76:79], v[144:159]
    ds_read_b128 v[88:91], v1 offset:22528
    s_xor_b32 s59, s58, 28672
    s_waitcnt vmcnt(11) lgkmcnt(3)
    v_mfma_f32_32x32x16_bf16 v[112:127], v[96:99], a[80:83], v[112:127]
    buffer_load_dwordx4 a[112:115], v1, s[4:7], s59 offen offset:0 sc1
    ds_read_b128 v[92:95], v1 offset:55296
    v_mfma_f32_32x32x16_bf16 v[128:143], v[100:103], a[80:83], v[128:143]
    ds_read_b128 v[96:99], v2 offset:22528
    v_mfma_f32_32x32x16_bf16 v[144:159], v[104:107], a[80:83], v[144:159]
    ds_read_b128 v[100:103], v1 offset:23552
    s_waitcnt vmcnt(11)
    v_mfma_f32_32x32x16_bf16 v[112:127], v[108:111], a[84:87], v[112:127]
    buffer_load_dwordx4 a[116:119], v1, s[4:7], s59 offen offset:1024 sc1
    ds_read_b128 v[104:107], v1 offset:56320
    s_waitcnt vmcnt(11)
    s_waitcnt lgkmcnt(3)
    v_mfma_f32_32x32x16_bf16 v[128:143], v[80:83], a[84:87], v[128:143]
    ds_read_b128 v[108:111], v2 offset:23552
    v_add_f32 v176, v176, v184
    v_add_f32 v177, v177, v185
    v_add_f32 v178, v178, v186
    v_add_f32 v179, v179, v187
    v_add_f32 v180, v180, v188
    v_add_f32 v181, v181, v189
    v_add_f32 v182, v182, v190
    v_mfma_f32_32x32x16_bf16 v[144:159], v[84:87], a[84:87], v[144:159]
    ds_read_b128 v[80:83], v1 offset:24576
    s_xor_b32 s59, s58, 30720
    v_add_f32 v183, v183, v191
    v_add_f32 v176, v176, v180
    v_add_f32 v177, v177, v181
    v_add_f32 v178, v178, v182
    v_add_f32 v179, v179, v183
    s_waitcnt vmcnt(9)
    v_mfma_f32_32x32x16_bf16 v[112:127], v[88:91], a[88:91], v[112:127]
    buffer_load_dwordx4 a[120:123], v1, s[4:7], s59 offen offset:0 sc1
    ds_read_b128 v[84:87], v1 offset:57344
    v_permlane32_swap_b32 v176, v178
    v_permlane32_swap_b32 v177, v179
    v_mfma_f32_32x32x16_bf16 v[128:143], v[92:95], a[88:91], v[128:143]
    ds_read_b128 v[88:91], v2 offset:24576
    s_add_u32 m0, s56, 147456
    s_add_u32 s60, s64, 147456
    v_add_f32 v176, v176, v178
    v_add_f32 v177, v177, v179
    s_waitcnt lgkmcnt(3)
    v_mfma_f32_32x32x16_bf16 v[144:159], v[96:99], a[88:91], v[144:159]
    buffer_load_dwordx4 v1, s[8:11], s60 offen sc1 lds
    ds_read_b128 v[92:95], v1 offset:25600
    v_permlane16_swap_b32 v176, v177
    s_waitcnt vmcnt(10)
    v_mfma_f32_32x32x16_bf16 v[112:127], v[100:103], a[92:95], v[112:127]
    buffer_load_dwordx4 a[124:127], v1, s[4:7], s59 offen offset:1024 sc1
    ds_read_b128 v[96:99], v1 offset:58368
    v_add_f32 v176, v176, v177
    v_mul_f32 v176, 0x3b000000, v176
    v_mfma_f32_32x32x16_bf16 v[128:143], v[104:107], a[92:95], v[128:143]
    buffer_load_dwordx4 v1, s[8:11], s60 offen offset:1024 sc1 lds
    ds_read_b128 v[100:103], v2 offset:25600
    v_mov_b32 v177, v176
    v_mfma_f32_32x32x16_bf16 v[144:159], v[108:111], a[92:95], v[144:159]
    ds_read_b128 v[104:107], v1 offset:26624
    v_permlane32_swap_b32 v176, v177
    v_fma_f32 v177, -v176, v176, v177
    v_max_f32 v177, 0, v177
    v_add_f32 v38, 0x3727c5ac, v177
    v_rsq_f32 v32, v38
    s_waitcnt vmcnt(11) lgkmcnt(3)
    v_mfma_f32_32x32x16_bf16 v[112:127], v[80:83], a[96:99], v[112:127]
    ds_read_b128 v[108:111], v1 offset:59392
    v_cvt_pk_bf16_f32 v40, -v176, -v176
    v_mov_b32 v45, v40
    v_mul_f32 v34, 0xc0135761, v32
    v_mul_f32 v178, v32, v32
    v_mul_f32 v178, 0x3d372713, v178
    v_mul_f32 v36, v178, v34
    s_add_u32 s68, s79, 0
    v_mfma_f32_32x32x16_bf16 v[128:143], v[84:87], a[96:99], v[128:143]
    buffer_load_dwordx4 v1, s[8:11], s60 offen offset:2048 sc1 lds
    ds_read_b128 v[80:83], v2 offset:26624
    v_mfma_f32_32x32x16_bf16 v[144:159], v[88:91], a[96:99], v[144:159]
    s_cmp_eq_u32 s53, 0
    s_cbranch_scc1 L_dev_44
    buffer_store_dwordx4 v[72:75], v1, s[4:7], s68 offen offset:0
L_st_45:
    ds_read_b128 v[84:87], v1 offset:27648
    s_waitcnt vmcnt(11)
    v_mfma_f32_32x32x16_bf16 v[112:127], v[92:95], a[100:103], v[112:127]
    s_cmp_eq_u32 s53, 0
    s_cbranch_scc1 L_dev_46
    buffer_store_dwordx4 v[72:75], v1, s[4:7], s68 offen offset:1024
L_st_47:
    ds_read_b128 v[88:91], v1 offset:60416
    s_waitcnt lgkmcnt(3)
    v_mfma_f32_32x32x16_bf16 v[128:143], v[96:99], a[100:103], v[128:143]
    buffer_load_dwordx4 v1, s[8:11], s60 offen offset:3072 sc1 lds
    ds_read_b128 v[92:95], v2 offset:27648
    v_mfma_f32_32x32x16_bf16 v[144:159], v[100:103], a[100:103], v[144:159]
    ds_read_b128 v[96:99], v1 offset:28672
    s_waitcnt vmcnt(12)
    v_mfma_f32_32x32x16_bf16 v[112:127], v[104:107], a[104:107], v[112:127]
    ds_read_b128 v[100:103], v1 offset:61440
    v_mfma_f32_32x32x16_bf16 v[128:143], v[108:111], a[104:107], v[128:143]
    ds_read_b128 v[104:107], v2 offset:28672
    s_waitcnt lgkmcnt(3)
    v_mfma_f32_32x32x16_bf16 v[144:159], v[80:83], a[104:107], v[144:159]
    ds_read_b128 v[108:111], v1 offset:29696
    s_waitcnt vmcnt(11)
    v_mfma_f32_32x32x16_bf16 v[112:127], v[84:87], a[108:111], v[112:127]
    ds_read_b128 v[80:83], v1 offset:62464
    v_mfma_f32_32x32x16_bf16 v[128:143], v[88:91], a[108:111], v[128:143]
    ds_read_b128 v[84:87], v2 offset:29696
    v_mfma_f32_32x32x16_bf16 v[144:159], v[92:95], a[108:111], v[144:159]
    ds_read_b128 v[88:91], v1 offset:30720
    s_waitcnt vmcnt(9) lgkmcnt(3)
    v_mfma_f32_32x32x16_bf16 v[112:127], v[96:99], a[112:115], v[112:127]
    ds_read_b128 v[92:95], v1 offset:63488
    v_mfma_f32_32x32x16_bf16 v[128:143], v[100:103], a[112:115], v[128:143]
    ds_read_b128 v[96:99], v2 offset:30720
    v_mfma_f32_32x32x16_bf16 v[144:159], v[104:107], a[112:115], v[144:159]
    ds_read_b128 v[100:103], v1 offset:31744
    s_waitcnt vmcnt(8)
    v_mfma_f32_32x32x16_bf16 v[112:127], v[108:111], a[116:119], v[112:127]
    ds_read_b128 v[104:107], v1 offset:64512
    s_waitcnt lgkmcnt(3)
    v_mfma_f32_32x32x16_bf16 v[128:143], v[80:83], a[116:119], v[128:143]
    ds_read_b128 v[108:111], v2 offset:31744
    v_mfma_f32_32x32x16_bf16 v[144:159], v[84:87], a[116:119], v[144:159]
    s_waitcnt vmcnt(7)
    v_mfma_f32_32x32x16_bf16 v[112:127], v[88:91], a[120:123], v[112:127]
    v_mfma_f32_32x32x16_bf16 v[128:143], v[92:95], a[120:123], v[128:143]
    s_barrier
    s_waitcnt lgkmcnt(0)
    v_mfma_f32_32x32x16_bf16 v[144:159], v[96:99], a[120:123], v[144:159]
    ds_read_b128 v[92:95], v2 offset:32768
    s_waitcnt vmcnt(5)
    v_mfma_f32_32x32x16_bf16 v[112:127], v[100:103], a[124:127], v[112:127]
    ds_read_b128 v[96:99], v2 offset:33792
L_page_3:
    s_cbranch_execz L_page_7
    v_mfma_f32_32x32x16_bf16 v[128:143], v[104:107], a[124:127], v[128:143]
    ds_read_b128 v[100:103], v2 offset:34816
    v_mfma_f32_32x32x16_bf16 v[144:159], v[108:111], a[124:127], v[144:159]
    ds_read_b128 v[104:107], v2 offset:35840
    v_mfma_f32_32x32x16_bf16 v[112:127], a[136:139], v[42:45], v[112:127]
    ds_read_b128 v[108:111], v2 offset:36864
    v_mfma_f32_32x32x16_bf16 v[128:143], a[140:143], v[40:43], v[128:143]
    ds_read_b128 v[80:83], v2 offset:37888
    v_mfma_f32_32x32x16_bf16 v[144:159], a[138:141], v[42:45], v[144:159]
    ds_read_b128 v[84:87], v2 offset:38912
    s_barrier
    s_waitcnt lgkmcnt(3)
    v_mfma_f32_32x32x16_bf16 v[160:175], v[92:95], a[0:3], 0
    s_add_u32 m0, s56, 32768
    s_add_u32 s60, s64, 163840
    buffer_load_dwordx4 v1, s[8:11], s60 offen sc1 lds
    ds_read_b128 v[88:91], v2 offset:39936
    v_mfma_f32_32x32x16_bf16 v[160:175], v[96:99], a[4:7], v[160:175]
    ds_read_b128 v[92:95], v2 offset:40960
    v_mul_f32 v192, v112, v112
    v_mul_f32 v193, v113, v113
    v_mul_f32 v194, v114, v114
    v_mul_f32 v195, v115, v115
    v_fma_f32 v192, v192, v36, v34
    v_fma_f32 v193, v193, v36, v34
    v_fma_f32 v194, v194, v36, v34
    v_mfma_f32_32x32x16_bf16 v[160:175], v[100:103], a[8:11], v[160:175]
    buffer_load_dwordx4 v1, s[8:11], s60 offen offset:1024 sc1 lds
    ds_read_b128 v[96:99], v2 offset:41984
    v_fma_f32 v195, v195, v36, v34
    v_mul_f32 v192, v192, v112
    v_mfma_f32_32x32x16_bf16 v[160:175], v[104:107], a[12:15], v[160:175]
    ds_read_b128 v[100:103], v2 offset:43008
    v_mul_f32 v193, v193, v113
    v_mul_f32 v194, v194, v114
    v_mul_f32 v195, v195, v115
    v_exp_f32 v192, v192
    v_mul_f32 v112, v112, v120
    s_waitcnt lgkmcnt(3)
    v_mfma_f32_32x32x16_bf16 v[160:175], v[108:111], a[16:19], v[160:175]
    ds_read_b128 v[104:107], v2 offset:44032
    v_exp_f32 v193, v193
    v_mul_f32 v113, v113, v121
    v_exp_f32 v194, v194
    v_mul_f32 v114, v114, v122
    v_mfma_f32_32x32x16_bf16 v[160:175], v[80:83], a[20:23], v[160:175]
    buffer_load_dwordx4 v1, s[8:11], s60 offen offset:2048 sc1 lds
    ds_read_b128 v[108:111], v2 offset:45056
    v_exp_f32 v195, v195
    v_mfma_f32_32x32x16_bf16 v[160:175], v[84:87], a[24:27], v[160:175]
    ds_read_b128 v[80:83], v2 offset:46080
    v_mul_f32_e64 v115, v115, v123
    v_fma_f32 v192, v192, v38, v38
    v_fma_f32 v193, v193, v38, v38
    v_fma_f32 v194, v194, v38, v38
    v_fma_f32 v195, v195, v38, v38
    v_rcp_f32 v192, v192
    v_mfma_f32_32x32x16_bf16 v[160:175], v[88:91], a[28:31], v[160:175]
    ds_read_b128 v[84:87], v2 offset:47104
    v_rcp_f32 v193, v193
    v_rcp_f32 v194, v194
    v_rcp_f32 v195, v195
    s_waitcnt lgkmcnt(3)
    v_mfma_f32_32x32x16_bf16 v[160:175], v[92:95], a[32:35], v[160:175]
    buffer_load_dwordx4 v1, s[8:11], s60 offen offset:3072 sc1 lds
    ds_read_b128 v[88:91], v2 offset:48128
    v_mul_f32 v112, v112, v192
    v_mul_f32 v113, v113, v193
    v_mfma_f32_32x32x16_bf16 v[160:175], v[96:99], a[36:39], v[160:175]
    ds_read_b128 v[92:95], v2 offset:49152
    v_mul_f32 v114, v114, v194
    v_mul_f32 v115, v115, v195
    v_cvt_pk_bf16_f32 v176, v112, v113
    v_cvt_pk_bf16_f32 v177, v114, v115
    v_mul_f32 v196, v116, v116
    v_mul_f32 v197, v117, v117
    v_mul_f32 v198, v118, v118
    v_mfma_f32_32x32x16_bf16 v[160:175], v[100:103], a[40:43], v[160:175]
    ds_read_b128 v[96:99], v2 offset:50176
    v_mul_f32_e64 v199, v119, v119
    v_fma_f32 v196, v196, v36, v34
    v_fma_f32 v197, v197, v36, v34
    v_fma_f32 v198, v198, v36, v34
    v_fma_f32 v199, v199, v36, v34
    v_mul_f32 v196, v196, v116
    v_mul_f32 v197, v197, v117
    v_mfma_f32_32x32x16_bf16 v[160:175], v[104:107], a[44:47], v[160:175]
    ds_read_b128 v[100:103], v2 offset:51200
    s_add_u32 m0, s56, 49152
    s_add_u32 s60, s64, 180224
    v_mul_f32 v198, v198, v118
    v_mul_f32 v199, v199, v119
    v_exp_f32 v196, v196
    s_waitcnt lgkmcnt(3)
    v_mfma_f32_32x32x16_bf16 v[160:175], v[108:111], a[48:51], v[160:175]
    buffer_load_dwordx4 v1, s[8:11], s60 offen sc1 lds
    ds_read_b128 v[104:107], v2 offset:52224
    v_mul_f32 v116, v116, v124
    v_mfma_f32_32x32x16_bf16 v[160:175], v[80:83], a[52:55], v[160:175]
    ds_read_b128 v[108:111], v2 offset:53248
    v_exp_f32 v197, v197
    v_mul_f32 v117, v117, v125
    v_exp_f32 v198, v198
    v_mul_f32 v118, v118, v126
    v_mfma_f32_32x32x16_bf16 v[160:175], v[84:87], a[56:59], v[160:175]
    buffer_load_dwordx4 v1, s[8:11], s60 offen offset:1024 sc1 lds
    ds_read_b128 v[80:83], v2 offset:54272
    v_exp_f32 v199, v199
    v_mfma_f32_32x32x16_bf16 v[160:175], v[88:91], a[60:63], v[160:175]
    ds_read_b128 v[84:87], v2 offset:55296
    v_mul_f32_e64 v119, v119, v127
    v_fma_f32 v196, v196, v38, v38
    v_fma_f32 v197, v197, v38, v38
    v_fma_f32 v198, v198, v38, v38
    v_fma_f32 v199, v199, v38, v38
    s_waitcnt lgkmcnt(3)
    v_mfma_f32_32x32x16_bf16 v[160:175], v[92:95], a[64:67], v[160:175]
    ds_read_b128 v[88:91], v2 offset:56320
    v_rcp_f32 v196, v196
    v_rcp_f32 v197, v197
    v_rcp_f32 v198, v198
    v_mfma_f32_32x32x16_bf16 v[160:175], v[96:99], a[68:71], v[160:175]
    buffer_load_dwordx4 v1, s[8:11], s60 offen offset:2048 sc1 lds
    ds_read_b128 v[92:95], v2 offset:57344
    v_rcp_f32 v199, v199
    v_mfma_f32_32x32x16_bf16 v[160:175], v[100:103], a[72:75], v[160:175]
    ds_read_b128 v[96:99], v2 offset:58368
    v_mul_f32 v116, v116, v196
    v_mul_f32 v117, v117, v197
    v_mul_f32 v118, v118, v198
    v_mul_f32 v119, v119, v199
    v_cvt_pk_bf16_f32 v178, v116, v117
    v_cvt_pk_bf16_f32 v179, v118, v119
    s_add_u32 s76, s75, 0
    v_mfma_f32_32x32x16_bf16 v[160:175], v[104:107], a[76:79], v[160:175]
    buffer_store_dwordx4 v[176:179], v1, s[4:7], s76 offen sc1
    ds_read_b128 v[100:103], v2 offset:59392
    s_waitcnt lgkmcnt(3)
    v_mfma_f32_32x32x16_bf16 v[160:175], v[108:111], a[80:83], v[160:175]
    buffer_load_dwordx4 v1, s[8:11], s60 offen offset:3072 sc1 lds
    ds_read_b128 v[104:107], v2 offset:60416
    v_mul_f32 v192, v128, v128
    v_mul_f32 v193, v129, v129
    v_mfma_f32_32x32x16_bf16 v[160:175], v[80:83], a[84:87], v[160:175]
    ds_read_b128 v[108:111], v2 offset:61440
    v_mul_f32 v194, v130, v130
    v_mul_f32_e64 v195, v131, v131
    v_fma_f32 v192, v192, v36, v34
    v_fma_f32 v193, v193, v36, v34
    v_fma_f32 v194, v194, v36, v34
    v_fma_f32 v195, v195, v36, v34
    v_mul_f32 v192, v192, v128
    v_mfma_f32_32x32x16_bf16 v[160:175], v[84:87], a[88:91], v[160:175]
    ds_read_b128 v[80:83], v2 offset:62464
    v_mul_f32 v193, v193, v129
    v_mul_f32 v194, v194, v130
    v_mul_f32 v195, v195, v131
    v_exp_f32 v192, v192
    v_mul_f32 v128, v128, v136
    v_mfma_f32_32x32x16_bf16 v[160:175], v[88:91], a[92:95], v[160:175]
    ds_read_b128 v[84:87], v2 offset:63488
    s_add_u32 m0, s56, 65536
    s_add_u32 s60, s64, 196608
    v_exp_f32 v193, v193
    v_mul_f32 v129, v129, v137
    s_waitcnt lgkmcnt(3)
    v_mfma_f32_32x32x16_bf16 v[160:175], v[92:95], a[96:99], v[160:175]
    buffer_load_dwordx4 v1, s[8:11], s60 offen sc1 lds
    ds_read_b128 v[88:91], v2 offset:64512
    v_exp_f32 v194, v194
    v_mfma_f32_32x32x16_bf16 v[160:175], v[96:99], a[100:103], v[160:175]
    s_waitcnt vmcnt(10)
    s_barrier
    v_mfma_f32_32x32x16_bf16 v[160:175], v[100:103], a[104:107], v[160:175]
    buffer_load_dwordx4 v1, s[8:11], s60 offen offset:1024 sc1 lds
    ds_read_b128 v[96:99], v3 offset:0
    v_mul_f32 v130, v130, v138
    v_mfma_f32_32x32x16_bf16 v[160:175], v[104:107], a[108:111], v[160:175]
    ds_read_b128 v[100:103], v3 offset:1024
    v_exp_f32 v195, v195
    v_mul_f32 v131, v131, v139
    v_fma_f32 v192, v192, v38, v38
    v_fma_f32 v193, v193, v38, v38
    v_fma_f32 v194, v194, v38, v38
    s_waitcnt lgkmcnt(2)
    v_mfma_f32_32x32x16_bf16 v[160:175], v[108:111], a[112:115], v[160:175]
    ds_read_b128 v[104:107], v3 offset:2048
    v_fma_f32 v195, v195, v38, v38
    v_rcp_f32 v192, v192
    v_rcp_f32 v193, v193
    v_rcp_f32 v194, v194
    v_mfma_f32_32x32x16_bf16 v[160:175], v[80:83], a[116:119], v[160:175]
    buffer_load_dwordx4 v1, s[8:11], s60 offen offset:2048 sc1 lds
    ds_read_b128 v[108:111], v3 offset:3072
    v_rcp_f32 v195, v195
    v_mfma_f32_32x32x16_bf16 v[160:175], v[84:87], a[120:123], v[160:175]
    ds_read_b128 v[80:83], v3 offset:4096
    v_mul_f32 v128, v128, v192
    v_mul_f32 v129, v129, v193
    v_mul_f32 v130, v130, v194
    v_mul_f32 v131, v131, v195
    v_cvt_pk_bf16_f32 v180, v128, v129
    v_cvt_pk_bf16_f32 v181, v130, v131
    v_mul_f32 v196, v132, v132
    v_mfma_f32_32x32x16_bf16 v[160:175], v[88:91], a[124:127], v[160:175]
    ds_read_b128 v[84:87], v3 offset:5120
    v_mul_f32 v197, v133, v133
    v_mul_f32 v198, v134, v134
    v_mul_f32 v199, v135, v135
    v_fma_f32 v196, v196, v36, v34
    v_fma_f32 v197, v197, v36, v34
    v_fma_f32 v198, v198, v36, v34
    v_fma_f32 v199, v199, v36, v34
    v_mfma_f32_32x32x16_bf16 v[160:175], a[142:145], v[40:43], v[160:175]
    ds_read_b128 v[88:91], v3 offset:6144
    s_barrier
    s_waitcnt lgkmcnt(3)
    v_mfma_f32_32x32x16_bf16 v[112:127], v[96:99], a[0:3], 0
    buffer_load_dwordx4 v1, s[8:11], s60 offen offset:3072 sc1 lds
    ds_read_b128 v[92:95], v3 offset:7168
    v_mul_f32 v196, v196, v132
    v_mul_f32 v197, v197, v133
    v_mfma_f32_32x32x16_bf16 v[112:127], v[100:103], a[4:7], v[112:127]
    ds_read_b128 v[96:99], v3 offset:8192
    s_add_u32 m0, s56, 81920
    s_add_u32 s60, s64, 212992
    v_mul_f32 v198, v198, v134
    v_mul_f32 v199, v199, v135
    v_exp_f32 v196, v196
    v_mul_f32 v132, v132, v140
    v_mfma_f32_32x32x16_bf16 v[112:127], v[104:107], a[8:11], v[112:127]
    buffer_load_dwordx4 v1, s[8:11], s60 offen sc1 lds
    ds_read_b128 v[100:103], v3 offset:9216
    v_exp_f32 v197, v197
    v_mfma_f32_32x32x16_bf16 v[112:127], v[108:111], a[12:15], v[112:127]
    ds_read_b128 v[104:107], v3 offset:10240
    v_mul_f32 v133, v133, v141
    v_exp_f32 v198, v198
    v_mul_f32 v134, v134, v142
    v_exp_f32 v199, v199
    s_waitcnt lgkmcnt(3)
    v_mfma_f32_32x32x16_bf16 v[112:127], v[80:83], a[16:19], v[112:127]
    ds_read_b128 v[108:111], v3 offset:11264
    v_mul_f32_e64 v135, v135, v143
    v_fma_f32 v196, v196, v38, v38
    v_fma_f32 v197, v197, v38, v38
    v_fma_f32 v198, v198, v38, v38
    v_fma_f32 v199, v199, v38, v38
    v_rcp_f32 v196, v196
    v_mfma_f32_32x32x16_bf16 v[112:127], v[84:87], a[20:23], v[112:127]
    buffer_load_dwordx4 v1, s[8:11], s60 offen offset:1024 sc1 lds
    ds_read_b128 v[80:83], v3 offset:12288
    v_rcp_f32 v197, v197
    v_mfma_f32_32x32x16_bf16 v[112:127], v[88:91], a[24:27], v[112:127]
    ds_read_b128 v[84:87], v3 offset:13312
    v_rcp_f32 v198, v198
    v_rcp_f32 v199, v199
    v_mul_f32 v132, v132, v196
    v_mul_f32 v133, v133, v197
    v_mul_f32 v134, v134, v198
    v_mfma_f32_32x32x16_bf16 v[112:127], v[92:95], a[28:31], v[112:127]
    ds_read_b128 v[88:91], v3 offset:14336
    v_mul_f32 v135, v135, v199
    v_cvt_pk_bf16_f32 v182, v132, v133
    v_cvt_pk_bf16_f32 v183, v134, v135
    s_add_u32 s76, s75, 16384
    s_waitcnt lgkmcnt(3)
    v_mfma_f32_32x32x16_bf16 v[112:127], v[96:99], a[32:35], v[112:127]
    buffer_load_dwordx4 v1, s[8:11], s60 offen offset:2048 sc1 lds
    ds_read_b128 v[92:95], v3 offset:15360
    v_mfma_f32_32x32x16_bf16 v[112:127], v[100:103], a[36:39], v[112:127]
    buffer_store_dwordx4 v[180:183], v1, s[4:7], s76 offen sc1
    ds_read_b128 v[96:99], v3 offset:16384
    v_mfma_f32_32x32x16_bf16 v[112:127], v[104:107], a[40:43], v[112:127]
    ds_read_b128 v[100:103], v3 offset:17408
    v_mul_f32 v192, v144, v144
    v_mul_f32 v193, v145, v145
    v_mul_f32 v194, v146, v146
    v_mul_f32 v195, v147, v147
    v_fma_f32 v192, v192, v36, v34
    v_fma_f32 v193, v193, v36, v34
    v_fma_f32 v194, v194, v36, v34
    v_mfma_f32_32x32x16_bf16 v[112:127], v[108:111], a[44:47], v[112:127]
    ds_read_b128 v[104:107], v3 offset:18432
    v_fma_f32 v195, v195, v36, v34
    v_mul_f32 v192, v192, v144
    v_mul_f32 v193, v193, v145
    v_mul_f32 v194, v194, v146
    v_mul_f32 v195, v195, v147
    s_waitcnt lgkmcnt(3)
    v_mfma_f32_32x32x16_bf16 v[112:127], v[80:83], a[48:51], v[112:127]
    buffer_load_dwordx4 v1, s[8:11], s60 offen offset:3072 sc1 lds
    ds_read_b128 v[108:111], v3 offset:19456
    v_exp_f32 v192, v192
    v_mfma_f32_32x32x16_bf16 v[112:127], v[84:87], a[52:55], v[112:127]
    ds_read_b128 v[80:83], v3 offset:20480
    s_add_u32 m0, s56, 0
    s_add_u32 s60, s63, 0
    v_mul_f32 v144, v144, v152
    v_exp_f32 v193, v193
    v_mul_f32 v145, v145, v153
    v_mfma_f32_32x32x16_bf16 v[112:127], v[88:91], a[56:59], v[112:127]
    buffer_load_dwordx4 v1, s[8:11], s60 offen sc1 lds
    ds_read_b128 v[84:87], v3 offset:21504
    v_exp_f32 v194, v194
    v_mfma_f32_32x32x16_bf16 v[112:127], v[92:95], a[60:63], v[112:127]
    ds_read_b128 v[88:91], v3 offset:22528
    v_mul_f32 v146, v146, v154
    v_exp_f32 v195, v195
    v_mul_f32 v147, v147, v155
    v_fma_f32 v192, v192, v38, v38
    v_fma_f32 v193, v193, v38, v38
    s_waitcnt lgkmcnt(3)
    v_mfma_f32_32x32x16_bf16 v[112:127], v[96:99], a[64:67], v[112:127]
    ds_read_b128 v[92:95], v3 offset:23552
    v_fma_f32 v194, v194, v38, v38
    v_fma_f32 v195, v195, v38, v38
    v_rcp_f32 v192, v192
    v_rcp_f32 v193, v193
    v_mfma_f32_32x32x16_bf16 v[112:127], v[100:103], a[68:71], v[112:127]
    ds_read_b128 v[96:99], v3 offset:24576
    v_rcp_f32 v194, v194
    v_rcp_f32 v195, v195
    v_mul_f32 v144, v144, v192
    v_mul_f32 v145, v145, v193
    v_mul_f32 v146, v146, v194
    v_mfma_f32_32x32x16_bf16 v[112:127], v[104:107], a[72:75], v[112:127]
    buffer_load_dwordx4 v1, s[8:11], s60 offen offset:1024 sc1 lds
    ds_read_b128 v[100:103], v3 offset:25600
    v_mul_f32 v147, v147, v195
    v_cvt_pk_bf16_f32 v184, v144, v145
    v_mfma_f32_32x32x16_bf16 v[112:127], v[108:111], a[76:79], v[112:127]
    ds_read_b128 v[104:107], v3 offset:26624
    v_cvt_pk_bf16_f32 v185, v146, v147
    v_mul_f32 v196, v148, v148
    v_mul_f32 v197, v149, v149
    v_mul_f32 v198, v150, v150
    v_mul_f32 v199, v151, v151
    v_fma_f32 v196, v196, v36, v34
    s_waitcnt lgkmcnt(3)
    v_mfma_f32_32x32x16_bf16 v[112:127], v[80:83], a[80:83], v[112:127]
    ds_read_b128 v[108:111], v3 offset:27648
    v_fma_f32 v197, v197, v36, v34
    v_fma_f32 v198, v198, v36, v34
    v_fma_f32 v199, v199, v36, v34
    v_mul_f32 v196, v196, v148
    v_mul_f32 v197, v197, v149
    v_mul_f32 v198, v198, v150
    v_mul_f32 v199, v199, v151
    v_mfma_f32_32x32x16_bf16 v[112:127], v[84:87], a[84:87], v[112:127]
    ds_read_b128 v[80:83], v3 offset:28672
    v_exp_f32 v196, v196
    v_mul_f32 v148, v148, v156
    v_exp_f32 v197, v197
    v_mul_f32 v149, v149, v157
    v_mfma_f32_32x32x16_bf16 v[112:127], v[88:91], a[88:91], v[112:127]
    buffer_load_dwordx4 v1, s[8:11], s60 offen offset:2048 sc1 lds
    ds_read_b128 v[84:87], v3 offset:29696
    v_exp_f32 v198, v198
    v_mfma_f32_32x32x16_bf16 v[112:127], v[92:95], a[92:95], v[112:127]
    ds_read_b128 v[88:91], v3 offset:30720
    v_mul_f32 v150, v150, v158
    v_exp_f32 v199, v199
    v_mul_f32 v151, v151, v159
    v_fma_f32 v196, v196, v38, v38
    v_fma_f32 v197, v197, v38, v38
    s_waitcnt lgkmcnt(3)
    v_mfma_f32_32x32x16_bf16 v[112:127], v[96:99], a[96:99], v[112:127]
    ds_read_b128 v[92:95], v3 offset:31744
    v_fma_f32 v198, v198, v38, v38
    v_fma_f32 v199, v199, v38, v38
    v_rcp_f32 v196, v196
    v_rcp_f32 v197, v197
    v_mfma_f32_32x32x16_bf16 v[112:127], v[100:103], a[100:103], v[112:127]
    s_waitcnt vmcnt(12)
    s_barrier
    v_mfma_f32_32x32x16_bf16 v[112:127], v[104:107], a[104:107], v[112:127]
    buffer_load_dwordx4 v1, s[8:11], s60 offen offset:3072 sc1 lds
    ds_read_b128 v[100:103], v1 offset:32768
    v_rcp_f32 v198, v198
    v_mfma_f32_32x32x16_bf16 v[112:127], v[108:111], a[108:111], v[112:127]
    ds_read_b128 v[104:107], v1 offset:33792
    v_rcp_f32 v199, v199
    v_mul_f32 v148, v148, v196
    v_mul_f32 v149, v149, v197
    v_mul_f32 v150, v150, v198
    v_mul_f32 v151, v151, v199
    s_waitcnt lgkmcnt(2)
    v_mfma_f32_32x32x16_bf16 v[112:127], v[80:83], a[112:115], v[112:127]
    ds_read_b128 v[108:111], v1 offset:34816
    v_cvt_pk_bf16_f32 v186, v148, v149
    v_cvt_pk_bf16_f32 v187, v150, v151
    s_add_u32 s76, s75, 32768
    v_mfma_f32_32x32x16_bf16 v[112:127], v[84:87], a[116:119], v[112:127]
    buffer_store_dwordx4 v[184:187], v1, s[4:7], s76 offen sc1
    ds_read_b128 v[80:83], v1 offset:35840
    s_add_u32 m0, s56, 16384
    s_add_u32 s60, s63, 16384
    v_mfma_f32_32x32x16_bf16 v[112:127], v[88:91], a[120:123], v[112:127]
    buffer_load_dwordx4 v1, s[8:11], s60 offen sc1 lds
    ds_read_b128 v[84:87], v1 offset:36864
    v_mul_f32 v192, v160, v160
    v_mul_f32 v193, v161, v161
    v_mfma_f32_32x32x16_bf16 v[112:127], v[92:95], a[124:127], v[112:127]
    ds_read_b128 v[88:91], v1 offset:37888
    v_mul_f32 v194, v162, v162
    v_mul_f32 v195, v163, v163
    v_fma_f32 v192, v192, v36, v34
    v_fma_f32 v193, v193, v36, v34
    v_fma_f32 v194, v194, v36, v34
    v_fma_f32 v195, v195, v36, v34
    v_mul_f32 v192, v192, v160
    v_mfma_f32_32x32x16_bf16 v[112:127], a[140:143], v[42:45], v[112:127]
    ds_read_b128 v[92:95], v1 offset:38912
    s_barrier
    s_waitcnt lgkmcnt(3)
    v_mfma_f32_32x32x16_bf16 v[128:143], v[100:103], a[0:3], 0
    ds_read_b128 v[96:99], v1 offset:39936
    v_mul_f32 v193, v193, v161
    v_mul_f32 v194, v194, v162
    v_mul_f32 v195, v195, v163
    v_exp_f32 v192, v192
    v_mul_f32 v160, v160, v168
    v_mfma_f32_32x32x16_bf16 v[128:143], v[104:107], a[4:7], v[128:143]
    buffer_load_dwordx4 v1, s[8:11], s60 offen offset:1024 sc1 lds
    ds_read_b128 v[100:103], v1 offset:40960
    v_exp_f32 v193, v193
    v_mfma_f32_32x32x16_bf16 v[128:143], v[108:111], a[8:11], v[128:143]
    ds_read_b128 v[104:107], v1 offset:41984
    v_mul_f32 v161, v161, v169
    v_exp_f32 v194, v194
    v_mul_f32 v162, v162, v170
    v_exp_f32 v195, v195
    v_mul_f32 v163, v163, v171
    v_mfma_f32_32x32x16_bf16 v[128:143], v[80:83], a[12:15], v[128:143]
    ds_read_b128 v[108:111], v1 offset:43008
    v_fma_f32 v192, v192, v38, v38
    v_fma_f32 v193, v193, v38, v38
    v_fma_f32 v194, v194, v38, v38
    v_fma_f32 v195, v195, v38, v38
    v_rcp_f32 v192, v192
    s_waitcnt lgkmcnt(3)
    v_mfma_f32_32x32x16_bf16 v[128:143], v[84:87], a[16:19], v[128:143]
    ds_read_b128 v[80:83], v1 offset:44032
    v_rcp_f32 v193, v193
    v_rcp_f32 v194, v194
    v_rcp_f32 v195, v195
    v_mul_f32 v160, v160, v192
    v_mfma_f32_32x32x16_bf16 v[128:143], v[88:91], a[20:23], v[128:143]
    buffer_load_dwordx4 v1, s[8:11], s60 offen offset:2048 sc1 lds
    ds_read_b128 v[84:87], v1 offset:45056
    v_mul_f32 v161, v161, v193
    v_mul_f32 v162, v162, v194
    v_mfma_f32_32x32x16_bf16 v[128:143], v[92:95], a[24:27], v[128:143]
    ds_read_b128 v[88:91], v1 offset:46080
    v_add_u32 v28, 3, v24
    s_mov_b64 exec, 1
    s_cmp_eq_u32 s53, 0
    s_cbranch_scc1 L_dev_48
    s_waitcnt vmcnt(9)
    buffer_store_dword v28, off, s[8:11], s82
L_sg_49:
    s_mov_b64 exec, -1
    v_mfma_f32_32x32x16_bf16 v[128:143], v[96:99], a[28:31], v[128:143]
    ds_read_b128 v[92:95], v1 offset:47104
    v_mul_f32 v163, v163, v195
    v_cvt_pk_bf16_f32 v188, v160, v161
    v_cvt_pk_bf16_f32 v189, v162, v163
    v_mul_f32 v196, v164, v164
    v_mul_f32 v197, v165, v165
    v_mul_f32 v198, v166, v166
    s_waitcnt lgkmcnt(3)
    v_mfma_f32_32x32x16_bf16 v[128:143], v[100:103], a[32:35], v[128:143]
    ds_read_b128 v[96:99], v1 offset:48128
    v_mul_f32 v199, v167, v167
    v_fma_f32 v196, v196, v36, v34
    v_fma_f32 v197, v197, v36, v34
    v_fma_f32 v198, v198, v36, v34
    v_fma_f32 v199, v199, v36, v34
    v_mul_f32 v196, v196, v164
    v_mul_f32 v197, v197, v165
    v_mfma_f32_32x32x16_bf16 v[128:143], v[104:107], a[36:39], v[128:143]
    buffer_load_dwordx4 v1, s[8:11], s60 offen offset:3072 sc1 lds
    ds_read_b128 v[100:103], v1 offset:49152
    v_mul_f32 v198, v198, v166
    v_mul_f32 v199, v199, v167
    v_mfma_f32_32x32x16_bf16 v[128:143], v[108:111], a[40:43], v[128:143]
    ds_read_b128 v[104:107], v1 offset:50176
    v_exp_f32 v196, v196
    v_mul_f32 v164, v164, v172
    v_exp_f32 v197, v197
    v_mul_f32 v165, v165, v173
    v_mfma_f32_32x32x16_bf16 v[128:143], v[80:83], a[44:47], v[128:143]
    ds_read_b128 v[108:111], v1 offset:51200
    v_exp_f32 v198, v198
    v_mul_f32 v166, v166, v174
    v_exp_f32 v199, v199
    v_mul_f32 v167, v167, v175
    s_waitcnt lgkmcnt(3)
    v_mfma_f32_32x32x16_bf16 v[128:143], v[84:87], a[48:51], v[128:143]
    ds_read_b128 v[80:83], v1 offset:52224
    s_add_u32 m0, s56, 98304
    s_add_u32 s60, s63, 32768
    v_fma_f32 v196, v196, v38, v38
    v_fma_f32 v197, v197, v38, v38
    v_fma_f32 v198, v198, v38, v38
    v_fma_f32 v199, v199, v38, v38
    v_mfma_f32_32x32x16_bf16 v[128:143], v[88:91], a[52:55], v[128:143]
    buffer_load_dwordx4 v1, s[8:11], s60 offen sc1 lds
    ds_read_b128 v[84:87], v1 offset:53248
    v_rcp_f32 v196, v196
    v_mfma_f32_32x32x16_bf16 v[128:143], v[92:95], a[56:59], v[128:143]
    ds_read_b128 v[88:91], v1 offset:54272
    v_rcp_f32 v197, v197
    v_rcp_f32 v198, v198
    v_rcp_f32 v199, v199
    v_mul_f32 v164, v164, v196
    v_mfma_f32_32x32x16_bf16 v[128:143], v[96:99], a[60:63], v[128:143]
    ds_read_b128 v[92:95], v1 offset:55296
    v_mul_f32 v165, v165, v197
    v_mul_f32 v166, v166, v198
    v_mul_f32 v167, v167, v199
    v_cvt_pk_bf16_f32 v190, v164, v165
    v_cvt_pk_bf16_f32 v191, v166, v167
    s_add_u32 s76, s75, 49152
    s_waitcnt lgkmcnt(3)
    v_mfma_f32_32x32x16_bf16 v[128:143], v[100:103], a[64:67], v[128:143]
    buffer_store_dwordx4 v[188:191], v1, s[4:7], s76 offen sc1
    ds_read_b128 v[96:99], v1 offset:56320
    v_mfma_f32_32x32x16_bf16 v[128:143], v[104:107], a[68:71], v[128:143]
    buffer_load_dwordx4 v1, s[8:11], s60 offen offset:1024 sc1 lds
    ds_read_b128 v[100:103], v1 offset:57344
    v_mul_f32 v192, v112, v112
    v_mul_f32 v193, v113, v113
    v_mfma_f32_32x32x16_bf16 v[128:143], v[108:111], a[72:75], v[128:143]
    ds_read_b128 v[104:107], v1 offset:58368
    v_mul_f32 v194, v114, v114
    v_mul_f32 v195, v115, v115
    v_fma_f32 v192, v192, v36, v34
    v_fma_f32 v193, v193, v36, v34
    v_fma_f32 v194, v194, v36, v34
    v_fma_f32 v195, v195, v36, v34
    v_mul_f32 v192, v192, v112
    v_mfma_f32_32x32x16_bf16 v[128:143], v[80:83], a[76:79], v[128:143]
    ds_read_b128 v[108:111], v1 offset:59392
    v_mul_f32 v193, v193, v113
    v_mul_f32 v194, v194, v114
    v_mul_f32 v195, v195, v115
    v_exp_f32 v192, v192
    v_mul_f32 v112, v112, v120
    s_waitcnt lgkmcnt(3)
    v_mfma_f32_32x32x16_bf16 v[128:143], v[84:87], a[80:83], v[128:143]
    ds_read_b128 v[80:83], v1 offset:60416
    v_exp_f32 v193, v193
    v_mul_f32 v113, v113, v121
    v_exp_f32 v194, v194
    v_mul_f32 v114, v114, v122
    v_mfma_f32_32x32x16_bf16 v[128:143], v[88:91], a[84:87], v[128:143]
    buffer_load_dwordx4 v1, s[8:11], s60 offen offset:2048 sc1 lds
    ds_read_b128 v[84:87], v1 offset:61440
    v_exp_f32 v195, v195
    v_mfma_f32_32x32x16_bf16 v[128:143], v[92:95], a[88:91], v[128:143]
    ds_read_b128 v[88:91], v1 offset:62464
    v_mul_f32_e64 v115, v115, v123
    v_fma_f32 v192, v192, v38, v38
    v_fma_f32 v193, v193, v38, v38
    v_fma_f32 v194, v194, v38, v38
    v_fma_f32 v195, v195, v38, v38
    v_rcp_f32 v192, v192
    v_mfma_f32_32x32x16_bf16 v[128:143], v[96:99], a[92:95], v[128:143]
    ds_read_b128 v[92:95], v1 offset:63488
    v_rcp_f32 v193, v193
    v_rcp_f32 v194, v194
    v_rcp_f32 v195, v195
    s_waitcnt lgkmcnt(3)
    v_mfma_f32_32x32x16_bf16 v[128:143], v[100:103], a[96:99], v[128:143]
    ds_read_b128 v[96:99], v1 offset:64512
    v_mul_f32 v112, v112, v192
    v_mul_f32 v113, v113, v193
    v_mul_f32 v114, v114, v194
    v_mul_f32 v115, v115, v195
    v_cvt_pk_bf16_f32 v200, v112, v113
    v_cvt_pk_bf16_f32 v201, v114, v115
    v_mul_f32 v196, v116, v116
    v_mfma_f32_32x32x16_bf16 v[128:143], v[104:107], a[100:103], v[128:143]
    buffer_load_dwordx4 v1, s[8:11], s60 offen offset:3072 sc1 lds
    s_waitcnt vmcnt(15)
    s_barrier
    v_mfma_f32_32x32x16_bf16 v[128:143], v[108:111], a[104:107], v[128:143]
    ds_read_b128 v[104:107], v2 offset:0
    v_mul_f32 v197, v117, v117
    v_mul_f32 v198, v118, v118
    v_mul_f32_e64 v199, v119, v119
    v_fma_f32 v196, v196, v36, v34
    v_fma_f32 v197, v197, v36, v34
    v_fma_f32 v198, v198, v36, v34
    v_fma_f32 v199, v199, v36, v34
    v_mfma_f32_32x32x16_bf16 v[128:143], v[80:83], a[108:111], v[128:143]
    ds_read_b128 v[108:111], v2 offset:1024
    v_mul_f32 v196, v196, v116
    v_mul_f32 v197, v197, v117
    v_mul_f32 v198, v198, v118
    v_mul_f32 v199, v199, v119
    v_exp_f32 v196, v196
    s_waitcnt lgkmcnt(2)
    v_mfma_f32_32x32x16_bf16 v[128:143], v[84:87], a[112:115], v[128:143]
    ds_read_b128 v[80:83], v2 offset:2048
    s_add_u32 m0, s56, 114688
    s_add_u32 s60, s63, 49152
    v_mul_f32 v116, v116, v124
    v_exp_f32 v197, v197
    v_mul_f32 v117, v117, v125
    v_mfma_f32_32x32x16_bf16 v[128:143], v[88:91], a[116:119], v[128:143]
    buffer_load_dwordx4 v1, s[8:11], s60 offen sc1 lds
    ds_read_b128 v[84:87], v2 offset:3072
    v_exp_f32 v198, v198
    v_mfma_f32_32x32x16_bf16 v[128:143], v[92:95], a[120:123], v[128:143]
    ds_read_b128 v[88:91], v2 offset:4096
    v_mul_f32 v118, v118, v126
    v_exp_f32 v199, v199
    v_mul_f32 v119, v119, v127
    v_fma_f32 v196, v196, v38, v38
    v_fma_f32 v197, v197, v38, v38
    v_fma_f32 v198, v198, v38, v38
    v_mfma_f32_32x32x16_bf16 v[128:143], v[96:99], a[124:127], v[128:143]
    ds_read_b128 v[92:95], v2 offset:5120
    v_fma_f32 v199, v199, v38, v38
    v_rcp_f32 v196, v196
    v_rcp_f32 v197, v197
    v_rcp_f32 v198, v198
    v_mfma_f32_32x32x16_bf16 v[128:143], a[144:147], v[40:43], v[128:143]
    ds_read_b128 v[96:99], v2 offset:6144
    s_waitcnt lgkmcnt(3)
    v_mfma_f32_32x32x16_bf16 v[144:159], v[104:107], a[0:3], 0
    buffer_load_dwordx4 v1, s[8:11], s60 offen offset:1024 sc1 lds
    ds_read_b128 v[100:103], v2 offset:7168
    v_rcp_f32 v199, v199
    v_mfma_f32_32x32x16_bf16 v[144:159], v[108:111], a[4:7], v[144:159]
    ds_read_b128 v[104:107], v2 offset:8192
    v_mul_f32 v116, v116, v196
    v_mul_f32 v117, v117, v197
    v_mul_f32 v118, v118, v198
    v_mul_f32 v119, v119, v199
    v_cvt_pk_bf16_f32 v202, v116, v117
    v_cvt_pk_bf16_f32 v203, v118, v119
    s_add_u32 s76, s75, 65536
    v_mfma_f32_32x32x16_bf16 v[144:159], v[80:83], a[8:11], v[144:159]
    buffer_store_dwordx4 v[200:203], v1, s[4:7], s76 offen sc1
    ds_read_b128 v[108:111], v2 offset:9216
    v_mfma_f32_32x32x16_bf16 v[144:159], v[84:87], a[12:15], v[144:159]
    ds_read_b128 v[80:83], v2 offset:10240
L_page_4:
    s_cbranch_execz L_page_8
    buffer_load_dword v26, v5, s[8:11], s81 offen sc1
    s_waitcnt lgkmcnt(3)
    v_mfma_f32_32x32x16_bf16 v[144:159], v[88:91], a[16:19], v[144:159]
    buffer_load_dwordx4 v1, s[8:11], s60 offen offset:2048 sc1 lds
    ds_read_b128 v[84:87], v2 offset:11264
    v_mul_f32 v192, v128, v128
    v_mul_f32 v193, v129, v129
    v_mfma_f32_32x32x16_bf16 v[144:159], v[92:95], a[20:23], v[144:159]
    ds_read_b128 v[88:91], v2 offset:12288
    v_mul_f32 v194, v130, v130
    v_mul_f32 v195, v131, v131
    v_fma_f32 v192, v192, v36, v34
    v_fma_f32 v193, v193, v36, v34
    v_fma_f32 v194, v194, v36, v34
    v_fma_f32 v195, v195, v36, v34
    v_mul_f32 v192, v192, v128
    v_mfma_f32_32x32x16_bf16 v[144:159], v[96:99], a[24:27], v[144:159]
    ds_read_b128 v[92:95], v2 offset:13312
    v_mul_f32 v193, v193, v129
    v_mul_f32 v194, v194, v130
    v_mul_f32 v195, v195, v131
    v_exp_f32 v192, v192
    v_mul_f32 v128, v128, v136
    v_mfma_f32_32x32x16_bf16 v[144:159], v[100:103], a[28:31], v[144:159]
    ds_read_b128 v[96:99], v2 offset:14336
    v_exp_f32 v193, v193
    v_mul_f32 v129, v129, v137
    v_exp_f32 v194, v194
    v_mul_f32 v130, v130, v138
    s_waitcnt lgkmcnt(3)
    v_mfma_f32_32x32x16_bf16 v[144:159], v[104:107], a[32:35], v[144:159]
    buffer_load_dwordx4 v1, s[8:11], s60 offen offset:3072 sc1 lds
    ds_read_b128 v[100:103], v2 offset:15360
    v_exp_f32 v195, v195
    v_mfma_f32_32x32x16_bf16 v[144:159], v[108:111], a[36:39], v[144:159]
    ds_read_b128 v[104:107], v2 offset:16384
    v_mul_f32_e64 v131, v131, v139
    v_fma_f32 v192, v192, v38, v38
    v_fma_f32 v193, v193, v38, v38
    v_fma_f32 v194, v194, v38, v38
    v_fma_f32 v195, v195, v38, v38
    v_rcp_f32 v192, v192
    v_mfma_f32_32x32x16_bf16 v[144:159], v[80:83], a[40:43], v[144:159]
    ds_read_b128 v[108:111], v2 offset:17408
    v_rcp_f32 v193, v193
    v_rcp_f32 v194, v194
    v_rcp_f32 v195, v195
    v_mul_f32 v128, v128, v192
    v_mfma_f32_32x32x16_bf16 v[144:159], v[84:87], a[44:47], v[144:159]
    ds_read_b128 v[80:83], v2 offset:18432
    s_add_u32 m0, s56, 131072
    s_add_u32 s60, s63, 65536
    v_add_u32 v28, 5, v24
    s_mov_b64 exec, 1
    s_cmp_eq_u32 s53, 0
    s_cbranch_scc1 L_dev_50
    s_waitcnt vmcnt(9)
    buffer_store_dword v28, off, s[8:11], s82
L_sg_51:
    s_mov_b64 exec, -1
    s_waitcnt lgkmcnt(3)
    v_mfma_f32_32x32x16_bf16 v[144:159], v[88:91], a[48:51], v[144:159]
    buffer_load_dwordx4 v1, s[8:11], s60 offen sc1 lds
    ds_read_b128 v[84:87], v2 offset:19456
    v_mul_f32 v129, v129, v193
    v_mul_f32 v130, v130, v194
    v_mfma_f32_32x32x16_bf16 v[144:159], v[92:95], a[52:55], v[144:159]
    ds_read_b128 v[88:91], v2 offset:20480
    v_mul_f32 v131, v131, v195
    v_cvt_pk_bf16_f32 v204, v128, v129
    v_cvt_pk_bf16_f32 v205, v130, v131
    v_mul_f32 v196, v132, v132
    v_mul_f32 v197, v133, v133
    v_mul_f32 v198, v134, v134
    v_mul_f32 v199, v135, v135
    v_mfma_f32_32x32x16_bf16 v[144:159], v[96:99], a[56:59], v[144:159]
    ds_read_b128 v[92:95], v2 offset:21504
    v_fma_f32 v196, v196, v36, v34
    v_fma_f32 v197, v197, v36, v34
    v_fma_f32 v198, v198, v36, v34
    v_fma_f32 v199, v199, v36, v34
    v_mul_f32 v196, v196, v132
    v_mul_f32 v197, v197, v133
    v_mul_f32 v198, v198, v134
    v_mfma_f32_32x32x16_bf16 v[144:159], v[100:103], a[60:63], v[144:159]
    ds_read_b128 v[96:99], v2 offset:22528
    v_mul_f32 v199, v199, v135
    v_exp_f32 v196, v196
    v_mul_f32 v132, v132, v140
    v_exp_f32 v197, v197
    s_waitcnt lgkmcnt(3)
    v_mfma_f32_32x32x16_bf16 v[144:159], v[104:107], a[64:67], v[144:159]
    buffer_load_dwordx4 v1, s[8:11], s60 offen offset:1024 sc1 lds
    ds_read_b128 v[100:103], v2 offset:23552
    v_mul_f32 v133, v133, v141
    v_mfma_f32_32x32x16_bf16 v[144:159], v[108:111], a[68:71], v[144:159]
    ds_read_b128 v[104:107], v2 offset:24576
    v_exp_f32 v198, v198
    v_mul_f32 v134, v134, v142
    v_exp_f32 v199, v199
    v_mul_f32 v135, v135, v143
    v_fma_f32 v196, v196, v38, v38
    v_mfma_f32_32x32x16_bf16 v[144:159], v[80:83], a[72:75], v[144:159]
    ds_read_b128 v[108:111], v2 offset:25600
    v_fma_f32 v197, v197, v38, v38
    v_fma_f32 v198, v198, v38, v38
    v_fma_f32 v199, v199, v38, v38
    v_rcp_f32 v196, v196
    v_rcp_f32 v197, v197
    v_mfma_f32_32x32x16_bf16 v[144:159], v[84:87], a[76:79], v[144:159]
    ds_read_b128 v[80:83], v2 offset:26624
    v_rcp_f32 v198, v198
    v_rcp_f32 v199, v199
    v_mul_f32 v132, v132, v196
    v_mul_f32 v133, v133, v197
    s_waitcnt lgkmcnt(3)
    v_mfma_f32_32x32x16_bf16 v[144:159], v[88:91], a[80:83], v[144:159]
    buffer_load_dwordx4 v1, s[8:11], s60 offen offset:2048 sc1 lds
    ds_read_b128 v[84:87], v2 offset:27648
    s_waitcnt vmcnt(6)
    s_add_u32 s57, s44, 3
L_chk_53:
    v_cmp_gt_u32 vcc, s57, v26
    s_nop 0
    s_cbranch_vccnz L_spin_52
    v_mfma_f32_32x32x16_bf16 v[144:159], v[92:95], a[84:87], v[144:159]
    ds_read_b128 v[88:91], v2 offset:28672
    s_xor_b32 s59, s75, 1024
    v_mul_f32 v134, v134, v198
    v_mul_f32 v135, v135, v199
    v_cvt_pk_bf16_f32 v206, v132, v133
    v_cvt_pk_bf16_f32 v207, v134, v135
    s_add_u32 s76, s75, 81920
    v_mfma_f32_32x32x16_bf16 v[144:159], v[96:99], a[88:91], v[144:159]
    buffer_load_dwordx4 a[4:7], v1, s[4:7], s59 offen sc1
    ds_read_b128 v[92:95], v2 offset:29696
    s_xor_b32 s59, s75, 2048
    v_mfma_f32_32x32x16_bf16 v[144:159], v[100:103], a[92:95], v[144:159]
    buffer_load_dwordx4 a[8:11], v1, s[4:7], s59 offen sc1
    ds_read_b128 v[96:99], v2 offset:30720
    s_xor_b32 s59, s75, 3072
    s_waitcnt lgkmcnt(3)
    v_mfma_f32_32x32x16_bf16 v[144:159], v[104:107], a[96:99], v[144:159]
    buffer_load_dwordx4 a[12:15], v1, s[4:7], s59 offen sc1
    ds_read_b128 v[100:103], v2 offset:31744
    s_xor_b32 s59, s75, 4096
    v_mfma_f32_32x32x16_bf16 v[144:159], v[108:111], a[100:103], v[144:159]
    buffer_load_dwordx4 a[16:19], v1, s[4:7], s59 offen sc1
    s_xor_b32 s59, s75, 5120
    s_barrier
    v_mfma_f32_32x32x16_bf16 v[144:159], v[80:83], a[104:107], v[144:159]
    buffer_load_dwordx4 a[20:23], v1, s[4:7], s59 offen sc1
    s_xor_b32 s59, s75, 6144
    v_mfma_f32_32x32x16_bf16 v[144:159], v[84:87], a[108:111], v[144:159]
    buffer_load_dwordx4 a[24:27], v1, s[4:7], s59 offen sc1
    s_xor_b32 s59, s75, 7168
    s_waitcnt lgkmcnt(0)
    v_mfma_f32_32x32x16_bf16 v[144:159], v[88:91], a[112:115], v[144:159]
    buffer_load_dwordx4 a[28:31], v1, s[4:7], s59 offen sc1
    s_xor_b32 s59, s75, 17408
    buffer_load_dword v27, v5, s[8:11], s81 offen sc1
    v_mfma_f32_32x32x16_bf16 v[144:159], v[92:95], a[116:119], v[144:159]
    buffer_load_dwordx4 a[36:39], v1, s[4:7], s59 offen sc1
    v_mfma_f32_32x32x16_bf16 v[144:159], v[96:99], a[120:123], v[144:159]
    buffer_store_dwordx4 v[204:207], v1, s[4:7], s76 offen sc1
    v_mfma_f32_32x32x16_bf16 v[144:159], v[100:103], a[124:127], v[144:159]
    buffer_load_dwordx4 v1, s[8:11], s60 offen offset:3072 sc1 lds
    v_mfma_f32_32x32x16_bf16 v[144:159], a[142:145], v[42:45], v[144:159]
    ds_read_b128 v[80:83], v1 offset:0
    ds_read_b128 v[84:87], v1 offset:1024
    ds_read_b128 v[88:91], v1 offset:2048
    ds_read_b128 v[92:95], v1 offset:3072
    ds_read_b128 v[96:99], v1 offset:4096
    ds_read_b128 v[100:103], v1 offset:5120
    s_nop 5
    v_mul_f32 v192, v144, v144
    v_mul_f32 v193, v145, v145
    v_mul_f32 v194, v146, v146
    v_mul_f32 v195, v147, v147
    v_fma_f32 v192, v192, v36, v34
    v_fma_f32 v193, v193, v36, v34
    v_fma_f32 v194, v194, v36, v34
    v_fma_f32 v195, v195, v36, v34
    v_mul_f32 v192, v192, v144
    v_mul_f32 v193, v193, v145
    v_mul_f32 v194, v194, v146
    v_mul_f32 v195, v195, v147
    v_exp_f32 v192, v192
    v_mul_f32 v144, v144, v152
    v_exp_f32 v193, v193
    v_mul_f32 v145, v145, v153
    v_exp_f32 v194, v194
    v_mul_f32 v146, v146, v154
    v_exp_f32 v195, v195
    v_mul_f32 v147, v147, v155
    v_fma_f32 v192, v192, v38, v38
    v_fma_f32 v193, v193, v38, v38
    v_fma_f32 v194, v194, v38, v38
    v_fma_f32 v195, v195, v38, v38
    v_rcp_f32 v192, v192
    v_rcp_f32 v193, v193
    v_rcp_f32 v194, v194
    v_rcp_f32 v195, v195
    v_mul_f32 v144, v144, v192
    v_mul_f32 v145, v145, v193
    v_mul_f32 v146, v146, v194
    v_mul_f32 v147, v147, v195
    s_waitcnt lgkmcnt(4)
    v_mfma_f32_32x32x16_bf16 v[112:127], v[84:87], v[176:179], 0
    s_xor_b32 s59, s75, 18432
    buffer_load_dwordx4 a[40:43], v1, s[4:7], s59 offen sc1
    ds_read_b128 v[104:107], v1 offset:6144
    s_add_u32 m0, s56, 147456
    s_add_u32 s60, s63, 81920
    v_mfma_f32_32x32x16_bf16 v[48:63], v[80:83], v[176:179], v[48:63]
    buffer_load_dwordx4 v1, s[8:11], s60 offen sc1 lds
    ds_read_b128 v[108:111], v1 offset:7168
    s_xor_b32 s59, s75, 19456
    s_waitcnt vmcnt(12) lgkmcnt(4)
    v_mfma_f32_32x32x16_bf16 v[112:127], v[92:95], a[4:7], v[112:127]
    buffer_load_dwordx4 a[44:47], v1, s[4:7], s59 offen sc1
    ds_read_b128 v[80:83], v1 offset:8192
    v_cvt_pk_bf16_f32 v208, v144, v145
    v_cvt_pk_bf16_f32 v209, v146, v147
    v_mfma_f32_32x32x16_bf16 v[48:63], v[88:91], a[4:7], v[48:63]
    ds_read_b128 v[84:87], v1 offset:9216
    s_xor_b32 s59, s75, 20480
    v_mul_f32 v196, v148, v148
    v_mul_f32 v197, v149, v149
    v_mul_f32 v198, v150, v150
    v_mul_f32 v199, v151, v151
    v_fma_f32 v196, v196, v36, v34
    v_fma_f32 v197, v197, v36, v34
    s_waitcnt vmcnt(12) lgkmcnt(4)
    v_mfma_f32_32x32x16_bf16 v[112:127], v[100:103], a[8:11], v[112:127]
    buffer_load_dwordx4 a[48:51], v1, s[4:7], s59 offen sc1
    ds_read_b128 v[88:91], v1 offset:10240
    v_fma_f32 v198, v198, v36, v34
    v_fma_f32 v199, v199, v36, v34
    v_mfma_f32_32x32x16_bf16 v[48:63], v[96:99], a[8:11], v[48:63]
    buffer_load_dwordx4 v1, s[8:11], s60 offen offset:1024 sc1 lds
    ds_read_b128 v[92:95], v1 offset:11264
    s_xor_b32 s59, s75, 21504
    s_waitcnt vmcnt(13) lgkmcnt(4)
    v_mfma_f32_32x32x16_bf16 v[112:127], v[108:111], a[12:15], v[112:127]
    buffer_load_dwordx4 a[52:55], v1, s[4:7], s59 offen sc1
    ds_read_b128 v[96:99], v1 offset:12288
    v_mul_f32 v196, v196, v148
    v_mul_f32 v197, v197, v149
    v_mfma_f32_32x32x16_bf16 v[48:63], v[104:107], a[12:15], v[48:63]
    ds_read_b128 v[100:103], v1 offset:13312
    s_xor_b32 s59, s75, 22528
    v_mul_f32 v198, v198, v150
    v_mul_f32 v199, v199, v151
    v_exp_f32 v196, v196
    v_mul_f32 v148, v148, v156
    s_waitcnt vmcnt(13) lgkmcnt(4)
    v_mfma_f32_32x32x16_bf16 v[112:127], v[84:87], a[16:19], v[112:127]
    buffer_load_dwordx4 a[56:59], v1, s[4:7], s59 offen sc1
    ds_read_b128 v[104:107], v1 offset:14336
    v_exp_f32 v197, v197
    v_mfma_f32_32x32x16_bf16 v[48:63], v[80:83], a[16:19], v[48:63]
    buffer_load_dwordx4 v1, s[8:11], s60 offen offset:2048 sc1 lds
    ds_read_b128 v[108:111], v1 offset:15360
    s_xor_b32 s59, s75, 23552
    s_waitcnt vmcnt(14) lgkmcnt(4)
    v_mfma_f32_32x32x16_bf16 v[112:127], v[92:95], a[20:23], v[112:127]
    buffer_load_dwordx4 a[60:63], v1, s[4:7], s59 offen sc1
    ds_read_b128 v[80:83], v1 offset:16384
    v_mul_f32 v149, v149, v157
    v_mfma_f32_32x32x16_bf16 v[48:63], v[88:91], a[20:23], v[48:63]
    ds_read_b128 v[84:87], v1 offset:17408
    v_exp_f32 v198, v198
    v_mul_f32 v150, v150, v158
    v_exp_f32 v199, v199
    v_mul_f32 v151, v151, v159
    v_fma_f32 v196, v196, v38, v38
    s_waitcnt vmcnt(14) lgkmcnt(4)
    v_mfma_f32_32x32x16_bf16 v[112:127], v[100:103], a[24:27], v[112:127]
    ds_read_b128 v[88:91], v1 offset:18432
    v_fma_f32 v197, v197, v38, v38
    v_fma_f32 v198, v198, v38, v38
    v_fma_f32 v199, v199, v38, v38
    v_rcp_f32 v196, v196
    v_rcp_f32 v197, v197
    v_mfma_f32_32x32x16_bf16 v[48:63], v[96:99], a[24:27], v[48:63]
    buffer_load_dwordx4 v1, s[8:11], s60 offen offset:3072 sc1 lds
    ds_read_b128 v[92:95], v1 offset:19456
    s_xor_b32 s59, s75, 33792
    s_waitcnt vmcnt(14) lgkmcnt(4)
    s_waitcnt vmcnt(13)
    s_add_u32 s57, s44, 5
L_chk_55:
    v_cmp_gt_u32 vcc, s57, v27
    s_nop 0
    s_cbranch_vccnz L_spin_54
    v_mfma_f32_32x32x16_bf16 v[112:127], v[108:111], a[28:31], v[112:127]
    buffer_load_dwordx4 a[4:7], v1, s[4:7], s59 offen sc1
    ds_read_b128 v[96:99], v1 offset:20480
    v_rcp_f32 v198, v198
    v_mfma_f32_32x32x16_bf16 v[48:63], v[104:107], a[28:31], v[48:63]
    ds_read_b128 v[100:103], v1 offset:21504
    s_xor_b32 s59, s75, 34816
    s_waitcnt lgkmcnt(4)
    v_add_u32 v28, 7, v24
    s_mov_b64 exec, 1
    s_cmp_eq_u32 s53, 0
    s_cbranch_scc1 L_dev_56
    s_waitcnt vmcnt(12)
    buffer_store_dword v28, off, s[8:11], s82
L_sg_57:
    s_mov_b64 exec, -1
    v_mfma_f32_32x32x16_bf16 v[112:127], v[84:87], v[180:183], v[112:127]
    buffer_load_dwordx4 a[8:11], v1, s[4:7], s59 offen sc1
    ds_read_b128 v[104:107], v1 offset:22528
    s_add_u32 m0, s56, 32768
    s_add_u32 s60, s63, 98304
    v_mfma_f32_32x32x16_bf16 v[48:63], v[80:83], v[180:183], v[48:63]
    buffer_load_dwordx4 v1, s[8:11], s60 offen sc1 lds
    ds_read_b128 v[108:111], v1 offset:23552
    s_xor_b32 s59, s75, 35840
    s_waitcnt lgkmcnt(4)
    v_mfma_f32_32x32x16_bf16 v[112:127], v[92:95], a[36:39], v[112:127]
    buffer_load_dwordx4 a[12:15], v1, s[4:7], s59 offen sc1
    ds_read_b128 v[80:83], v1 offset:24576
    v_rcp_f32 v199, v199
    v_mfma_f32_32x32x16_bf16 v[48:63], v[88:91], a[36:39], v[48:63]
    ds_read_b128 v[84:87], v1 offset:25600
    s_xor_b32 s59, s75, 36864
    v_mul_f32 v148, v148, v196
    v_mul_f32 v149, v149, v197
    v_mul_f32 v150, v150, v198
    v_mul_f32 v151, v151, v199
    v_cvt_pk_bf16_f32 v210, v148, v149
    v_cvt_pk_bf16_f32 v211, v150, v151
    s_waitcnt vmcnt(14) lgkmcnt(4)
    v_mfma_f32_32x32x16_bf16 v[112:127], v[100:103], a[40:43], v[112:127]
    buffer_load_dwordx4 a[16:19], v1, s[4:7], s59 offen sc1
    ds_read_b128 v[88:91], v1 offset:26624
    s_add_u32 s76, s75, 98304
    v_mfma_f32_32x32x16_bf16 v[48:63], v[96:99], a[40:43], v[48:63]
    buffer_load_dwordx4 v1, s[8:11], s60 offen offset:1024 sc1 lds
    ds_read_b128 v[92:95], v1 offset:27648
    s_xor_b32 s59, s75, 37888
    s_waitcnt vmcnt(14) lgkmcnt(4)
    v_mfma_f32_32x32x16_bf16 v[112:127], v[108:111], a[44:47], v[112:127]
    buffer_load_dwordx4 a[20:23], v1, s[4:7], s59 offen sc1
    ds_read_b128 v[96:99], v1 offset:28672
    v_mfma_f32_32x32x16_bf16 v[48:63], v[104:107], a[44:47], v[48:63]
    buffer_store_dwordx4 v[208:211], v1, s[4:7], s76 offen sc1
    ds_read_b128 v[100:103], v1 offset:29696
    s_xor_b32 s59, s75, 38912
    s_waitcnt vmcnt(15) lgkmcnt(4)
    s_barrier
    v_mfma_f32_32x32x16_bf16 v[112:127], v[84:87], a[48:51], v[112:127]
    buffer_load_dwordx4 a[24:27], v1, s[4:7], s59 offen sc1
    ds_read_b128 v[104:107], v1 offset:30720
    v_mfma_f32_32x32x16_bf16 v[48:63], v[80:83], a[48:51], v[48:63]
    buffer_load_dwordx4 v1, s[8:11], s60 offen offset:2048 sc1 lds
    ds_read_b128 v[108:111], v1 offset:31744
    s_xor_b32 s59, s75, 39936
    s_waitcnt vmcnt(15) lgkmcnt(4)
    v_mfma_f32_32x32x16_bf16 v[112:127], v[92:95], a[52:55], v[112:127]
    buffer_load_dwordx4 a[28:31], v1, s[4:7], s59 offen sc1
    ds_read_b128 v[80:83], v2 offset:32768
    v_mfma_f32_32x32x16_bf16 v[48:63], v[88:91], a[52:55], v[48:63]
    ds_read_b128 v[84:87], v2 offset:33792
    ds_write_b128 v35, a[216:219] offset:0
    s_waitcnt vmcnt(15) lgkmcnt(5)
    buffer_load_dword v26, v5, s[8:11], s81 offen sc1
    v_mfma_f32_32x32x16_bf16 v[112:127], v[100:103], a[56:59], v[112:127]
    ds_read_b128 v[88:91], v2 offset:34816
    v_mfma_f32_32x32x16_bf16 v[48:63], v[96:99], a[56:59], v[48:63]
    buffer_load_dwordx4 v1, s[8:11], s60 offen offset:3072 sc1 lds
    ds_read_b128 v[92:95], v2 offset:35840
    ds_read_b128 a[216:219], v33 offset:0
    s_xor_b32 s59, s75, 50176
    s_waitcnt vmcnt(15) lgkmcnt(6)
    v_mfma_f32_32x32x16_bf16 v[112:127], v[108:111], a[60:63], v[112:127]
    buffer_load_dwordx4 a[36:39], v1, s[4:7], s59 offen sc1
    ds_read_b128 v[96:99], v2 offset:36864
    v_mfma_f32_32x32x16_bf16 v[48:63], v[104:107], a[60:63], v[48:63]
    ds_read_b128 v[100:103], v2 offset:37888
    ds_write_b128 v35, a[220:223] offset:4096
    s_xor_b32 s59, s75, 51200
    s_waitcnt lgkmcnt(7)
    v_mfma_f32_32x32x16_bf16 v[112:127], v[84:87], v[184:187], v[112:127]
    buffer_load_dwordx4 a[40:43], v1, s[4:7], s59 offen sc1
    ds_read_b128 v[104:107], v2 offset:38912
    v_mfma_f32_32x32x16_bf16 v[48:63], v[80:83], v[184:187], v[48:63]
    ds_read_b128 v[108:111], v2 offset:39936
    ds_read_b128 a[220:223], v33 offset:4096
    s_xor_b32 s59, s75, 52224
    s_waitcnt vmcnt(15) lgkmcnt(7)
    v_mfma_f32_32x32x16_bf16 v[112:127], v[92:95], a[4:7], v[112:127]
    buffer_load_dwordx4 a[44:47], v1, s[4:7], s59 offen sc1
    ds_read_b128 v[80:83], v2 offset:40960
    v_mfma_f32_32x32x16_bf16 v[48:63], v[88:91], a[4:7], v[48:63]
    ds_read_b128 v[84:87], v2 offset:41984
    ds_write_b128 v35, a[224:227] offset:8192
    s_xor_b32 s59, s75, 53248
    s_waitcnt vmcnt(14) lgkmcnt(7)
    v_mfma_f32_32x32x16_bf16 v[112:127], v[100:103], a[8:11], v[112:127]
    buffer_load_dwordx4 a[48:51], v1, s[4:7], s59 offen sc1
    ds_read_b128 v[88:91], v2 offset:43008
    v_mfma_f32_32x32x16_bf16 v[48:63], v[96:99], a[8:11], v[48:63]
    ds_read_b128 v[92:95], v2 offset:44032
    ds_read_b128 a[224:227], v33 offset:8192
    s_xor_b32 s59, s75, 54272
    s_waitcnt vmcnt(13) lgkmcnt(7)
    v_mfma_f32_32x32x16_bf16 v[112:127], v[108:111], a[12:15], v[112:127]
    buffer_load_dwordx4 a[52:55], v1, s[4:7], s59 offen sc1
    ds_read_b128 v[96:99], v2 offset:45056
    v_mfma_f32_32x32x16_bf16 v[48:63], v[104:107], a[12:15], v[48:63]
    ds_read_b128 v[100:103], v2 offset:46080
    ds_write_b128 v35, a[228:231] offset:12288
    s_xor_b32 s59, s75, 55296
    s_waitcnt vmcnt(13) lgkmcnt(7)
    v_mfma_f32_32x32x16_bf16 v[112:127], v[84:87], a[16:19], v[112:127]
    buffer_load_dwordx4 a[56:59], v1, s[4:7], s59 offen sc1
    ds_read_b128 v[104:107], v2 offset:47104
    v_mfma_f32_32x32x16_bf16 v[48:63], v[80:83], a[16:19], v[48:63]
    ds_read_b128 v[108:111], v2 offset:48128
    ds_read_b128 a[228:231], v33 offset:12288
    s_xor_b32 s59, s75, 56320
    s_waitcnt vmcnt(12) lgkmcnt(7)
    v_mfma_f32_32x32x16_bf16 v[112:127], v[92:95], a[20:23], v[112:127]
    buffer_load_dwordx4 a[60:63], v1, s[4:7], s59 offen sc1
    ds_read_b128 v[80:83], v2 offset:49152
    v_mfma_f32_32x32x16_bf16 v[48:63], v[88:91], a[20:23], v[48:63]
    ds_read_b128 v[84:87], v2 offset:50176
    ds_write_b128 v35, a[232:235] offset:16384
    s_waitcnt vmcnt(11) lgkmcnt(7)
    v_add_u32 v28, 8, v24
    s_mov_b64 exec, 1
    s_cmp_eq_u32 s53, 0
    s_cbranch_scc1 L_dev_58
    buffer_store_dword v28, off, s[8:11], s82
L_sg_59:
    s_mov_b64 exec, -1
    v_mfma_f32_32x32x16_bf16 v[112:127], v[100:103], a[24:27], v[112:127]
    ds_read_b128 v[88:91], v2 offset:51200
    v_mfma_f32_32x32x16_bf16 v[48:63], v[96:99], a[24:27], v[48:63]
    ds_read_b128 v[92:95], v2 offset:52224
    ds_read_b128 a[232:235], v33 offset:16384
    s_xor_b32 s59, s75, 66560
    s_waitcnt vmcnt(10) lgkmcnt(7)
    s_waitcnt vmcnt(9)
    s_add_u32 s57, s44, 7
L_chk_61:
    v_cmp_gt_u32 vcc, s57, v26
    s_nop 0
    s_cbranch_vccnz L_spin_60
    v_mfma_f32_32x32x16_bf16 v[112:127], v[108:111], a[28:31], v[112:127]
    buffer_load_dwordx4 a[4:7], v1, s[4:7], s59 offen sc1
    ds_read_b128 v[96:99], v2 offset:53248
    v_mfma_f32_32x32x16_bf16 v[48:63], v[104:107], a[28:31], v[48:63]
    ds_read_b128 v[100:103], v2 offset:54272
    ds_write_b128 v35, a[236:239] offset:20480
    s_xor_b32 s59, s75, 67584
    s_waitcnt lgkmcnt(7)
    v_mfma_f32_32x32x16_bf16 v[112:127], v[84:87], v[188:191], v[112:127]
    buffer_load_dwordx4 a[8:11], v1, s[4:7], s59 offen sc1
    ds_read_b128 v[104:107], v2 offset:55296
    v_mfma_f32_32x32x16_bf16 v[48:63], v[80:83], v[188:191], v[48:63]
    ds_read_b128 v[108:111], v2 offset:56320
    ds_read_b128 a[236:239], v33 offset:20480
    s_xor_b32 s59, s75, 68608
    s_waitcnt vmcnt(9) lgkmcnt(7)
    v_mfma_f32_32x32x16_bf16 v[112:127], v[92:95], a[36:39], v[112:127]
    buffer_load_dwordx4 a[12:15], v1, s[4:7], s59 offen sc1
    ds_read_b128 v[80:83], v2 offset:57344
    v_mfma_f32_32x32x16_bf16 v[48:63], v[88:91], a[36:39], v[48:63]
    ds_read_b128 v[84:87], v2 offset:58368
    ds_write_b128 v35, a[240:243] offset:24576
    s_xor_b32 s59, s75, 69632
    s_waitcnt vmcnt(9) lgkmcnt(7)
    v_mfma_f32_32x32x16_bf16 v[112:127], v[100:103], a[40:43], v[112:127]
    buffer_load_dwordx4 a[16:19], v1, s[4:7], s59 offen sc1
    ds_read_b128 v[88:91], v2 offset:59392
    v_mfma_f32_32x32x16_bf16 v[48:63], v[96:99], a[40:43], v[48:63]
    ds_read_b128 v[92:95], v2 offset:60416
    ds_read_b128 a[240:243], v33 offset:24576
    s_xor_b32 s59, s75, 70656
    s_waitcnt vmcnt(9) lgkmcnt(7)
    v_mfma_f32_32x32x16_bf16 v[112:127], v[108:111], a[44:47], v[112:127]
    buffer_load_dwordx4 a[20:23], v1, s[4:7], s59 offen sc1
    ds_read_b128 v[96:99], v2 offset:61440
    v_mfma_f32_32x32x16_bf16 v[48:63], v[104:107], a[44:47], v[48:63]
    ds_read_b128 v[100:103], v2 offset:62464
    ds_write_b128 v35, a[244:247] offset:28672
    s_xor_b32 s59, s75, 71680
    s_waitcnt vmcnt(9) lgkmcnt(7)
    s_barrier
    v_mfma_f32_32x32x16_bf16 v[112:127], v[84:87], a[48:51], v[112:127]
    buffer_load_dwordx4 a[24:27], v1, s[4:7], s59 offen sc1
    ds_read_b128 v[104:107], v2 offset:63488
    v_mfma_f32_32x32x16_bf16 v[48:63], v[80:83], a[48:51], v[48:63]
    ds_read_b128 v[108:111], v2 offset:64512
    ds_read_b128 a[244:247], v33 offset:28672
    s_xor_b32 s59, s75, 72704
    s_waitcnt vmcnt(9) lgkmcnt(7)
    v_mfma_f32_32x32x16_bf16 v[112:127], v[92:95], a[52:55], v[112:127]
    buffer_load_dwordx4 a[28:31], v1, s[4:7], s59 offen sc1
    ds_read_b128 v[80:83], v3 offset:0
    v_mfma_f32_32x32x16_bf16 v[48:63], v[88:91], a[52:55], v[48:63]
    ds_read_b128 v[84:87], v3 offset:1024
    s_waitcnt vmcnt(9) lgkmcnt(6)
    buffer_load_dword v27, v5, s[8:11], s81 offen sc1
    v_mfma_f32_32x32x16_bf16 v[112:127], v[100:103], a[56:59], v[112:127]
    ds_read_b128 v[88:91], v3 offset:2048
    v_mfma_f32_32x32x16_bf16 v[48:63], v[96:99], a[56:59], v[48:63]
    ds_read_b128 v[92:95], v3 offset:3072
    ds_write_b128 v33, a[152:155] offset:0
    s_xor_b32 s59, s75, 82944
    s_waitcnt vmcnt(9) lgkmcnt(6)
    v_mfma_f32_32x32x16_bf16 v[112:127], v[108:111], a[60:63], v[112:127]
    buffer_load_dwordx4 a[36:39], v1, s[4:7], s59 offen sc1
    ds_read_b128 v[96:99], v3 offset:4096
    v_mfma_f32_32x32x16_bf16 v[48:63], v[104:107], a[60:63], v[48:63]
    ds_read_b128 v[100:103], v3 offset:5120
    ds_read_b128 a[152:155], v35 offset:32768
    s_xor_b32 s59, s75, 83968
    s_waitcnt lgkmcnt(6)
    v_mfma_f32_32x32x16_bf16 v[112:127], v[84:87], v[200:203], v[112:127]
    buffer_load_dwordx4 a[40:43], v1, s[4:7], s59 offen sc1
    ds_read_b128 v[104:107], v3 offset:6144
    v_mfma_f32_32x32x16_bf16 v[48:63], v[80:83], v[200:203], v[48:63]
    ds_read_b128 v[108:111], v3 offset:7168
    ds_write_b128 v33, a[156:159] offset:4096
    s_xor_b32 s59, s75, 84992
    s_waitcnt vmcnt(9) lgkmcnt(7)
    v_mfma_f32_32x32x16_bf16 v[112:127], v[92:95], a[4:7], v[112:127]
    buffer_load_dwordx4 a[44:47], v1, s[4:7], s59 offen sc1
    ds_read_b128 v[80:83], v3 offset:8192
    v_mfma_f32_32x32x16_bf16 v[48:63], v[88:91], a[4:7], v[48:63]
    ds_read_b128 v[84:87], v3 offset:9216
    ds_read_b128 a[156:159], v35 offset:36864
    s_xor_b32 s59, s75, 86016
    s_waitcnt vmcnt(9) lgkmcnt(7)
    v_mfma_f32_32x32x16_bf16 v[112:127], v[100:103], a[8:11], v[112:127]
    buffer_load_dwordx4 a[48:51], v1, s[4:7], s59 offen sc1
    ds_read_b128 v[88:91], v3 offset:10240
    v_mfma_f32_32x32x16_bf16 v[48:63], v[96:99], a[8:11], v[48:63]
    ds_read_b128 v[92:95], v3 offset:11264
    ds_write_b128 v33, a[160:163] offset:8192
    s_xor_b32 s59, s75, 87040
    s_waitcnt vmcnt(9) lgkmcnt(7)
    v_mfma_f32_32x32x16_bf16 v[112:127], v[108:111], a[12:15], v[112:127]
    buffer_load_dwordx4 a[52:55], v1, s[4:7], s59 offen sc1
    ds_read_b128 v[96:99], v3 offset:12288
    v_mfma_f32_32x32x16_bf16 v[48:63], v[104:107], a[12:15], v[48:63]
    ds_read_b128 v[100:103], v3 offset:13312
    ds_read_b128 a[160:163], v35 offset:40960
    s_xor_b32 s59, s75, 88064
    s_waitcnt vmcnt(9) lgkmcnt(7)
    s_add_u32 s60, s80, 0
    buffer_load_dword v21, v4, s[4:7], s60 offen sc1
    s_getpc_b64 s[46:47]
L_pc_62:
    s_lshr_b32 s57, s2, 3
    s_lshl_b32 s57, s57, 11
    v_lshrrev_b32 v29, 4, v0
    v_lshl_add_u32 v29, v29, 7, s57
    v_min_u32 v29, L_code_end-L_pc_62-4, v29
    global_load_dword v21, v29, s[46:47]
    v_mfma_f32_32x32x16_bf16 v[112:127], v[84:87], a[16:19], v[112:127]
    buffer_load_dwordx4 a[56:59], v1, s[4:7], s59 offen sc1
    ds_read_b128 v[104:107], v3 offset:14336
    v_mfma_f32_32x32x16_bf16 v[48:63], v[80:83], a[16:19], v[48:63]
    ds_read_b128 v[108:111], v3 offset:15360
    ds_write_b128 v33, a[164:167] offset:12288
    s_xor_b32 s59, s75, 89088
    s_waitcnt vmcnt(11) lgkmcnt(7)
    v_mfma_f32_32x32x16_bf16 v[112:127], v[92:95], a[20:23], v[112:127]
    buffer_load_dwordx4 a[60:63], v1, s[4:7], s59 offen sc1
    ds_read_b128 v[80:83], v3 offset:16384
    v_mfma_f32_32x32x16_bf16 v[48:63], v[88:91], a[20:23], v[48:63]
    ds_read_b128 v[84:87], v3 offset:17408
    ds_read_b128 a[164:167], v35 offset:45056
    s_waitcnt vmcnt(11) lgkmcnt(7)
    v_mfma_f32_32x32x16_bf16 v[112:127], v[100:103], a[24:27], v[112:127]
    ds_read_b128 v[88:91], v3 offset:18432
    v_mfma_f32_32x32x16_bf16 v[48:63], v[96:99], a[24:27], v[48:63]
    ds_read_b128 v[92:95], v3 offset:19456
    ds_write_b128 v33, a[168:171] offset:16384
    s_xor_b32 s59, s75, 99328
    s_waitcnt vmcnt(10) lgkmcnt(7)
    s_waitcnt vmcnt(9)
    s_add_u32 s57, s44, 8
L_chk_64:
    v_cmp_gt_u32 vcc, s57, v27
    s_nop 0
    s_cbranch_vccnz L_spin_63
    v_mfma_f32_32x32x16_bf16 v[112:127], v[108:111], a[28:31], v[112:127]
    buffer_load_dwordx4 a[4:7], v1, s[4:7], s59 offen sc1
    ds_read_b128 v[96:99], v3 offset:20480
    v_mfma_f32_32x32x16_bf16 v[48:63], v[104:107], a[28:31], v[48:63]
    ds_read_b128 v[100:103], v3 offset:21504
    ds_read_b128 a[168:171], v35 offset:49152
    s_xor_b32 s59, s75, 100352
    s_waitcnt lgkmcnt(7)
    v_mfma_f32_32x32x16_bf16 v[112:127], v[84:87], v[204:207], v[112:127]
    buffer_load_dwordx4 a[8:11], v1, s[4:7], s59 offen sc1
    ds_read_b128 v[104:107], v3 offset:22528
    v_mfma_f32_32x32x16_bf16 v[48:63], v[80:83], v[204:207], v[48:63]
    ds_read_b128 v[108:111], v3 offset:23552
    ds_write_b128 v33, a[172:175] offset:20480
    s_xor_b32 s59, s75, 101376
    s_waitcnt vmcnt(10) lgkmcnt(7)
    v_mfma_f32_32x32x16_bf16 v[112:127], v[92:95], a[36:39], v[112:127]
    buffer_load_dwordx4 a[12:15], v1, s[4:7], s59 offen sc1
    ds_read_b128 v[80:83], v3 offset:24576
    v_mfma_f32_32x32x16_bf16 v[48:63], v[88:91], a[36:39], v[48:63]
    ds_read_b128 v[84:87], v3 offset:25600
L_page_5:
    s_cbranch_execz L_page_9
    ds_read_b128 a[172:175], v35 offset:53248
    s_xor_b32 s59, s75, 102400
    s_waitcnt vmcnt(10) lgkmcnt(7)
    v_mfma_f32_32x32x16_bf16 v[112:127], v[100:103], a[40:43], v[112:127]
    buffer_load_dwordx4 a[16:19], v1, s[4:7], s59 offen sc1
    ds_read_b128 v[88:91], v3 offset:26624
    v_mfma_f32_32x32x16_bf16 v[48:63], v[96:99], a[40:43], v[48:63]
    ds_read_b128 v[92:95], v3 offset:27648
    ds_write_b128 v33, a[176:179] offset:24576
    s_xor_b32 s59, s75, 103424
    s_waitcnt vmcnt(10) lgkmcnt(7)
    v_mfma_f32_32x32x16_bf16 v[112:127], v[108:111], a[44:47], v[112:127]
    buffer_load_dwordx4 a[20:23], v1, s[4:7], s59 offen sc1
    ds_read_b128 v[96:99], v3 offset:28672
    v_mfma_f32_32x32x16_bf16 v[48:63], v[104:107], a[44:47], v[48:63]
    ds_read_b128 v[100:103], v3 offset:29696
    ds_read_b128 a[176:179], v35 offset:57344
    s_xor_b32 s59, s75, 104448
    s_waitcnt vmcnt(10) lgkmcnt(7)
    v_mfma_f32_32x32x16_bf16 v[112:127], v[84:87], a[48:51], v[112:127]
    buffer_load_dwordx4 a[24:27], v1, s[4:7], s59 offen sc1
    ds_read_b128 v[104:107], v3 offset:30720
    v_mfma_f32_32x32x16_bf16 v[48:63], v[80:83], a[48:51], v[48:63]
    ds_read_b128 v[108:111], v3 offset:31744
    ds_write_b128 v33, a[180:183] offset:28672
    s_xor_b32 s59, s75, 105472
    s_waitcnt vmcnt(10) lgkmcnt(7)
    v_mfma_f32_32x32x16_bf16 v[112:127], v[92:95], a[52:55], v[112:127]
    buffer_load_dwordx4 a[28:31], v1, s[4:7], s59 offen sc1
    ds_read_b128 v[80:83], v1 offset:32768
    v_mfma_f32_32x32x16_bf16 v[48:63], v[88:91], a[52:55], v[48:63]
    ds_read_b128 v[84:87], v1 offset:33792
    ds_read_b128 a[180:183], v35 offset:61440
    s_waitcnt vmcnt(8) lgkmcnt(7)
    v_mfma_f32_32x32x16_bf16 v[112:127], v[100:103], a[56:59], v[112:127]
    ds_read_b128 v[88:91], v1 offset:34816
    v_mfma_f32_32x32x16_bf16 v[48:63], v[96:99], a[56:59], v[48:63]
    ds_read_b128 v[92:95], v1 offset:35840
    s_waitcnt vmcnt(7) lgkmcnt(6)
    v_mfma_f32_32x32x16_bf16 v[112:127], v[108:111], a[60:63], v[112:127]
    ds_read_b128 v[96:99], v1 offset:36864
    v_mfma_f32_32x32x16_bf16 v[48:63], v[104:107], a[60:63], v[48:63]
    ds_read_b128 v[100:103], v1 offset:37888
    s_waitcnt lgkmcnt(5)
    v_mfma_f32_32x32x16_bf16 v[112:127], v[84:87], v[208:211], v[112:127]
    ds_read_b128 v[104:107], v1 offset:38912
    v_mfma_f32_32x32x16_bf16 v[48:63], v[80:83], v[208:211], v[48:63]
    ds_read_b128 v[108:111], v1 offset:39936
    s_waitcnt vmcnt(6) lgkmcnt(4)
    v_mfma_f32_32x32x16_bf16 v[112:127], v[92:95], a[4:7], v[112:127]
    ds_read_b128 v[80:83], v1 offset:40960
    v_mfma_f32_32x32x16_bf16 v[48:63], v[88:91], a[4:7], v[48:63]
    ds_read_b128 v[84:87], v1 offset:41984
    s_waitcnt vmcnt(5) lgkmcnt(4)
    v_mfma_f32_32x32x16_bf16 v[112:127], v[100:103], a[8:11], v[112:127]
    ds_read_b128 v[88:91], v1 offset:43008
    ds_read_b128 v[92:95], v1 offset:44032
    s_waitcnt vmcnt(4) lgkmcnt(4)
    v_mfma_f32_32x32x16_bf16 v[112:127], v[108:111], a[12:15], v[112:127]
    ds_read_b128 v[100:103], v1 offset:46080
    s_waitcnt vmcnt(3) lgkmcnt(3)
    v_mfma_f32_32x32x16_bf16 v[112:127], v[84:87], a[16:19], v[112:127]
    ds_read_b128 v[108:111], v1 offset:48128
    s_waitcnt vmcnt(2) lgkmcnt(2)
    v_mfma_f32_32x32x16_bf16 v[112:127], v[92:95], a[20:23], v[112:127]
    s_waitcnt vmcnt(1) lgkmcnt(1)
    v_mfma_f32_32x32x16_bf16 v[112:127], v[100:103], a[24:27], v[112:127]
    s_waitcnt vmcnt(0) lgkmcnt(0)
    v_mfma_f32_32x32x16_bf16 v[112:127], v[108:111], a[28:31], v[112:127]
    ds_read_b128 v[92:95], v1 offset:45056
    ds_read_b128 v[100:103], v1 offset:47104
    s_nop 3
    v_mfma_f32_32x32x16_bf16 v[48:63], v[96:99], a[8:11], v[48:63]
    s_xor_b32 s59, s68, 2048
    s_nop 3
    v_cvt_pk_bf16_f32 v72, v112, v113
    v_cvt_pk_bf16_f32 v73, v114, v115
    v_cvt_pk_bf16_f32 v74, v116, v117
    v_cvt_pk_bf16_f32 v75, v118, v119
    v_min_u32 v72, -2, v72
    v_min_u32 v73, -2, v73
    v_min_u32 v74, -2, v74
    v_min_u32 v75, -2, v75
    v_cvt_pk_bf16_f32 v76, v120, v121
    v_cvt_pk_bf16_f32 v77, v122, v123
    v_cvt_pk_bf16_f32 v78, v124, v125
    v_cvt_pk_bf16_f32 v79, v126, v127
    v_min_u32 v76, -2, v76
    v_min_u32 v77, -2, v77
    v_min_u32 v78, -2, v78
    v_min_u32 v79, -2, v79
    s_cmp_eq_u32 s53, 0
    s_cbranch_scc1 L_dev_65
    buffer_store_dwordx4 v[72:75], v1, s[4:7], s59 offen offset:0
    buffer_store_dwordx4 v[76:79], v1, s[4:7], s59 offen offset:1024
L_st_66:
    v_mfma_f32_32x32x16_bf16 v[48:63], v[104:107], a[12:15], v[48:63]
    v_mfma_f32_32x32x16_bf16 v[48:63], v[80:83], a[16:19], v[48:63]
    v_mfma_f32_32x32x16_bf16 v[48:63], v[88:91], a[20:23], v[48:63]
    s_waitcnt lgkmcnt(0)
    v_mfma_f32_32x32x16_bf16 v[48:63], v[92:95], a[24:27], v[48:63]
    v_mfma_f32_32x32x16_bf16 v[48:63], v[100:103], a[28:31], v[48:63]
L_swap_67:
    buffer_load_dwordx4 v[176:179], v1, s[4:7], s68 offen offset:0 sc1
    buffer_load_dwordx4 v[180:183], v1, s[4:7], s68 offen offset:1024 sc1
    s_sub_u32 s54, s54, 1
    s_cbranch_scc1 L_abort
L_swapc_68:
    s_waitcnt vmcnt(0)
    v_max3_u32 v184, v176, v177, v178
    v_max3_u32 v185, v179, v180, v181
    v_max3_u32 v184, v182, v183, v184
    v_max_u32 v184, v184, v185
    v_cmp_eq_u32 vcc, -1, v184
    s_nop 0
    s_cbranch_vccnz L_swap_67
    v_dot2_f32_bf16 v48, v176, s87, v48
    v_dot2_f32_bf16 v49, v176, s88, v49
    v_dot2_f32_bf16 v50, v177, s87, v50
    v_dot2_f32_bf16 v51, v177, s88, v51
    v_dot2_f32_bf16 v52, v178, s87, v52
    v_dot2_f32_bf16 v53, v178, s88, v53
    v_dot2_f32_bf16 v54, v179, s87, v54
    v_dot2_f32_bf16 v55, v179, s88, v55
    v_dot2_f32_bf16 v56, v180, s87, v56
    v_dot2_f32_bf16 v57, v180, s88, v57
    v_dot2_f32_bf16 v58, v181, s87, v58
    v_dot2_f32_bf16 v59, v181, s88, v59
    v_dot2_f32_bf16 v60, v182, s87, v60
    v_dot2_f32_bf16 v61, v182, s88, v61
    v_dot2_f32_bf16 v62, v183, s87, v62
    v_dot2_f32_bf16 v63, v183, s88, v63
    v_cvt_pk_bf16_f32 v64, v48, v49
    v_cvt_pk_bf16_f32 v65, v50, v51
    v_cvt_pk_bf16_f32 v66, v52, v53
    v_cvt_pk_bf16_f32 v67, v54, v55
    v_cvt_pk_bf16_f32 v68, v56, v57
    v_cvt_pk_bf16_f32 v69, v58, v59
    v_cvt_pk_bf16_f32 v70, v60, v61
    v_cvt_pk_bf16_f32 v71, v62, v63
    s_cmp_eq_u32 s53, 0
    s_cbranch_scc1 L_dev_69
    buffer_store_dwordx4 v[64:67], v1, s[4:7], s68 offen
    buffer_store_dwordx4 v[68:71], v1, s[4:7], s68 offen offset:1024
L_st_70:
    v_dot2_f32_bf16 v176, v64, s71, 0
    v_dot2_f32_bf16 v177, v64, v64, 0
    v_dot2_f32_bf16 v176, v65, s71, v176
    v_dot2_f32_bf16 v177, v65, v65, v177
    v_dot2_f32_bf16 v176, v66, s71, v176
    v_dot2_f32_bf16 v177, v66, v66, v177
    v_dot2_f32_bf16 v176, v67, s71, v176
    v_dot2_f32_bf16 v177, v67, v67, v177
    v_dot2_f32_bf16 v176, v68, s71, v176
    v_dot2_f32_bf16 v177, v68, v68, v177
    v_dot2_f32_bf16 v176, v69, s71, v176
    v_dot2_f32_bf16 v177, v69, v69, v177
    v_dot2_f32_bf16 v176, v70, s71, v176
    v_dot2_f32_bf16 v177, v70, v70, v177
    v_dot2_f32_bf16 v176, v71, s71, v176
    v_dot2_f32_bf16 v177, v71, v71, v177
    s_nop 2
    v_permlane32_swap_b32 v176, v177
    v_add_f32 v176, v176, v177
    s_cmp_eq_u32 s53, 0
    s_cbranch_scc1 L_dev_71
    buffer_store_dword v176, v39, s[4:7], s80 offen
L_st_72:
    v_add_u32 v28, 9, v24
    s_mov_b64 exec, 1
    s_cmp_eq_u32 s53, 0
    s_cbranch_scc1 L_dev_73
    s_waitcnt vmcnt(0)
    buffer_store_dword v28, off, s[8:11], s82
L_sg_74:
    s_mov_b64 exec, -1
    s_barrier
    s_lshl_b32 s58, s52, 15
    s_add_u32 s58, s58, 0
    s_lshl_b32 s69, s52, 12
    s_add_u32 s69, s69, 262144
    ds_read_b64_tr_b16 v[80:81], v6 offset:0
    ds_read_b64_tr_b16 v[82:83], v6 offset:256
    ds_read_b64_tr_b16 v[84:85], v6 offset:1024
    ds_read_b64_tr_b16 v[86:87], v6 offset:1280
    ds_read_b64_tr_b16 v[88:89], v6 offset:2048
    ds_read_b64_tr_b16 v[90:91], v6 offset:2304
    ds_read_b64_tr_b16 v[92:93], v6 offset:3072
    ds_read_b64_tr_b16 v[94:95], v6 offset:3328
    ds_read_b64_tr_b16 v[96:97], v6 offset:4096
    ds_read_b64_tr_b16 v[98:99], v6 offset:4352
    buffer_load_dword v30, v5, s[8:11], s81 offen sc1
    s_add_u32 s57, s44, 9
    s_add_u32 s59, s58, 0
L_poll_75:
    s_sub_u32 s54, s54, 1
    s_cbranch_scc1 L_abort
    buffer_load_dword v31, v5, s[8:11], s81 offen sc1
    s_waitcnt vmcnt(1)
    v_cmp_gt_u32 vcc, s57, v30
    s_nop 0
    s_cbranch_vccz L_done_76
    buffer_load_dword v30, v5, s[8:11], s81 offen sc1
    s_waitcnt vmcnt(1)
    v_cmp_gt_u32 vcc, s57, v31
    s_nop 0
    s_cbranch_vccnz L_poll_75
L_done_76:
    buffer_load_dwordx4 a[0:3], v1, s[4:7], s59 offen sc1
    buffer_load_dwordx4 a[4:7], v1, s[4:7], s59 offen offset:1024 sc1
    buffer_load_dwordx4 a[8:11], v1, s[4:7], s59 offen offset:2048 sc1
    buffer_load_dwordx4 a[12:15], v1, s[4:7], s59 offen offset:3072 sc1
    s_add_u32 s59, s58, 4096
    buffer_load_dwordx4 a[16:19], v1, s[4:7], s59 offen sc1
    buffer_load_dwordx4 a[20:23], v1, s[4:7], s59 offen offset:1024 sc1
    buffer_load_dwordx4 a[24:27], v1, s[4:7], s59 offen offset:2048 sc1
    buffer_load_dwordx4 a[28:31], v1, s[4:7], s59 offen offset:3072 sc1
    s_waitcnt vmcnt(7) lgkmcnt(6)
    v_mfma_f32_32x32x16_bf16 v[112:127], v[80:83], a[0:3], 0
    s_add_u32 s59, s58, 8192
    buffer_load_dwordx4 a[32:35], v1, s[4:7], s59 offen sc1
    ds_read_b64_tr_b16 v[100:101], v6 offset:5120
    ds_read_b64_tr_b16 v[102:103], v6 offset:5376
    ds_write_b128 v33, a[200:203] offset:49152
    v_mfma_f32_32x32x16_bf16 v[128:143], v[84:87], a[0:3], 0
    ds_read_b64_tr_b16 v[104:105], v6 offset:6144
    ds_read_b64_tr_b16 v[106:107], v6 offset:6400
    s_waitcnt vmcnt(7) lgkmcnt(7)
    v_mfma_f32_32x32x16_bf16 v[112:127], v[88:91], a[4:7], v[112:127]
    buffer_load_dwordx4 a[36:39], v1, s[4:7], s59 offen offset:1024 sc1
    ds_read_b64_tr_b16 v[108:109], v6 offset:7168
    ds_read_b64_tr_b16 v[110:111], v6 offset:7424
    ds_write_b128 v33, a[204:207] offset:53248
    v_mfma_f32_32x32x16_bf16 v[128:143], v[92:95], a[4:7], v[128:143]
    ds_read_b64_tr_b16 v[80:81], v6 offset:8192
    ds_read_b64_tr_b16 v[82:83], v6 offset:8448
    s_waitcnt vmcnt(7) lgkmcnt(8)
    v_mfma_f32_32x32x16_bf16 v[112:127], v[96:99], a[8:11], v[112:127]
    buffer_load_dwordx4 a[40:43], v1, s[4:7], s59 offen offset:2048 sc1
    ds_read_b64_tr_b16 v[84:85], v6 offset:9216
    ds_read_b64_tr_b16 v[86:87], v6 offset:9472
    ds_write_b128 v33, a[208:211] offset:57344
    v_mfma_f32_32x32x16_bf16 v[128:143], v[100:103], a[8:11], v[128:143]
    ds_read_b64_tr_b16 v[88:89], v6 offset:10240
    ds_read_b64_tr_b16 v[90:91], v6 offset:10496
    s_waitcnt vmcnt(7) lgkmcnt(8)
    v_mfma_f32_32x32x16_bf16 v[112:127], v[104:107], a[12:15], v[112:127]
    buffer_load_dwordx4 a[44:47], v1, s[4:7], s59 offen offset:3072 sc1
    ds_read_b64_tr_b16 v[92:93], v6 offset:11264
    ds_read_b64_tr_b16 v[94:95], v6 offset:11520
    ds_write_b128 v33, a[212:215] offset:61440
    v_mfma_f32_32x32x16_bf16 v[128:143], v[108:111], a[12:15], v[128:143]
    ds_read_b64_tr_b16 v[96:97], v6 offset:12288
    ds_read_b64_tr_b16 v[98:99], v6 offset:12544
    s_add_u32 s59, s58, 12288
    s_waitcnt vmcnt(7) lgkmcnt(8)
    v_mfma_f32_32x32x16_bf16 v[112:127], v[80:83], a[16:19], v[112:127]
    buffer_load_dwordx4 a[48:51], v1, s[4:7], s59 offen sc1
    ds_read_b64_tr_b16 v[100:101], v6 offset:13312
    ds_read_b64_tr_b16 v[102:103], v6 offset:13568
    ds_read_b128 a[200:203], v33 offset:32768
    v_mfma_f32_32x32x16_bf16 v[128:143], v[84:87], a[16:19], v[128:143]
    buffer_load_dwordx4 v[176:179], v1, s[4:7], s69 offen offset:0 sc1
    ds_read_b64_tr_b16 v[104:105], v6 offset:14336
    ds_read_b64_tr_b16 v[106:107], v6 offset:14592
    s_waitcnt vmcnt(8) lgkmcnt(8)
    v_mfma_f32_32x32x16_bf16 v[112:127], v[88:91], a[20:23], v[112:127]
    buffer_load_dwordx4 a[52:55], v1, s[4:7], s59 offen offset:1024 sc1
    ds_read_b64_tr_b16 v[108:109], v6 offset:15360
    ds_read_b64_tr_b16 v[110:111], v6 offset:15616
    ds_write_b128 v33, a[184:187] offset:32768
    v_mfma_f32_32x32x16_bf16 v[128:143], v[92:95], a[20:23], v[128:143]
    ds_read_b64_tr_b16 v[80:81], v6 offset:16384
    ds_read_b64_tr_b16 v[82:83], v6 offset:16640
    s_waitcnt vmcnt(8) lgkmcnt(8)
    v_mfma_f32_32x32x16_bf16 v[112:127], v[96:99], a[24:27], v[112:127]
    buffer_load_dwordx4 a[56:59], v1, s[4:7], s59 offen offset:2048 sc1
    ds_read_b64_tr_b16 v[84:85], v6 offset:17408
    ds_read_b64_tr_b16 v[86:87], v6 offset:17664
    ds_read_b128 a[204:207], v33 offset:36864
    v_mfma_f32_32x32x16_bf16 v[128:143], v[100:103], a[24:27], v[128:143]
    ds_read_b64_tr_b16 v[88:89], v6 offset:18432
    ds_read_b64_tr_b16 v[90:91], v6 offset:18688
    ds_write_b128 v33, a[188:191] offset:36864
    s_waitcnt vmcnt(8) lgkmcnt(9)
    v_mfma_f32_32x32x16_bf16 v[112:127], v[104:107], a[28:31], v[112:127]
    buffer_load_dwordx4 a[60:63], v1, s[4:7], s59 offen offset:3072 sc1
    ds_read_b64_tr_b16 v[92:93], v6 offset:19456
    ds_read_b64_tr_b16 v[94:95], v6 offset:19712
    v_mfma_f32_32x32x16_bf16 v[128:143], v[108:111], a[28:31], v[128:143]
    buffer_load_dwordx4 v[180:183], v1, s[4:7], s69 offen offset:1024 sc1
    ds_read_b64_tr_b16 v[96:97], v6 offset:20480
    ds_read_b64_tr_b16 v[98:99], v6 offset:20736
    s_add_u32 s59, s58, 16384
    s_waitcnt vmcnt(9) lgkmcnt(8)
    v_mfma_f32_32x32x16_bf16 v[112:127], v[80:83], a[32:35], v[112:127]
    buffer_load_dwordx4 a[64:67], v1, s[4:7], s59 offen sc1
    ds_read_b64_tr_b16 v[100:101], v6 offset:21504
    ds_read_b64_tr_b16 v[102:103], v6 offset:21760
    ds_read_b128 a[208:211], v33 offset:40960
    v_mfma_f32_32x32x16_bf16 v[128:143], v[84:87], a[32:35], v[128:143]
    ds_read_b64_tr_b16 v[104:105], v6 offset:22528
    ds_read_b64_tr_b16 v[106:107], v6 offset:22784
    ds_write_b128 v33, a[192:195] offset:40960
    s_waitcnt vmcnt(9) lgkmcnt(8)
    v_mfma_f32_32x32x16_bf16 v[112:127], v[88:91], a[36:39], v[112:127]
    buffer_load_dwordx4 a[68:71], v1, s[4:7], s59 offen offset:1024 sc1
    ds_read_b64_tr_b16 v[108:109], v6 offset:23552
    ds_read_b64_tr_b16 v[110:111], v6 offset:23808
    v_mfma_f32_32x32x16_bf16 v[128:143], v[92:95], a[36:39], v[128:143]
    ds_read_b64_tr_b16 v[80:81], v6 offset:24576
    ds_read_b64_tr_b16 v[82:83], v6 offset:24832
    ds_read_b128 a[212:215], v33 offset:45056
    ds_write_b128 v33, a[196:199] offset:45056
    s_waitcnt vmcnt(9) lgkmcnt(10)
    v_mfma_f32_32x32x16_bf16 v[112:127], v[96:99], a[40:43], v[112:127]
    buffer_load_dwordx4 a[72:75], v1, s[4:7], s59 offen offset:2048 sc1
    ds_read_b64_tr_b16 v[84:85], v6 offset:25600
    ds_read_b64_tr_b16 v[86:87], v6 offset:25856
    v_mfma_f32_32x32x16_bf16 v[128:143], v[100:103], a[40:43], v[128:143]
    buffer_load_dwordx4 v[184:187], v1, s[4:7], s69 offen offset:2048 sc1
    ds_read_b64_tr_b16 v[88:89], v6 offset:26624
    ds_read_b64_tr_b16 v[90:91], v6 offset:26880
    s_waitcnt vmcnt(10) lgkmcnt(8)
    v_mfma_f32_32x32x16_bf16 v[112:127], v[104:107], a[44:47], v[112:127]
    buffer_load_dwordx4 a[76:79], v1, s[4:7], s59 offen offset:3072 sc1
    ds_read_b64_tr_b16 v[92:93], v6 offset:27648
    ds_read_b64_tr_b16 v[94:95], v6 offset:27904
    ds_read_b128 a[184:187], v37 offset:0
    v_mfma_f32_32x32x16_bf16 v[128:143], v[108:111], a[44:47], v[128:143]
    ds_read_b64_tr_b16 v[96:97], v6 offset:28672
    ds_read_b64_tr_b16 v[98:99], v6 offset:28928
    s_add_u32 s59, s58, 20480
    ds_read_b128 a[188:191], v37 offset:4096
    ds_read_b128 a[192:195], v37 offset:8192
    ds_read_b128 a[196:199], v37 offset:12288
    s_waitcnt vmcnt(10) lgkmcnt(10)
    v_mfma_f32_32x32x16_bf16 v[112:127], v[80:83], a[48:51], v[112:127]
    buffer_load_dwordx4 a[80:83], v1, s[4:7], s59 offen sc1
    ds_read_b64_tr_b16 v[100:101], v6 offset:29696
    ds_read_b64_tr_b16 v[102:103], v6 offset:29952
    v_mov_b32 v218, s71
    v_mfma_f32_32x32x16_bf16 v[128:143], v[84:87], a[48:51], v[128:143]
    ds_read_b64_tr_b16 v[104:105], v6 offset:30720
    ds_read_b64_tr_b16 v[106:107], v6 offset:30976
    s_barrier
    s_waitcnt vmcnt(9) lgkmcnt(10)
    v_mfma_f32_32x32x16_bf16 v[112:127], v[88:91], a[52:55], v[112:127]
    buffer_load_dwordx4 a[84:87], v1, s[4:7], s59 offen offset:1024 sc1
    ds_read_b64_tr_b16 v[108:109], v6 offset:31744
    ds_read_b64_tr_b16 v[110:111], v6 offset:32000
    v_mov_b32 v219, s71
    v_mfma_f32_32x32x16_bf16 v[128:143], v[92:95], a[52:55], v[128:143]
    buffer_load_dwordx4 v[188:191], v1, s[4:7], s69 offen offset:3072 sc1
    ds_read_b64_tr_b16 v[80:81], v6 offset:32768
    ds_read_b64_tr_b16 v[82:83], v6 offset:33024
    s_waitcnt vmcnt(10) lgkmcnt(6)
    v_mfma_f32_32x32x16_bf16 v[112:127], v[96:99], a[56:59], v[112:127]
    buffer_load_dwordx4 a[88:91], v1, s[4:7], s59 offen offset:2048 sc1
    ds_read_b64_tr_b16 v[84:85], v6 offset:33792
    ds_read_b64_tr_b16 v[86:87], v6 offset:34048
    v_mov_b32 v217, 122880
    v_mfma_f32_32x32x16_bf16 v[128:143], v[100:103], a[56:59], v[128:143]
    ds_read_b64_tr_b16 v[88:89], v6 offset:34816
    ds_read_b64_tr_b16 v[90:91], v6 offset:35072
    ds_write_b64 v217, v[218:219]
    v_mov_b32 v192, v13
    v_mov_b32 v193, v14
    v_add_u32 v194, v192, v15
    s_waitcnt vmcnt(10) lgkmcnt(7)
    v_mfma_f32_32x32x16_bf16 v[112:127], v[104:107], a[60:63], v[112:127]
    buffer_load_dwordx4 a[92:95], v1, s[4:7], s59 offen offset:3072 sc1
    ds_read_b64_tr_b16 v[92:93], v6 offset:35840
    ds_read_b64_tr_b16 v[94:95], v6 offset:36096
    v_add_u32 v195, v193, v15
    v_mfma_f32_32x32x16_bf16 v[128:143], v[108:111], a[60:63], v[128:143]
    ds_read_b64_tr_b16 v[96:97], v6 offset:36864
    ds_read_b64_tr_b16 v[98:99], v6 offset:37120
    s_add_u32 s59, s58, 24576
    v_add_u32 v196, v194, v15
    v_add_u32 v197, v195, v15
    v_add_u32 v198, v196, v15
    s_waitcnt vmcnt(9) lgkmcnt(7)
    v_mfma_f32_32x32x16_bf16 v[112:127], v[80:83], a[64:67], v[112:127]
    buffer_load_dwordx4 a[96:99], v1, s[4:7], s59 offen sc1
    ds_read_b64_tr_b16 v[100:101], v6 offset:37888
    ds_read_b64_tr_b16 v[102:103], v6 offset:38144
    v_add_u32 v199, v197, v15
    v_mfma_f32_32x32x16_bf16 v[128:143], v[84:87], a[64:67], v[128:143]
    ds_read_b64_tr_b16 v[104:105], v6 offset:38912
    ds_read_b64_tr_b16 v[106:107], v6 offset:39168
    v_add_u32 v200, v198, v15
    v_add_u32 v201, v199, v15
    v_add_u32 v202, v200, v15
    v_add_u32 v203, v201, v15
    s_waitcnt vmcnt(9) lgkmcnt(6)
    v_mfma_f32_32x32x16_bf16 v[112:127], v[88:91], a[68:71], v[112:127]
    buffer_load_dwordx4 a[100:103], v1, s[4:7], s59 offen offset:1024 sc1
    ds_read_b64_tr_b16 v[108:109], v6 offset:39936
    ds_read_b64_tr_b16 v[110:111], v6 offset:40192
    v_add_u32 v204, v202, v15
    v_mfma_f32_32x32x16_bf16 v[128:143], v[92:95], a[68:71], v[128:143]
    ds_read_b64_tr_b16 v[80:81], v6 offset:40960
    ds_read_b64_tr_b16 v[82:83], v6 offset:41216
    v_add_u32 v205, v203, v15
    v_add_u32 v206, v204, v15
    v_add_u32 v207, v205, v15
    s_waitcnt vmcnt(9) lgkmcnt(6)
    v_mfma_f32_32x32x16_bf16 v[112:127], v[96:99], a[72:75], v[112:127]
    buffer_load_dwordx4 a[104:107], v1, s[4:7], s59 offen offset:2048 sc1
    ds_read_b64_tr_b16 v[84:85], v6 offset:41984
    ds_read_b64_tr_b16 v[86:87], v6 offset:42240
    v_mfma_f32_32x32x16_bf16 v[128:143], v[100:103], a[72:75], v[128:143]
    ds_read_b64_tr_b16 v[88:89], v6 offset:43008
    ds_read_b64_tr_b16 v[90:91], v6 offset:43264
    s_waitcnt vmcnt(8) lgkmcnt(6)
    v_mfma_f32_32x32x16_bf16 v[112:127], v[104:107], a[76:79], v[112:127]
    buffer_load_dwordx4 a[108:111], v1, s[4:7], s59 offen offset:3072 sc1
    ds_read_b64_tr_b16 v[92:93], v6 offset:44032
    ds_read_b64_tr_b16 v[94:95], v6 offset:44288
    v_mfma_f32_32x32x16_bf16 v[128:143], v[108:111], a[76:79], v[128:143]
    ds_read_b64_tr_b16 v[96:97], v6 offset:45056
    ds_read_b64_tr_b16 v[98:99], v6 offset:45312
    s_add_u32 s59, s58, 28672
    s_waitcnt vmcnt(8) lgkmcnt(6)
    v_mfma_f32_32x32x16_bf16 v[112:127], v[80:83], a[80:83], v[112:127]
    buffer_load_dwordx4 a[112:115], v1, s[4:7], s59 offen sc1
    ds_read_b64_tr_b16 v[100:101], v6 offset:46080
    ds_read_b64_tr_b16 v[102:103], v6 offset:46336
    v_mfma_f32_32x32x16_bf16 v[128:143], v[84:87], a[80:83], v[128:143]
    ds_read_b64_tr_b16 v[104:105], v6 offset:47104
    ds_read_b64_tr_b16 v[106:107], v6 offset:47360
    s_waitcnt vmcnt(8) lgkmcnt(6)
    v_mfma_f32_32x32x16_bf16 v[112:127], v[88:91], a[84:87], v[112:127]
    buffer_load_dwordx4 a[116:119], v1, s[4:7], s59 offen offset:1024 sc1
    ds_read_b64_tr_b16 v[108:109], v6 offset:48128
    ds_read_b64_tr_b16 v[110:111], v6 offset:48384
    s_waitcnt vmcnt(8)
    v_mfma_f32_32x32x16_bf16 v[128:143], v[92:95], a[84:87], v[128:143]
    ds_read_b64_tr_b16 v[80:81], v6 offset:49152
    ds_read_b64_tr_b16 v[82:83], v6 offset:49408
    v_add_f32 v176, v176, v184
    v_add_f32 v177, v177, v185
    v_add_f32 v178, v178, v186
    v_add_f32 v179, v179, v187
    s_waitcnt vmcnt(7) lgkmcnt(6)
    v_mfma_f32_32x32x16_bf16 v[112:127], v[96:99], a[88:91], v[112:127]
    buffer_load_dwordx4 a[120:123], v1, s[4:7], s59 offen offset:2048 sc1
    ds_read_b64_tr_b16 v[84:85], v6 offset:50176
    ds_read_b64_tr_b16 v[86:87], v6 offset:50432
    v_add_f32 v180, v180, v188
    v_mfma_f32_32x32x16_bf16 v[128:143], v[100:103], a[88:91], v[128:143]
    ds_read_b64_tr_b16 v[88:89], v6 offset:51200
    ds_read_b64_tr_b16 v[90:91], v6 offset:51456
    v_add_f32 v181, v181, v189
    v_add_f32 v182, v182, v190
    v_add_f32 v183, v183, v191
    v_add_f32 v176, v176, v180
    s_waitcnt vmcnt(7) lgkmcnt(6)
    v_mfma_f32_32x32x16_bf16 v[112:127], v[104:107], a[92:95], v[112:127]
    buffer_load_dwordx4 a[124:127], v1, s[4:7], s59 offen offset:3072 sc1
    ds_read_b64_tr_b16 v[92:93], v6 offset:52224
    ds_read_b64_tr_b16 v[94:95], v6 offset:52480
    v_add_f32 v177, v177, v181
    v_mfma_f32_32x32x16_bf16 v[128:143], v[108:111], a[92:95], v[128:143]
    ds_read_b64_tr_b16 v[96:97], v6 offset:53248
    ds_read_b64_tr_b16 v[98:99], v6 offset:53504
    s_barrier
    s_waitcnt vmcnt(7) lgkmcnt(6)
    v_mfma_f32_32x32x16_bf16 v[112:127], v[80:83], a[96:99], v[112:127]
    s_add_u32 s60, s86, 131072
    buffer_load_dword v21, v20, s[4:7], s60 offen sc1
    ds_read_b64_tr_b16 v[100:101], v6 offset:54272
    ds_read_b64_tr_b16 v[102:103], v6 offset:54528
    s_add_u32 m0, s56, 0
    s_add_u32 s60, s64, 0
    v_mfma_f32_32x32x16_bf16 v[128:143], v[84:87], a[96:99], v[128:143]
    buffer_load_dwordx4 v1, s[8:11], s60 offen sc1 lds
    ds_read_b64_tr_b16 v[104:105], v6 offset:55296
    ds_read_b64_tr_b16 v[106:107], v6 offset:55552
    s_waitcnt vmcnt(8) lgkmcnt(6)
    v_mfma_f32_32x32x16_bf16 v[112:127], v[88:91], a[100:103], v[112:127]
    ds_read_b64_tr_b16 v[108:109], v6 offset:56320
    ds_read_b64_tr_b16 v[110:111], v6 offset:56576
    v_add_f32 v178, v178, v182
    v_add_f32 v179, v179, v183
    s_nop 0
    v_permlane32_swap_b32 v176, v178
    v_permlane32_swap_b32 v177, v179
    v_add_f32 v176, v176, v178
    v_mfma_f32_32x32x16_bf16 v[128:143], v[92:95], a[100:103], v[128:143]
    buffer_load_dwordx4 v1, s[8:11], s60 offen offset:1024 sc1 lds
    ds_read_b64_tr_b16 v[80:81], v6 offset:57344
    ds_read_b64_tr_b16 v[82:83], v6 offset:57600
    s_waitcnt vmcnt(8) lgkmcnt(6)
    v_mfma_f32_32x32x16_bf16 v[112:127], v[96:99], a[104:107], v[112:127]
    ds_read_b64_tr_b16 v[84:85], v6 offset:58368
    ds_read_b64_tr_b16 v[86:87], v6 offset:58624
    v_add_f32 v177, v177, v179
    v_mfma_f32_32x32x16_bf16 v[128:143], v[100:103], a[104:107], v[128:143]
    buffer_load_dwordx4 v1, s[8:11], s60 offen offset:2048 sc1 lds
    v_permlane16_swap_b32 v176, v177
    v_add_f32 v176, v176, v177
    s_waitcnt vmcnt(8) lgkmcnt(4)
    v_mfma_f32_32x32x16_bf16 v[112:127], v[104:107], a[108:111], v[112:127]
    v_mul_f32 v176, 0x3b000000, v176
    v_mov_b32 v177, v176
    v_mfma_f32_32x32x16_bf16 v[128:143], v[108:111], a[108:111], v[128:143]
    buffer_load_dwordx4 v1, s[8:11], s60 offen offset:3072 sc1 lds
    ds_read_b64_tr_b16 v[96:97], v6 offset:59392
    ds_read_b64_tr_b16 v[98:99], v6 offset:59648
    s_waitcnt vmcnt(8) lgkmcnt(2)
    v_mfma_f32_32x32x16_bf16 v[112:127], v[80:83], a[112:115], v[112:127]
    ds_read_b64_tr_b16 v[100:101], v6 offset:60416
    ds_read_b64_tr_b16 v[102:103], v6 offset:60672
    s_add_u32 m0, s56, 16384
    s_add_u32 s60, s64, 16384
    v_permlane32_swap_b32 v176, v177
    v_fma_f32 v177, -v176, v176, v177
    v_max_f32 v177, 0, v177
    v_mfma_f32_32x32x16_bf16 v[128:143], v[84:87], a[112:115], v[128:143]
    buffer_load_dwordx4 v1, s[8:11], s60 offen sc1 lds
    ds_read_b64_tr_b16 v[104:105], v6 offset:61440
    ds_read_b64_tr_b16 v[106:107], v6 offset:61696
    v_add_f32 v38, 0x3727c5ac, v177
    v_rsq_f32 v32, v38
    v_cvt_pk_bf16_f32 v40, -v176, -v176
    v_mov_b32 v45, v40
    v_mul_f32 v34, 0x3fb8aa3b, v32
    v_mfma_f32_32x32x16_bf16 v[112:127], a[136:139], v[40:43], v[112:127]
    ds_read_b64_tr_b16 v[108:109], v6 offset:62464
    ds_read_b64_tr_b16 v[110:111], v6 offset:62720
    v_mfma_f32_32x32x16_bf16 v[128:143], a[134:137], v[42:45], v[128:143]
    buffer_load_dwordx4 v1, s[8:11], s60 offen offset:1024 sc1 lds
    ds_read_b64_tr_b16 v[80:81], v6 offset:63488
    ds_read_b64_tr_b16 v[82:83], v6 offset:63744
    s_waitcnt vmcnt(9) lgkmcnt(6)
    v_mfma_f32_32x32x16_bf16 v[112:127], v[96:99], a[116:119], v[112:127]
    ds_read_b64_tr_b16 v[84:85], v6 offset:64512
    ds_read_b64_tr_b16 v[86:87], v6 offset:64768
    v_mfma_f32_32x32x16_bf16 v[128:143], v[100:103], a[116:119], v[128:143]
    buffer_load_dwordx4 v1, s[8:11], s60 offen offset:2048 sc1 lds
    s_waitcnt vmcnt(9) lgkmcnt(4)
    v_mfma_f32_32x32x16_bf16 v[112:127], v[104:107], a[120:123], v[112:127]
    v_mfma_f32_32x32x16_bf16 v[128:143], v[108:111], a[120:123], v[128:143]
    buffer_load_dwordx4 v1, s[8:11], s60 offen offset:3072 sc1 lds
    s_waitcnt vmcnt(9) lgkmcnt(0)
    v_mfma_f32_32x32x16_bf16 v[112:127], v[80:83], a[124:127], v[112:127]
    s_nop 5
    v_mfma_f32_32x32x16_bf16 v[128:143], v[84:87], a[124:127], v[128:143]
    s_nop 4
    v_cvt_pk_bf16_f32 v80, v112, v113
    v_cvt_pk_bf16_f32 v81, v114, v115
    v_cvt_pk_bf16_f32 v82, v116, v117
    v_cvt_pk_bf16_f32 v83, v118, v119
    v_cvt_pk_bf16_f32 v84, v120, v121
    v_cvt_pk_bf16_f32 v85, v122, v123
    v_mfma_f32_32x32x16_bf16 v[144:159], a[128:131], v[80:83], 0
    v_cvt_pk_bf16_f32 v86, v124, v125
    v_cvt_pk_bf16_f32 v87, v126, v127
    v_mul_f32 v128, v32, v128
    v_mul_f32 v129, v32, v129
    v_mul_f32 v130, v32, v130
    v_mul_f32 v131, v32, v131
    v_mfma_f32_32x32x16_bf16 v[160:175], a[132:135], v[84:87], 0
    v_mul_f32 v132, v32, v132
    v_mul_f32 v133, v32, v133
    v_mul_f32 v134, v32, v134
    v_mul_f32 v135, v32, v135
    v_cvt_pk_bf16_f32 v88, v128, v129
    v_cvt_pk_bf16_f32 v89, v130, v131
    v_cvt_pk_bf16_f32 v90, v132, v133
    v_cvt_pk_bf16_f32 v91, v134, v135
    ds_write_b128 v9, v[88:91] offset:16384
    v_pk_mul_f32 v[136:137], v[136:137], v[32:33] op_sel_hi:[1,0]
    v_pk_mul_f32 v[138:139], v[138:139], v[32:33] op_sel_hi:[1,0]
    v_pk_mul_f32 v[140:141], v[140:141], v[32:33] op_sel_hi:[1,0]
    v_pk_mul_f32 v[142:143], v[142:143], v[32:33] op_sel_hi:[1,0]
    v_cvt_pk_bf16_f32 v92, v136, v137
    v_cvt_pk_bf16_f32 v93, v138, v139
    v_cvt_pk_bf16_f32 v94, v140, v141
    v_cvt_pk_bf16_f32 v95, v142, v143
    ds_write_b128 v10, v[92:95] offset:16384
    v_max3_f32 v208, v144, v145, v146
    v_max3_f32 v208, v208, v147, v148
    v_max3_f32 v208, v208, v149, v150
    v_max3_f32 v208, v208, v151, v152
    v_max3_f32 v208, v208, v153, v154
    v_max3_f32 v208, v208, v155, v156
    v_max3_f32 v208, v208, v157, v158
    v_max_f32_e64 v208, v208, v159
    v_mul_f32 v208, -v208, v34
    v_pk_fma_f32 v[144:145], v[144:145], v[34:35], v[208:209] op_sel_hi:[1,0,0]
    v_pk_fma_f32 v[146:147], v[146:147], v[34:35], v[208:209] op_sel_hi:[1,0,0]
L_page_6:
    s_cbranch_execz L_page_10
    v_pk_fma_f32 v[148:149], v[148:149], v[34:35], v[208:209] op_sel_hi:[1,0,0]
    v_pk_fma_f32 v[150:151], v[150:151], v[34:35], v[208:209] op_sel_hi:[1,0,0]
    v_pk_fma_f32 v[152:153], v[152:153], v[34:35], v[208:209] op_sel_hi:[1,0,0]
    v_pk_fma_f32 v[154:155], v[154:155], v[34:35], v[208:209] op_sel_hi:[1,0,0]
    v_pk_fma_f32 v[156:157], v[156:157], v[34:35], v[208:209] op_sel_hi:[1,0,0]
    v_pk_fma_f32 v[158:159], v[158:159], v[34:35], v[208:209] op_sel_hi:[1,0,0]
    v_exp_f32 v144, v144
    v_exp_f32 v145, v145
    v_exp_f32 v146, v146
    v_exp_f32 v147, v147
    v_exp_f32 v148, v148
    v_exp_f32 v149, v149
    v_exp_f32 v150, v150
    v_exp_f32 v151, v151
    v_exp_f32 v152, v152
    v_exp_f32 v153, v153
    v_exp_f32 v154, v154
    v_exp_f32 v155, v155
    v_exp_f32 v156, v156
    v_exp_f32 v157, v157
    v_exp_f32 v158, v158
    v_exp_f32_e64 v159, v159
    v_pk_add_f32 v[210:211], v[144:145], v[146:147]
    v_pk_add_f32 v[210:211], v[210:211], v[148:149]
    v_pk_add_f32 v[210:211], v[210:211], v[150:151]
    v_pk_add_f32 v[210:211], v[210:211], v[152:153]
    v_pk_add_f32 v[210:211], v[210:211], v[154:155]
    v_pk_add_f32 v[210:211], v[210:211], v[156:157]
    v_pk_add_f32 v[210:211], v[210:211], v[158:159]
    v_add_f32 v210, v210, v211
    v_rcp_f32_e64 v210, v210
    s_nop 0
    v_pk_mul_f32 v[144:145], v[144:145], v[210:211] op_sel_hi:[1,0]
    v_pk_mul_f32 v[146:147], v[146:147], v[210:211] op_sel_hi:[1,0]
    v_pk_mul_f32 v[148:149], v[148:149], v[210:211] op_sel_hi:[1,0]
    v_pk_mul_f32 v[150:151], v[150:151], v[210:211] op_sel_hi:[1,0]
    v_cvt_pk_bf16_f32 v64, v144, v145
    v_cvt_pk_bf16_f32 v65, v146, v147
    v_cvt_pk_bf16_f32 v66, v148, v149
    v_cvt_pk_bf16_f32 v67, v150, v151
    ds_write_b128 v7, v[64:67] offset:0
    v_pk_mul_f32 v[152:153], v[152:153], v[210:211] op_sel_hi:[1,0]
    v_pk_mul_f32 v[154:155], v[154:155], v[210:211] op_sel_hi:[1,0]
    v_pk_mul_f32 v[156:157], v[156:157], v[210:211] op_sel_hi:[1,0]
    v_pk_mul_f32 v[158:159], v[158:159], v[210:211] op_sel_hi:[1,0]
    v_cvt_pk_bf16_f32 v68, v152, v153
    v_cvt_pk_bf16_f32 v69, v154, v155
    v_cvt_pk_bf16_f32 v70, v156, v157
    v_cvt_pk_bf16_f32 v71, v158, v159
    ds_write_b128 v8, v[68:71] offset:0
    v_max3_f32 v208, v160, v161, v162
    v_max3_f32 v208, v208, v163, v164
    v_max3_f32 v208, v208, v165, v166
    v_max3_f32 v208, v208, v167, v168
    v_max3_f32 v208, v208, v169, v170
    v_max3_f32 v208, v208, v171, v172
    v_max3_f32 v208, v208, v173, v174
    v_max_f32_e64 v208, v208, v175
    v_mul_f32 v208, -v208, v34
    v_pk_fma_f32 v[160:161], v[160:161], v[34:35], v[208:209] op_sel_hi:[1,0,0]
    v_pk_fma_f32 v[162:163], v[162:163], v[34:35], v[208:209] op_sel_hi:[1,0,0]
    v_pk_fma_f32 v[164:165], v[164:165], v[34:35], v[208:209] op_sel_hi:[1,0,0]
    v_pk_fma_f32 v[166:167], v[166:167], v[34:35], v[208:209] op_sel_hi:[1,0,0]
    v_pk_fma_f32 v[168:169], v[168:169], v[34:35], v[208:209] op_sel_hi:[1,0,0]
    v_pk_fma_f32 v[170:171], v[170:171], v[34:35], v[208:209] op_sel_hi:[1,0,0]
    v_pk_fma_f32 v[172:173], v[172:173], v[34:35], v[208:209] op_sel_hi:[1,0,0]
    v_pk_fma_f32 v[174:175], v[174:175], v[34:35], v[208:209] op_sel_hi:[1,0,0]
    v_exp_f32 v160, v160
    v_exp_f32 v161, v161
    v_exp_f32 v162, v162
    v_exp_f32 v163, v163
    v_exp_f32 v164, v164
    v_exp_f32 v165, v165
    v_exp_f32 v166, v166
    v_exp_f32 v167, v167
    v_exp_f32 v168, v168
    v_exp_f32 v169, v169
    v_exp_f32 v170, v170
    v_exp_f32 v171, v171
    v_exp_f32 v172, v172
    v_exp_f32 v173, v173
    v_exp_f32 v174, v174
    v_exp_f32 v175, v175
    v_pk_add_f32 v[210:211], v[160:161], v[162:163]
    v_pk_add_f32 v[210:211], v[210:211], v[164:165]
    v_pk_add_f32 v[210:211], v[210:211], v[166:167]
    v_pk_add_f32 v[210:211], v[210:211], v[168:169]
    v_pk_add_f32 v[210:211], v[210:211], v[170:171]
    v_pk_add_f32 v[210:211], v[210:211], v[172:173]
    v_pk_add_f32 v[210:211], v[210:211], v[174:175]
    v_add_f32 v210, v210, v211
    v_rcp_f32_e64 v210, v210
    s_nop 0
    v_pk_mul_f32 v[160:161], v[160:161], v[210:211] op_sel_hi:[1,0]
    v_pk_mul_f32 v[162:163], v[162:163], v[210:211] op_sel_hi:[1,0]
    v_pk_mul_f32 v[164:165], v[164:165], v[210:211] op_sel_hi:[1,0]
    v_pk_mul_f32 v[166:167], v[166:167], v[210:211] op_sel_hi:[1,0]
    v_cvt_pk_bf16_f32 v72, v160, v161
    v_cvt_pk_bf16_f32 v73, v162, v163
    v_cvt_pk_bf16_f32 v74, v164, v165
    v_cvt_pk_bf16_f32 v75, v166, v167
    ds_write_b128 v7, v[72:75] offset:8192
    v_pk_mul_f32 v[168:169], v[168:169], v[210:211] op_sel_hi:[1,0]
    v_pk_mul_f32 v[170:171], v[170:171], v[210:211] op_sel_hi:[1,0]
    v_pk_mul_f32 v[172:173], v[172:173], v[210:211] op_sel_hi:[1,0]
    v_pk_mul_f32 v[174:175], v[174:175], v[210:211] op_sel_hi:[1,0]
    v_cvt_pk_bf16_f32 v76, v168, v169
    v_cvt_pk_bf16_f32 v77, v170, v171
    v_cvt_pk_bf16_f32 v78, v172, v173
    v_cvt_pk_bf16_f32 v79, v174, v175
    ds_write_b128 v8, v[76:79] offset:8192
    s_waitcnt lgkmcnt(0)
    s_barrier
    s_cmp_ge_u32 s52, 2
    s_cbranch_scc1 L_nokv_77
    ds_read_b64_tr_b16 v[80:81], v11 offset:0
    ds_read_b64_tr_b16 v[82:83], v12 offset:0
    ds_read_b64_tr_b16 v[144:145], v192
    ds_read_b64_tr_b16 v[146:147], v193
    ds_read_b64_tr_b16 v[84:85], v11 offset:1024
    ds_read_b64_tr_b16 v[86:87], v12 offset:1024
    ds_read_b64_tr_b16 v[148:149], v194
    ds_read_b64_tr_b16 v[150:151], v195
    ds_read_b64_tr_b16 v[88:89], v11 offset:2048
    ds_read_b64_tr_b16 v[90:91], v12 offset:2048
    ds_read_b64_tr_b16 v[152:153], v196
    ds_read_b64_tr_b16 v[154:155], v197
    s_waitcnt lgkmcnt(8)
    v_mfma_f32_32x32x16_bf16 v[112:127], v[80:83], v[144:147], 0
    ds_read_b64_tr_b16 v[92:93], v11 offset:3072
    ds_read_b64_tr_b16 v[94:95], v12 offset:3072
    ds_read_b64_tr_b16 v[156:157], v198
    ds_read_b64_tr_b16 v[158:159], v199
    s_waitcnt lgkmcnt(8)
    v_mfma_f32_32x32x16_bf16 v[112:127], v[84:87], v[148:151], v[112:127]
    ds_read_b64_tr_b16 v[96:97], v11 offset:4096
    ds_read_b64_tr_b16 v[98:99], v12 offset:4096
    ds_read_b64_tr_b16 v[160:161], v200
    ds_read_b64_tr_b16 v[162:163], v201
    s_waitcnt lgkmcnt(8)
    v_mfma_f32_32x32x16_bf16 v[112:127], v[88:91], v[152:155], v[112:127]
    ds_read_b64_tr_b16 v[100:101], v11 offset:5120
    ds_read_b64_tr_b16 v[102:103], v12 offset:5120
    ds_read_b64_tr_b16 v[164:165], v202
    ds_read_b64_tr_b16 v[166:167], v203
    s_waitcnt lgkmcnt(8)
    v_mfma_f32_32x32x16_bf16 v[112:127], v[92:95], v[156:159], v[112:127]
    ds_read_b64_tr_b16 v[104:105], v11 offset:6144
    ds_read_b64_tr_b16 v[106:107], v12 offset:6144
    ds_read_b64_tr_b16 v[168:169], v204
    ds_read_b64_tr_b16 v[170:171], v205
    s_waitcnt lgkmcnt(8)
    v_mfma_f32_32x32x16_bf16 v[112:127], v[96:99], v[160:163], v[112:127]
    ds_read_b64_tr_b16 v[108:109], v11 offset:7168
    ds_read_b64_tr_b16 v[110:111], v12 offset:7168
    ds_read_b64_tr_b16 v[172:173], v206
    ds_read_b64_tr_b16 v[174:175], v207
    s_waitcnt lgkmcnt(8)
    v_mfma_f32_32x32x16_bf16 v[112:127], v[100:103], v[164:167], v[112:127]
    s_waitcnt lgkmcnt(4)
    v_mfma_f32_32x32x16_bf16 v[112:127], v[104:107], v[168:171], v[112:127]
    s_waitcnt lgkmcnt(0)
    v_mfma_f32_32x32x16_bf16 v[112:127], v[108:111], v[172:175], v[112:127]
    s_lshl_b32 s57, s51, 1
    s_add_u32 s57, s57, s52
    s_lshl_b32 s57, s57, 5
    s_add_u32 s57, s57, s50
    s_mul_i32 s57, s57, 640
    s_add_u32 s59, s57, 917504
    s_add_u32 s58, s57, 927744
    s_mov_b32 s48, 0x1ffff
    s_mov_b32 s49, 0x1ffff
    s_nop 2
    v_cvt_pk_bf16_f32 v128, v112, v113
    v_cvt_pk_bf16_f32 v129, v114, v115
    v_cvt_pk_bf16_f32 v130, v116, v117
    v_cvt_pk_bf16_f32 v131, v118, v119
    v_min_u32 v128, -2, v128
    v_min_u32 v129, -2, v129
    v_min_u32 v130, -2, v130
    v_min_u32 v131, -2, v131
    s_mov_b64 exec, s[48:49]
    buffer_store_dwordx4 v[128:131], v16, s[8:11], s59 offen sc1
    s_mov_b64 exec, -1
    v_cvt_pk_bf16_f32 v132, v120, v121
    v_cvt_pk_bf16_f32 v133, v122, v123
    v_cvt_pk_bf16_f32 v134, v124, v125
    v_cvt_pk_bf16_f32 v135, v126, v127
    v_min_u32 v132, -2, v132
    v_min_u32 v133, -2, v133
    v_min_u32 v134, -2, v134
    v_min_u32 v135, -2, v135
    s_mov_b64 exec, s[48:49]
    buffer_store_dwordx4 v[132:135], v16, s[8:11], s58 offen sc1
    s_mov_b64 exec, -1
    s_branch L_kvdone_78
L_nokv_77:
    s_lshl_b32 s57, s56, 2
L_kvdone_78:
    s_lshl_b32 s57, s51, 2
    s_add_u32 s57, s57, s52
    s_mul_i32 s57, s57, 10240
    s_add_u32 s89, s57, 917504
    s_barrier
    ds_read_b128 v[80:83], v2 offset:0
    ds_read_b128 v[84:87], v2 offset:1024
    ds_read_b128 v[88:91], v2 offset:2048
    ds_read_b128 v[92:95], v2 offset:3072
    ds_read_b128 v[96:99], v2 offset:4096
    ds_read_b128 v[100:103], v2 offset:5120
    ds_read_b128 v[104:107], v2 offset:6144
    s_waitcnt lgkmcnt(3)
    v_mfma_f32_32x32x16_bf16 v[48:63], v[80:83], a[0:3], 0
    ds_read_b128 v[108:111], v2 offset:7168
    s_add_u32 m0, s56, 32768
    s_add_u32 s60, s64, 32768
    v_mfma_f32_32x32x16_bf16 v[48:63], v[84:87], a[4:7], v[48:63]
    buffer_load_dwordx4 v1, s[8:11], s60 offen sc1 lds
    ds_read_b128 v[80:83], v2 offset:8192
    v_mfma_f32_32x32x16_bf16 v[48:63], v[88:91], a[8:11], v[48:63]
    buffer_load_dwordx4 v1, s[8:11], s60 offen offset:1024 sc1 lds
    ds_read_b128 v[84:87], v2 offset:9216
    v_mfma_f32_32x32x16_bf16 v[48:63], v[92:95], a[12:15], v[48:63]
    buffer_load_dwordx4 v1, s[8:11], s60 offen offset:2048 sc1 lds
    ds_read_b128 v[88:91], v2 offset:10240
    s_waitcnt lgkmcnt(3)
    v_mfma_f32_32x32x16_bf16 v[48:63], v[96:99], a[16:19], v[48:63]
    buffer_load_dwordx4 v1, s[8:11], s60 offen offset:3072 sc1 lds
    ds_read_b128 v[92:95], v2 offset:11264
    s_add_u32 m0, s56, 49152
    s_add_u32 s60, s64, 49152
    v_mfma_f32_32x32x16_bf16 v[48:63], v[100:103], a[20:23], v[48:63]
    buffer_load_dwordx4 v1, s[8:11], s60 offen sc1 lds
    ds_read_b128 v[96:99], v2 offset:12288
    v_mfma_f32_32x32x16_bf16 v[48:63], v[104:107], a[24:27], v[48:63]
    buffer_load_dwordx4 v1, s[8:11], s60 offen offset:1024 sc1 lds
    ds_read_b128 v[100:103], v2 offset:13312
    v_mfma_f32_32x32x16_bf16 v[48:63], v[108:111], a[28:31], v[48:63]
    buffer_load_dwordx4 v1, s[8:11], s60 offen offset:2048 sc1 lds
    ds_read_b128 v[104:107], v2 offset:14336
    s_waitcnt lgkmcnt(3)
    v_mfma_f32_32x32x16_bf16 v[48:63], v[80:83], a[32:35], v[48:63]
    buffer_load_dwordx4 v1, s[8:11], s60 offen offset:3072 sc1 lds
    ds_read_b128 v[108:111], v2 offset:15360
    s_add_u32 m0, s56, 131072
    s_add_u32 s60, s62, 0
    v_mfma_f32_32x32x16_bf16 v[48:63], v[84:87], a[36:39], v[48:63]
    buffer_load_dwordx4 v1, s[8:11], s60 offen sc1 lds
    ds_read_b128 v[80:83], v2 offset:16384
    v_mfma_f32_32x32x16_bf16 v[48:63], v[88:91], a[40:43], v[48:63]
    buffer_load_dwordx4 v1, s[8:11], s60 offen offset:1024 sc1 lds
    ds_read_b128 v[84:87], v2 offset:17408
    v_mfma_f32_32x32x16_bf16 v[48:63], v[92:95], a[44:47], v[48:63]
    buffer_load_dwordx4 v1, s[8:11], s60 offen offset:2048 sc1 lds
    ds_read_b128 v[88:91], v2 offset:18432
    s_waitcnt lgkmcnt(3)
    v_mfma_f32_32x32x16_bf16 v[48:63], v[96:99], a[48:51], v[48:63]
    buffer_load_dwordx4 v1, s[8:11], s60 offen offset:3072 sc1 lds
    ds_read_b128 v[92:95], v2 offset:19456
    s_add_u32 m0, s56, 147456
    s_add_u32 s60, s62, 16384
    v_mfma_f32_32x32x16_bf16 v[48:63], v[100:103], a[52:55], v[48:63]
    buffer_load_dwordx4 v1, s[8:11], s60 offen sc1 lds
    ds_read_b128 v[96:99], v2 offset:20480
    v_mfma_f32_32x32x16_bf16 v[48:63], v[104:107], a[56:59], v[48:63]
    buffer_load_dwordx4 v1, s[8:11], s60 offen offset:1024 sc1 lds
    ds_read_b128 v[100:103], v2 offset:21504
    v_mfma_f32_32x32x16_bf16 v[48:63], v[108:111], a[60:63], v[48:63]
    buffer_load_dwordx4 v1, s[8:11], s60 offen offset:2048 sc1 lds
    ds_read_b128 v[104:107], v2 offset:22528
    s_waitcnt lgkmcnt(3)
    v_mfma_f32_32x32x16_bf16 v[48:63], v[80:83], a[64:67], v[48:63]
    buffer_load_dwordx4 v1, s[8:11], s60 offen offset:3072 sc1 lds
    ds_read_b128 v[108:111], v2 offset:23552
    s_add_u32 s60, s67, 0
    v_mfma_f32_32x32x16_bf16 v[48:63], v[84:87], a[68:71], v[48:63]
    buffer_load_dwordx4 v[212:215], v1, s[4:7], s60 offen sc1
    ds_read_b128 v[80:83], v2 offset:24576
    v_mfma_f32_32x32x16_bf16 v[48:63], v[88:91], a[72:75], v[48:63]
    buffer_load_dwordx4 v[220:223], v1, s[4:7], s60 offen offset:1024 sc1
    ds_read_b128 v[84:87], v2 offset:25600
    v_mfma_f32_32x32x16_bf16 v[48:63], v[92:95], a[76:79], v[48:63]
    buffer_load_dword v21, v5, s[8:11], s81 offen sc1
    ds_read_b128 v[88:91], v2 offset:26624
    s_waitcnt lgkmcnt(3)
    v_mfma_f32_32x32x16_bf16 v[48:63], v[96:99], a[80:83], v[48:63]
    buffer_load_dword v21, v5, s[8:11], s83 offen sc1
    ds_read_b128 v[92:95], v2 offset:27648
    v_mfma_f32_32x32x16_bf16 v[48:63], v[100:103], a[84:87], v[48:63]
    ds_read_b128 v[96:99], v2 offset:28672
    v_mfma_f32_32x32x16_bf16 v[48:63], v[104:107], a[88:91], v[48:63]
    s_add_u32 s57, s50, 2
    s_and_b32 s57, s57, 14
    s_mul_i32 s57, s57, 640
    s_add_u32 s59, s57, s89
    buffer_load_dwordx4 v[128:131], v16, s[8:11], s59 offen offset:0 sc1
    ds_read_b128 v[100:103], v2 offset:29696
    v_mfma_f32_32x32x16_bf16 v[48:63], v[108:111], a[92:95], v[48:63]
    buffer_load_dwordx4 v[132:135], v16, s[8:11], s59 offen offset:640 sc1
    ds_read_b128 v[104:107], v2 offset:30720
    s_add_u32 s57, s50, 4
    s_and_b32 s57, s57, 14
    s_mul_i32 s57, s57, 640
    s_add_u32 s59, s57, s89
    s_waitcnt lgkmcnt(3)
    v_mfma_f32_32x32x16_bf16 v[48:63], v[80:83], a[96:99], v[48:63]
    buffer_load_dwordx4 v[136:139], v16, s[8:11], s59 offen offset:0 sc1
    ds_read_b128 v[108:111], v2 offset:31744
    v_mfma_f32_32x32x16_bf16 v[48:63], v[84:87], a[100:103], v[48:63]
    buffer_load_dwordx4 v[140:143], v16, s[8:11], s59 offen offset:640 sc1
    s_add_u32 s57, s50, 6
    s_and_b32 s57, s57, 14
    s_mul_i32 s57, s57, 640
    s_add_u32 s59, s57, s89
    v_mfma_f32_32x32x16_bf16 v[48:63], v[88:91], a[104:107], v[48:63]
    buffer_load_dwordx4 v[176:179], v16, s[8:11], s59 offen offset:0 sc1
    v_mfma_f32_32x32x16_bf16 v[48:63], v[92:95], a[108:111], v[48:63]
    buffer_load_dwordx4 v[180:183], v16, s[8:11], s59 offen offset:640 sc1
    s_add_u32 s57, s50, 8
    s_and_b32 s57, s57, 14
    s_mul_i32 s57, s57, 640
    s_add_u32 s59, s57, s89
    s_waitcnt lgkmcnt(0)
    v_mfma_f32_32x32x16_bf16 v[48:63], v[96:99], a[112:115], v[48:63]
    buffer_load_dwordx4 v[184:187], v16, s[8:11], s59 offen offset:0 sc1
    v_mfma_f32_32x32x16_bf16 v[48:63], v[100:103], a[116:119], v[48:63]
    buffer_load_dwordx4 v[188:191], v16, s[8:11], s59 offen offset:640 sc1
    s_add_u32 s57, s50, 10
    s_and_b32 s57, s57, 14
    s_mul_i32 s57, s57, 640
    s_add_u32 s59, s57, s89
    v_mfma_f32_32x32x16_bf16 v[48:63], v[104:107], a[120:123], v[48:63]
    buffer_load_dwordx4 v[192:195], v16, s[8:11], s59 offen offset:0 sc1
    v_mfma_f32_32x32x16_bf16 v[48:63], v[108:111], a[124:127], v[48:63]
    buffer_load_dwordx4 v[196:199], v16, s[8:11], s59 offen offset:640 sc1
    s_add_u32 s57, s50, 12
    s_and_b32 s57, s57, 14
    s_mul_i32 s57, s57, 640
    s_add_u32 s59, s57, s89
    s_barrier
    v_mfma_f32_32x32x16_bf16 v[48:63], a[138:141], v[40:43], v[48:63]
    buffer_load_dwordx4 v[200:203], v16, s[8:11], s59 offen offset:0 sc1
    s_nop 10
    v_cvt_pk_bf16_f32 v80, v48, v49
    buffer_load_dwordx4 v[204:207], v16, s[8:11], s59 offen offset:640 sc1
    v_cvt_pk_bf16_f32 v81, v50, v51
    v_cvt_pk_bf16_f32 v82, v52, v53
    v_cvt_pk_bf16_f32 v83, v54, v55
    v_cvt_pk_bf16_f32 v84, v56, v57
    v_cvt_pk_bf16_f32 v85, v58, v59
    v_mfma_f32_32x32x16_bf16 v[144:159], a[128:131], v[80:83], 0
    v_cvt_pk_bf16_f32 v86, v60, v61
    v_cvt_pk_bf16_f32 v87, v62, v63
    s_nop 1
    s_nop 1
    v_mfma_f32_32x32x16_bf16 v[160:175], a[132:135], v[84:87], 0
    s_nop 4
    v_max3_f32 v208, v144, v145, v146
    s_add_u32 s57, s50, 14
    s_and_b32 s57, s57, 14
    s_mul_i32 s57, s57, 640
    s_add_u32 s59, s57, s89
    buffer_load_dwordx4 v[48:51], v16, s[8:11], s59 offen offset:0 sc1
    buffer_load_dwordx4 v[52:55], v16, s[8:11], s59 offen offset:640 sc1
    v_max3_f32 v208, v208, v147, v148
    v_max3_f32 v208, v208, v149, v150
    v_max3_f32 v208, v208, v151, v152
    v_max3_f32 v208, v208, v153, v154
    v_max3_f32 v208, v208, v155, v156
    v_max3_f32 v208, v208, v157, v158
    v_max_f32 v208, v208, v159
    v_mul_f32 v208, -v208, v34
    s_add_u32 s57, s50, 16
    s_and_b32 s57, s57, 14
    s_mul_i32 s57, s57, 640
    s_add_u32 s59, s57, s89
    buffer_load_dwordx4 v[56:59], v16, s[8:11], s59 offen offset:0 sc1
    v_pk_fma_f32 v[144:145], v[144:145], v[34:35], v[208:209] op_sel_hi:[1,0,0]
    v_pk_fma_f32 v[146:147], v[146:147], v[34:35], v[208:209] op_sel_hi:[1,0,0]
    v_pk_fma_f32 v[148:149], v[148:149], v[34:35], v[208:209] op_sel_hi:[1,0,0]
    v_pk_fma_f32 v[150:151], v[150:151], v[34:35], v[208:209] op_sel_hi:[1,0,0]
    v_pk_fma_f32 v[152:153], v[152:153], v[34:35], v[208:209] op_sel_hi:[1,0,0]
    buffer_load_dwordx4 v[60:63], v16, s[8:11], s59 offen offset:640 sc1
    v_pk_fma_f32 v[154:155], v[154:155], v[34:35], v[208:209] op_sel_hi:[1,0,0]
    v_pk_fma_f32 v[156:157], v[156:157], v[34:35], v[208:209] op_sel_hi:[1,0,0]
    v_pk_fma_f32 v[158:159], v[158:159], v[34:35], v[208:209] op_sel_hi:[1,0,0]
    v_exp_f32 v144, v144
    v_exp_f32 v145, v145
    v_exp_f32 v146, v146
    v_exp_f32 v147, v147
    v_exp_f32 v148, v148
    v_exp_f32 v149, v149
    v_exp_f32 v150, v150
    v_exp_f32 v151, v151
    v_exp_f32 v152, v152
    v_exp_f32 v153, v153
    v_exp_f32 v154, v154
    v_exp_f32 v155, v155
    v_exp_f32 v156, v156
    v_exp_f32 v157, v157
    v_exp_f32 v158, v158
    v_exp_f32 v159, v159
    v_pk_add_f32 v[210:211], v[144:145], v[146:147]
    v_pk_add_f32 v[210:211], v[210:211], v[148:149]
    v_pk_add_f32 v[210:211], v[210:211], v[150:151]
    v_pk_add_f32 v[210:211], v[210:211], v[152:153]
    v_pk_add_f32 v[210:211], v[210:211], v[154:155]
    v_pk_add_f32 v[210:211], v[210:211], v[156:157]
    v_pk_add_f32 v[210:211], v[210:211], v[158:159]
    v_add_f32 v210, v210, v211
    v_rcp_f32_e64 v210, v210
    s_nop 0
    v_pk_mul_f32 v[144:145], v[144:145], v[210:211] op_sel_hi:[1,0]
    v_pk_mul_f32 v[146:147], v[146:147], v[210:211] op_sel_hi:[1,0]
    v_pk_mul_f32 v[148:149], v[148:149], v[210:211] op_sel_hi:[1,0]
    v_pk_mul_f32 v[150:151], v[150:151], v[210:211] op_sel_hi:[1,0]
    v_cvt_pk_bf16_f32 v64, v144, v145
    v_cvt_pk_bf16_f32 v65, v146, v147
    v_cvt_pk_bf16_f32 v66, v148, v149
    v_cvt_pk_bf16_f32 v67, v150, v151
    v_pk_mul_f32 v[152:153], v[152:153], v[210:211] op_sel_hi:[1,0]
    v_pk_mul_f32 v[154:155], v[154:155], v[210:211] op_sel_hi:[1,0]
    v_pk_mul_f32 v[156:157], v[156:157], v[210:211] op_sel_hi:[1,0]
    v_pk_mul_f32 v[158:159], v[158:159], v[210:211] op_sel_hi:[1,0]
    v_cvt_pk_bf16_f32 v68, v152, v153
    v_cvt_pk_bf16_f32 v69, v154, v155
    v_cvt_pk_bf16_f32 v70, v156, v157
    v_cvt_pk_bf16_f32 v71, v158, v159
    v_max3_f32 v208, v160, v161, v162
    v_max3_f32 v208, v208, v163, v164
    v_max3_f32 v208, v208, v165, v166
    v_max3_f32 v208, v208, v167, v168
    v_max3_f32 v208, v208, v169, v170
    v_max3_f32 v208, v208, v171, v172
    v_max3_f32 v208, v208, v173, v174
    v_max_f32_e64 v208, v208, v175
    v_mul_f32 v208, -v208, v34
    v_pk_fma_f32 v[160:161], v[160:161], v[34:35], v[208:209] op_sel_hi:[1,0,0]
    v_pk_fma_f32 v[162:163], v[162:163], v[34:35], v[208:209] op_sel_hi:[1,0,0]
    v_pk_fma_f32 v[164:165], v[164:165], v[34:35], v[208:209] op_sel_hi:[1,0,0]
    v_pk_fma_f32 v[166:167], v[166:167], v[34:35], v[208:209] op_sel_hi:[1,0,0]
    v_pk_fma_f32 v[168:169], v[168:169], v[34:35], v[208:209] op_sel_hi:[1,0,0]
    v_pk_fma_f32 v[170:171], v[170:171], v[34:35], v[208:209] op_sel_hi:[1,0,0]
    v_pk_fma_f32 v[172:173], v[172:173], v[34:35], v[208:209] op_sel_hi:[1,0,0]
    v_pk_fma_f32 v[174:175], v[174:175], v[34:35], v[208:209] op_sel_hi:[1,0,0]
    v_exp_f32 v160, v160
    v_exp_f32 v161, v161
    v_exp_f32 v162, v162
    v_exp_f32 v163, v163
    v_exp_f32 v164, v164
    v_exp_f32 v165, v165
    v_exp_f32 v166, v166
    v_exp_f32 v167, v167
    v_exp_f32 v168, v168
    v_exp_f32 v169, v169
    v_exp_f32 v170, v170
    v_exp_f32 v171, v171
    v_exp_f32 v172, v172
    v_exp_f32 v173, v173
    v_exp_f32 v174, v174
    v_exp_f32 v175, v175
    v_pk_add_f32 v[210:211], v[160:161], v[162:163]
    v_pk_add_f32 v[210:211], v[210:211], v[164:165]
    v_pk_add_f32 v[210:211], v[210:211], v[166:167]
    v_pk_add_f32 v[210:211], v[210:211], v[168:169]
    v_pk_add_f32 v[210:211], v[210:211], v[170:171]
    v_pk_add_f32 v[210:211], v[210:211], v[172:173]
    v_pk_add_f32 v[210:211], v[210:211], v[174:175]
    v_add_f32 v210, v210, v211
    v_rcp_f32_e64 v210, v210
    s_nop 0
    v_pk_mul_f32 v[160:161], v[160:161], v[210:211] op_sel_hi:[1,0]
    v_pk_mul_f32 v[162:163], v[162:163], v[210:211] op_sel_hi:[1,0]
    v_pk_mul_f32 v[164:165], v[164:165], v[210:211] op_sel_hi:[1,0]
    v_pk_mul_f32 v[166:167], v[166:167], v[210:211] op_sel_hi:[1,0]
    v_cvt_pk_bf16_f32 v72, v160, v161
    v_cvt_pk_bf16_f32 v73, v162, v163
    v_cvt_pk_bf16_f32 v74, v164, v165
    v_cvt_pk_bf16_f32 v75, v166, v167
    v_pk_mul_f32 v[168:169], v[168:169], v[210:211] op_sel_hi:[1,0]
    v_pk_mul_f32 v[170:171], v[170:171], v[210:211] op_sel_hi:[1,0]
    v_pk_mul_f32 v[172:173], v[172:173], v[210:211] op_sel_hi:[1,0]
    v_pk_mul_f32 v[174:175], v[174:175], v[210:211] op_sel_hi:[1,0]
    v_cvt_pk_bf16_f32 v76, v168, v169
    v_cvt_pk_bf16_f32 v77, v170, v171
    v_cvt_pk_bf16_f32 v78, v172, v173
    v_cvt_pk_bf16_f32 v79, v174, v175
    s_add_u32 m0, s56, 98304
    s_add_u32 s60, s62, 32768
    s_waitcnt vmcnt(14)
    v_mfma_f32_32x32x16_bf16 v[112:127], a[148:151], v[128:131], 0
    buffer_load_dwordx4 v1, s[8:11], s60 offen sc1 lds
    v_mfma_f32_32x32x16_bf16 v[112:127], a[148:151], v[132:135], v[112:127]
    buffer_load_dwordx4 v1, s[8:11], s60 offen offset:1024 sc1 lds
    s_waitcnt vmcnt(14)
    v_mfma_f32_32x32x16_bf16 v[112:127], a[148:151], v[136:139], v[112:127]
    buffer_load_dwordx4 v1, s[8:11], s60 offen offset:2048 sc1 lds
    v_mfma_f32_32x32x16_bf16 v[112:127], a[148:151], v[140:143], v[112:127]
    buffer_load_dwordx4 v1, s[8:11], s60 offen offset:3072 sc1 lds
    s_add_u32 m0, s56, 114688
    s_add_u32 s60, s62, 49152
    s_waitcnt vmcnt(14)
    v_mfma_f32_32x32x16_bf16 v[112:127], a[148:151], v[176:179], v[112:127]
    buffer_load_dwordx4 v1, s[8:11], s60 offen sc1 lds
    v_mfma_f32_32x32x16_bf16 v[112:127], a[148:151], v[180:183], v[112:127]
    buffer_load_dwordx4 v1, s[8:11], s60 offen offset:1024 sc1 lds
    s_waitcnt vmcnt(14)
    v_mfma_f32_32x32x16_bf16 v[112:127], a[148:151], v[184:187], v[112:127]
    buffer_load_dwordx4 v1, s[8:11], s60 offen offset:2048 sc1 lds
    v_mfma_f32_32x32x16_bf16 v[112:127], a[148:151], v[188:191], v[112:127]
    buffer_load_dwordx4 v1, s[8:11], s60 offen offset:3072 sc1 lds
    s_waitcnt vmcnt(14)
    v_mfma_f32_32x32x16_bf16 v[112:127], a[148:151], v[192:195], v[112:127]
    v_mfma_f32_32x32x16_bf16 v[112:127], a[148:151], v[196:199], v[112:127]
    s_waitcnt vmcnt(12)
    v_mfma_f32_32x32x16_bf16 v[112:127], a[148:151], v[200:203], v[112:127]
    v_mfma_f32_32x32x16_bf16 v[112:127], a[148:151], v[204:207], v[112:127]
    s_waitcnt vmcnt(10)
    v_mfma_f32_32x32x16_bf16 v[112:127], a[148:151], v[48:51], v[112:127]
    v_mfma_f32_32x32x16_bf16 v[112:127], a[148:151], v[52:55], v[112:127]
    s_waitcnt vmcnt(8)
    v_mfma_f32_32x32x16_bf16 v[112:127], a[148:151], v[56:59], v[112:127]
    v_mfma_f32_32x32x16_bf16 v[112:127], a[148:151], v[60:63], v[112:127]
    s_nop 11
    v_cmp_u_f32 vcc, v112, v112
    v_cvt_pk_bf16_f32 v80, v112, v113
    v_cvt_pk_bf16_f32 v81, v114, v115
    v_cvt_pk_bf16_f32 v82, v116, v117
    v_cvt_pk_bf16_f32 v83, v118, v119
    s_cbranch_vccnz L_late_79_a
L_summed_80:
    ds_write_b128 v19, v[80:83]
    s_waitcnt lgkmcnt(0)
    s_barrier
    ds_read_b128 v[80:83], v2 offset:0
    ds_read_b128 v[84:87], v2 offset:1024
    ds_read_b128 v[88:91], v2 offset:2048
    ds_read_b128 v[92:95], v2 offset:3072
    s_add_u32 s68, s86, 131072
    s_waitcnt lgkmcnt(2)
    v_mfma_f32_32x32x16_bf16 v[144:159], v[80:83], v[64:67], 0
    v_mfma_f32_32x32x16_bf16 v[144:159], v[84:87], v[68:71], v[144:159]
    s_waitcnt lgkmcnt(0)
    s_nop 2
    v_mfma_f32_32x32x16_bf16 v[160:175], v[88:91], v[72:75], 0
    s_nop 5
    v_mfma_f32_32x32x16_bf16 v[160:175], v[92:95], v[76:79], v[160:175]
    v_add_f32 v152, 0x358637bd, v152
    v_rcp_f32 v152, v152
    s_nop 0
    v_mul_f32 v144, v144, v152
    v_mul_f32 v145, v145, v152
    v_mul_f32 v146, v146, v152
    v_mul_f32 v147, v147, v152
    v_mul_f32 v148, v148, v152
    v_mul_f32 v149, v149, v152
    v_mul_f32 v150, v150, v152
    v_mul_f32_e64 v151, v151, v152
    v_cvt_pk_bf16_f32 v96, v144, v145
    v_cvt_pk_bf16_f32 v97, v146, v147
    v_cvt_pk_bf16_f32 v98, v148, v149
    v_cvt_pk_bf16_f32 v99, v150, v151
    v_add_f32 v168, 0x358637bd, v168
    v_rcp_f32 v168, v168
    s_nop 0
    v_pk_mul_f32 v[160:161], v[160:161], v[168:169] op_sel_hi:[1,0]
    v_pk_mul_f32 v[162:163], v[162:163], v[168:169] op_sel_hi:[1,0]
    v_pk_mul_f32 v[164:165], v[164:165], v[168:169] op_sel_hi:[1,0]
    v_pk_mul_f32 v[166:167], v[166:167], v[168:169] op_sel_hi:[1,0]
    v_cvt_pk_bf16_f32 v100, v160, v161
    v_cvt_pk_bf16_f32 v101, v162, v163
    v_cvt_pk_bf16_f32 v102, v164, v165
    v_cvt_pk_bf16_f32 v103, v166, v167
    s_cmp_eq_u32 s53, 0
    s_cbranch_scc1 L_dev_97
    buffer_store_dwordx4 v[96:99], v1, s[4:7], s68 offen
    buffer_store_dwordx4 v[100:103], v1, s[4:7], s68 offen offset:1024
L_st_98:
    v_lshlrev_b32 v48, 16, v212
    v_and_b32 v49, 0xffff0000, v212
    v_lshlrev_b32 v50, 16, v213
    v_and_b32 v51, 0xffff0000, v213
    v_lshlrev_b32 v52, 16, v214
    v_and_b32 v53, 0xffff0000, v214
    v_lshlrev_b32 v54, 16, v215
    v_and_b32 v55, 0xffff0000, v215
    v_lshlrev_b32 v56, 16, v220
    v_and_b32 v57, 0xffff0000, v220
    v_lshlrev_b32 v58, 16, v221
    v_and_b32 v59, 0xffff0000, v221
    v_lshlrev_b32 v60, 16, v222
    v_and_b32 v61, 0xffff0000, v222
    v_lshlrev_b32 v62, 16, v223
    v_and_b32 v63, 0xffff0000, v223
    v_add_u32 v28, 11, v24
    s_mov_b64 exec, 1
    s_cmp_eq_u32 s53, 0
    s_cbranch_scc1 L_dev_99
    s_waitcnt vmcnt(0)
    buffer_store_dword v28, off, s[8:11], s82
L_sg_100:
    s_mov_b64 exec, -1
    s_barrier
    s_lshl_b32 s58, s74, 14
    ds_read_b128 v[80:83], v22 offset:32768
    ds_read_b128 v[84:87], v23 offset:32768
    ds_read_b128 v[88:91], v22 offset:36864
    ds_read_b128 v[92:95], v23 offset:36864
    ds_read_b128 v[96:99], v22 offset:40960
    ds_read_b128 v[100:103], v23 offset:40960
    buffer_load_dword v30, v5, s[8:11], s85 offen sc1
    s_add_u32 s57, s44, 11
    s_add_u32 s59, s58, 131072
L_poll_101:
L_page_7:
    s_cbranch_execz L_main
    s_sub_u32 s54, s54, 1
    s_cbranch_scc1 L_abort
    buffer_load_dword v31, v5, s[8:11], s85 offen sc1
    s_waitcnt vmcnt(1)
    v_cmp_gt_u32 vcc, s57, v30
    s_nop 0
    s_cbranch_vccz L_done_102
    buffer_load_dword v30, v5, s[8:11], s85 offen sc1
    s_waitcnt vmcnt(1)
    v_cmp_gt_u32 vcc, s57, v31
    s_nop 0
    s_cbranch_vccnz L_poll_101
L_done_102:
    buffer_load_dwordx4 a[0:3], v1, s[4:7], s59 offen sc1
    buffer_load_dwordx4 a[4:7], v1, s[4:7], s59 offen offset:1024 sc1
    buffer_load_dwordx4 a[8:11], v1, s[4:7], s59 offen offset:2048 sc1
    buffer_load_dwordx4 a[12:15], v1, s[4:7], s59 offen offset:3072 sc1
    s_add_u32 s59, s58, 135168
    buffer_load_dwordx4 a[16:19], v1, s[4:7], s59 offen sc1
    buffer_load_dwordx4 a[20:23], v1, s[4:7], s59 offen offset:1024 sc1
    buffer_load_dwordx4 a[24:27], v1, s[4:7], s59 offen offset:2048 sc1
    buffer_load_dwordx4 a[28:31], v1, s[4:7], s59 offen offset:3072 sc1
    s_waitcnt vmcnt(7) lgkmcnt(4)
    v_mfma_f32_32x32x16_bf16 v[112:127], v[84:87], a[0:3], 0
    s_add_u32 s59, s58, 139264
    buffer_load_dwordx4 a[32:35], v1, s[4:7], s59 offen sc1
    ds_read_b128 v[104:107], v22 offset:45056
    v_mfma_f32_32x32x16_bf16 v[48:63], v[80:83], a[0:3], v[48:63]
    ds_read_b128 v[108:111], v23 offset:45056
    s_waitcnt vmcnt(7) lgkmcnt(4)
    v_mfma_f32_32x32x16_bf16 v[112:127], v[92:95], a[4:7], v[112:127]
    buffer_load_dwordx4 a[36:39], v1, s[4:7], s59 offen offset:1024 sc1
    ds_read_b128 v[80:83], v22 offset:49152
    v_mfma_f32_32x32x16_bf16 v[48:63], v[88:91], a[4:7], v[48:63]
    ds_read_b128 v[84:87], v23 offset:49152
    s_waitcnt vmcnt(7) lgkmcnt(4)
    v_mfma_f32_32x32x16_bf16 v[112:127], v[100:103], a[8:11], v[112:127]
    buffer_load_dwordx4 a[40:43], v1, s[4:7], s59 offen offset:2048 sc1
    ds_read_b128 v[88:91], v22 offset:53248
    v_mfma_f32_32x32x16_bf16 v[48:63], v[96:99], a[8:11], v[48:63]
    ds_read_b128 v[92:95], v23 offset:53248
    s_waitcnt vmcnt(7) lgkmcnt(4)
    v_mfma_f32_32x32x16_bf16 v[112:127], v[108:111], a[12:15], v[112:127]
    buffer_load_dwordx4 a[44:47], v1, s[4:7], s59 offen offset:3072 sc1
    ds_read_b128 v[96:99], v22 offset:57344
    v_mfma_f32_32x32x16_bf16 v[48:63], v[104:107], a[12:15], v[48:63]
    ds_read_b128 v[100:103], v23 offset:57344
    s_add_u32 s59, s58, 143360
    s_waitcnt vmcnt(7) lgkmcnt(4)
    v_mfma_f32_32x32x16_bf16 v[112:127], v[84:87], a[16:19], v[112:127]
    buffer_load_dwordx4 a[48:51], v1, s[4:7], s59 offen sc1
    ds_read_b128 v[104:107], v22 offset:61440
    v_mfma_f32_32x32x16_bf16 v[48:63], v[80:83], a[16:19], v[48:63]
    ds_read_b128 v[108:111], v23 offset:61440
    s_waitcnt vmcnt(7) lgkmcnt(4)
    v_mfma_f32_32x32x16_bf16 v[112:127], v[92:95], a[20:23], v[112:127]
    buffer_load_dwordx4 a[52:55], v1, s[4:7], s59 offen offset:1024 sc1
    ds_read_b128 v[80:83], v22 offset:0
    v_mfma_f32_32x32x16_bf16 v[48:63], v[88:91], a[20:23], v[48:63]
    ds_read_b128 v[84:87], v23 offset:0
    s_waitcnt vmcnt(7) lgkmcnt(4)
    v_mfma_f32_32x32x16_bf16 v[112:127], v[100:103], a[24:27], v[112:127]
    buffer_load_dwordx4 a[56:59], v1, s[4:7], s59 offen offset:2048 sc1
    ds_read_b128 v[88:91], v22 offset:4096
    v_mfma_f32_32x32x16_bf16 v[48:63], v[96:99], a[24:27], v[48:63]
    ds_read_b128 v[92:95], v23 offset:4096
    s_waitcnt vmcnt(7) lgkmcnt(4)
    v_mfma_f32_32x32x16_bf16 v[112:127], v[108:111], a[28:31], v[112:127]
    buffer_load_dwordx4 a[60:63], v1, s[4:7], s59 offen offset:3072 sc1
    ds_read_b128 v[96:99], v22 offset:8192
    v_mfma_f32_32x32x16_bf16 v[48:63], v[104:107], a[28:31], v[48:63]
    ds_read_b128 v[100:103], v23 offset:8192
    s_waitcnt vmcnt(7) lgkmcnt(4)
    s_getpc_b64 s[46:47]
L_pc_103:
    s_lshr_b32 s57, s2, 3
    s_lshl_b32 s57, s57, 11
    v_lshrrev_b32 v29, 4, v0
    v_lshl_add_u32 v29, v29, 7, s57
    v_min_u32 v29, L_code_end-L_pc_103-4, v29
    global_load_dword v21, v29, s[46:47]
    v_mfma_f32_32x32x16_bf16 v[112:127], v[84:87], a[32:35], v[112:127]
    ds_read_b128 v[104:107], v22 offset:12288
    s_add_u32 m0, s56, 65536
    s_add_u32 s60, s64, 65536
    v_mfma_f32_32x32x16_bf16 v[48:63], v[80:83], a[32:35], v[48:63]
    buffer_load_dwordx4 v1, s[8:11], s60 offen sc1 lds
    ds_read_b128 v[108:111], v23 offset:12288
    s_waitcnt vmcnt(8) lgkmcnt(4)
    v_mfma_f32_32x32x16_bf16 v[112:127], v[92:95], a[36:39], v[112:127]
    ds_read_b128 v[80:83], v22 offset:16384
    v_mfma_f32_32x32x16_bf16 v[48:63], v[88:91], a[36:39], v[48:63]
    buffer_load_dwordx4 v1, s[8:11], s60 offen offset:1024 sc1 lds
    ds_read_b128 v[84:87], v23 offset:16384
    s_waitcnt vmcnt(8) lgkmcnt(4)
    v_mfma_f32_32x32x16_bf16 v[112:127], v[100:103], a[40:43], v[112:127]
    ds_read_b128 v[88:91], v22 offset:20480
    v_mfma_f32_32x32x16_bf16 v[48:63], v[96:99], a[40:43], v[48:63]
    buffer_load_dwordx4 v1, s[8:11], s60 offen offset:2048 sc1 lds
    ds_read_b128 v[92:95], v23 offset:20480
    s_waitcnt vmcnt(8) lgkmcnt(4)
    v_mfma_f32_32x32x16_bf16 v[112:127], v[108:111], a[44:47], v[112:127]
    ds_read_b128 v[96:99], v22 offset:24576
    v_mfma_f32_32x32x16_bf16 v[48:63], v[104:107], a[44:47], v[48:63]
    buffer_load_dwordx4 v1, s[8:11], s60 offen offset:3072 sc1 lds
    ds_read_b128 v[100:103], v23 offset:24576
    s_waitcnt vmcnt(8) lgkmcnt(4)
    v_mfma_f32_32x32x16_bf16 v[112:127], v[84:87], a[48:51], v[112:127]
    ds_read_b128 v[104:107], v22 offset:28672
    s_add_u32 m0, s56, 81920
    s_add_u32 s60, s64, 81920
    v_mfma_f32_32x32x16_bf16 v[48:63], v[80:83], a[48:51], v[48:63]
    buffer_load_dwordx4 v1, s[8:11], s60 offen sc1 lds
    ds_read_b128 v[108:111], v23 offset:28672
    s_waitcnt vmcnt(8) lgkmcnt(4)
    v_mfma_f32_32x32x16_bf16 v[112:127], v[92:95], a[52:55], v[112:127]
    buffer_load_dwordx4 v1, s[8:11], s60 offen offset:1024 sc1 lds
    s_waitcnt vmcnt(8) lgkmcnt(2)
    v_mfma_f32_32x32x16_bf16 v[112:127], v[100:103], a[56:59], v[112:127]
    buffer_load_dwordx4 v1, s[8:11], s60 offen offset:2048 sc1 lds
    s_waitcnt vmcnt(8) lgkmcnt(0)
    v_mfma_f32_32x32x16_bf16 v[112:127], v[108:111], a[60:63], v[112:127]
    buffer_load_dwordx4 v1, s[8:11], s60 offen offset:3072 sc1 lds
    s_nop 2
    v_mfma_f32_32x32x16_bf16 v[48:63], v[88:91], a[52:55], v[48:63]
    s_barrier
    s_nop 5
    v_cvt_pk_bf16_f32 v72, v112, v113
    v_cvt_pk_bf16_f32 v73, v114, v115
    v_cvt_pk_bf16_f32 v74, v116, v117
    v_cvt_pk_bf16_f32 v75, v118, v119
    ds_write_b128 v17, v[72:75] offset:0
    v_mfma_f32_32x32x16_bf16 v[48:63], v[96:99], a[56:59], v[48:63]
    v_cvt_pk_bf16_f32 v76, v120, v121
    v_cvt_pk_bf16_f32 v77, v122, v123
    v_cvt_pk_bf16_f32 v78, v124, v125
    v_cvt_pk_bf16_f32 v79, v126, v127
    ds_write_b128 v17, v[76:79] offset:1024
    v_mfma_f32_32x32x16_bf16 v[48:63], v[104:107], a[60:63], v[48:63]
    s_waitcnt lgkmcnt(0)
    s_barrier
    ds_read_b128 v[176:179], v18 offset:0
    ds_read_b128 v[180:183], v18 offset:1024
    s_add_u32 s68, s67, 0
    s_waitcnt lgkmcnt(1)
    s_nop 5
    v_dot2_f32_bf16 v48, v176, s87, v48
    v_dot2_f32_bf16 v49, v176, s88, v49
    v_dot2_f32_bf16 v50, v177, s87, v50
    v_dot2_f32_bf16 v51, v177, s88, v51
    v_dot2_f32_bf16 v52, v178, s87, v52
    v_dot2_f32_bf16 v53, v178, s88, v53
    v_dot2_f32_bf16 v54, v179, s87, v54
    v_dot2_f32_bf16 v55, v179, s88, v55
    s_waitcnt lgkmcnt(0)
    v_dot2_f32_bf16 v56, v180, s87, v56
    v_dot2_f32_bf16 v57, v180, s88, v57
    v_dot2_f32_bf16 v58, v181, s87, v58
    v_dot2_f32_bf16 v59, v181, s88, v59
    v_dot2_f32_bf16 v60, v182, s87, v60
    v_dot2_f32_bf16 v61, v182, s88, v61
    v_dot2_f32_bf16 v62, v183, s87, v62
    v_dot2_f32_bf16 v63, v183, s88, v63
    v_cvt_pk_bf16_f32 v64, v48, v49
    v_cvt_pk_bf16_f32 v65, v50, v51
    v_cvt_pk_bf16_f32 v66, v52, v53
    v_cvt_pk_bf16_f32 v67, v54, v55
    v_cvt_pk_bf16_f32 v68, v56, v57
    v_cvt_pk_bf16_f32 v69, v58, v59
    v_cvt_pk_bf16_f32 v70, v60, v61
    v_cvt_pk_bf16_f32 v71, v62, v63
    s_cmp_eq_u32 s53, 0
    s_cbranch_scc1 L_dev_104
    buffer_store_dwordx4 v[64:67], v1, s[4:7], s68 offen
    buffer_store_dwordx4 v[68:71], v1, s[4:7], s68 offen offset:1024
L_st_105:
    v_dot2_f32_bf16 v176, v64, s71, 0
    v_dot2_f32_bf16 v177, v64, v64, 0
    v_dot2_f32_bf16 v176, v65, s71, v176
    v_dot2_f32_bf16 v177, v65, v65, v177
    v_dot2_f32_bf16 v176, v66, s71, v176
    v_dot2_f32_bf16 v177, v66, v66, v177
    v_dot2_f32_bf16 v176, v67, s71, v176
    v_dot2_f32_bf16 v177, v67, v67, v177
    v_dot2_f32_bf16 v176, v68, s71, v176
    v_dot2_f32_bf16 v177, v68, v68, v177
    v_dot2_f32_bf16 v176, v69, s71, v176
    v_dot2_f32_bf16 v177, v69, v69, v177
    v_dot2_f32_bf16 v176, v70, s71, v176
    v_dot2_f32_bf16 v177, v70, v70, v177
    v_dot2_f32_bf16 v176, v71, s71, v176
    v_dot2_f32_bf16 v177, v71, v71, v177
    s_nop 2
    v_permlane32_swap_b32 v176, v177
    v_add_f32 v176, v176, v177
    s_cmp_eq_u32 s53, 0
    s_cbranch_scc1 L_dev_106
    buffer_store_dword v176, v39, s[4:7], s73 offen
L_st_107:
    v_add_u32 v28, 2, v24
    s_mov_b64 exec, 1
    s_cmp_eq_u32 s53, 0
    s_cbranch_scc1 L_dev_108
    s_waitcnt vmcnt(0)
    buffer_store_dword v28, off, s[8:11], s84
L_sg_109:
    s_mov_b64 exec, -1
    s_barrier
    s_lshl_b32 s70, s50, 2
    s_add_u32 s70, s70, s52
    s_lshl_b32 s70, s70, 15
    s_bfe_u32 s57, s79, 0x4000b
    s_lshl_b32 s57, s57, 6
    s_add_u32 s70, s70, s57
    s_lshl_b32 s75, s52, 17
    s_lshl_b32 s57, s51, 10
    s_add_u32 s75, s75, s57
    s_add_u32 s75, s75, 1048576
    s_lshl_b32 s58, s52, 15
    s_add_u32 s58, s58, 0
    s_lshl_b32 s69, s52, 12
    s_add_u32 s69, s69, 262144
    s_add_u32 s58, s79, 0
    ds_read_b128 v[80:83], v1 offset:0
    ds_read_b128 v[84:87], v1 offset:32768
    ds_read_b128 v[88:91], v2 offset:0
    ds_read_b128 v[92:95], v1 offset:1024
    ds_read_b128 v[96:99], v1 offset:33792
    ds_read_b128 v[100:103], v1 offset:2048
    ds_read_b128 v[104:107], v1 offset:34816
    buffer_load_dword v30, v5, s[8:11], s83 offen sc1
    s_add_u32 s57, s44, 2
    s_xor_b32 s59, s58, 0
L_poll_110:
    s_sub_u32 s54, s54, 1
    s_cbranch_scc1 L_abort
    buffer_load_dword v31, v5, s[8:11], s83 offen sc1
    s_waitcnt vmcnt(1)
    v_cmp_gt_u32 vcc, s57, v30
    s_nop 0
    s_cbranch_vccz L_done_111
    buffer_load_dword v30, v5, s[8:11], s83 offen sc1
    s_waitcnt vmcnt(1)
    v_cmp_gt_u32 vcc, s57, v31
    s_nop 0
    s_cbranch_vccnz L_poll_110
L_done_111:
    buffer_load_dwordx4 a[0:3], v1, s[4:7], s59 offen offset:0 sc1
    buffer_load_dwordx4 a[4:7], v1, s[4:7], s59 offen offset:1024 sc1
    s_xor_b32 s59, s58, 2048
    buffer_load_dwordx4 a[8:11], v1, s[4:7], s59 offen offset:0 sc1
    buffer_load_dwordx4 a[12:15], v1, s[4:7], s59 offen offset:1024 sc1
    s_xor_b32 s59, s58, 4096
    buffer_load_dwordx4 a[16:19], v1, s[4:7], s59 offen offset:0 sc1
    buffer_load_dwordx4 a[20:23], v1, s[4:7], s59 offen offset:1024 sc1
    s_xor_b32 s59, s58, 6144
    buffer_load_dwordx4 a[24:27], v1, s[4:7], s59 offen offset:0 sc1
    buffer_load_dwordx4 a[28:31], v1, s[4:7], s59 offen offset:1024 sc1
    s_waitcnt vmcnt(7) lgkmcnt(3)
    v_mfma_f32_32x32x16_bf16 v[112:127], v[80:83], a[0:3], 0
    s_xor_b32 s59, s58, 8192
    buffer_load_dwordx4 a[32:35], v1, s[4:7], s59 offen offset:0 sc1
    ds_read_b128 v[108:111], v2 offset:1024
    v_mov_b32 v72, -1
    v_mov_b32 v73, -1
    v_mfma_f32_32x32x16_bf16 v[128:143], v[84:87], a[0:3], 0
    ds_read_b128 v[80:83], v1 offset:3072
    v_mov_b32 v74, -1
    v_mov_b32 v75, -1
    v_mfma_f32_32x32x16_bf16 v[144:159], v[88:91], a[0:3], 0
    ds_read_b128 v[84:87], v1 offset:35840
    s_waitcnt vmcnt(7)
    v_mfma_f32_32x32x16_bf16 v[112:127], v[92:95], a[4:7], v[112:127]
    buffer_load_dwordx4 a[36:39], v1, s[4:7], s59 offen offset:1024 sc1
    ds_read_b128 v[88:91], v1 offset:4096
    s_waitcnt lgkmcnt(3)
    v_mfma_f32_32x32x16_bf16 v[128:143], v[96:99], a[4:7], v[128:143]
    ds_read_b128 v[92:95], v1 offset:36864
    s_xor_b32 s59, s58, 10240
    s_waitcnt vmcnt(7)
    v_mfma_f32_32x32x16_bf16 v[112:127], v[100:103], a[8:11], v[112:127]
    buffer_load_dwordx4 a[40:43], v1, s[4:7], s59 offen offset:0 sc1
    ds_read_b128 v[96:99], v2 offset:2048
    v_mfma_f32_32x32x16_bf16 v[128:143], v[104:107], a[8:11], v[128:143]
    ds_read_b128 v[100:103], v1 offset:5120
    v_accvgpr_read_b32 v64, a0
    v_accvgpr_read_b32 v65, a1
    v_accvgpr_read_b32 v66, a2
    v_accvgpr_read_b32 v67, a3
    v_accvgpr_read_b32 v68, a4
    v_accvgpr_read_b32 v69, a5
    v_mfma_f32_32x32x16_bf16 v[144:159], v[108:111], a[4:7], v[144:159]
    ds_read_b128 v[104:107], v1 offset:37888
    v_accvgpr_read_b32 v70, a6
    v_accvgpr_read_b32 v71, a7
    v_lshlrev_b32 v48, 16, v64
    v_and_b32 v49, 0xffff0000, v64
    v_lshlrev_b32 v50, 16, v65
    s_waitcnt vmcnt(7) lgkmcnt(3)
    v_mfma_f32_32x32x16_bf16 v[112:127], v[80:83], a[12:15], v[112:127]
    buffer_load_dwordx4 a[44:47], v1, s[4:7], s59 offen offset:1024 sc1
    ds_read_b128 v[108:111], v1 offset:6144
    v_and_b32 v51, 0xffff0000, v65
    v_lshlrev_b32 v52, 16, v66
    v_mfma_f32_32x32x16_bf16 v[128:143], v[84:87], a[12:15], v[128:143]
    ds_read_b128 v[80:83], v1 offset:38912
    s_xor_b32 s59, s58, 12288
    v_and_b32 v53, 0xffff0000, v66
    v_lshlrev_b32 v54, 16, v67
    v_and_b32 v55, 0xffff0000, v67
    v_lshlrev_b32 v56, 16, v68
    s_waitcnt vmcnt(7)
    v_mfma_f32_32x32x16_bf16 v[112:127], v[88:91], a[16:19], v[112:127]
    buffer_load_dwordx4 a[48:51], v1, s[4:7], s59 offen offset:0 sc1
    ds_read_b128 v[84:87], v2 offset:3072
    ds_write_b128 v35, a[248:251] offset:32768
    v_and_b32 v57, 0xffff0000, v68
    v_mfma_f32_32x32x16_bf16 v[128:143], v[92:95], a[16:19], v[128:143]
    buffer_load_dwordx4 v[176:179], v1, s[4:7], s69 offen offset:0 sc1
    ds_read_b128 v[88:91], v1 offset:7168
    v_lshlrev_b32 v58, 16, v69
    s_waitcnt lgkmcnt(4)
    v_mfma_f32_32x32x16_bf16 v[144:159], v[96:99], a[8:11], v[144:159]
    ds_read_b128 v[92:95], v1 offset:39936
    v_and_b32 v59, 0xffff0000, v69
    v_lshlrev_b32 v60, 16, v70
    v_and_b32 v61, 0xffff0000, v70
    v_lshlrev_b32 v62, 16, v71
    v_and_b32 v63, 0xffff0000, v71
    s_waitcnt vmcnt(8)
    v_mfma_f32_32x32x16_bf16 v[112:127], v[100:103], a[20:23], v[112:127]
    buffer_load_dwordx4 a[52:55], v1, s[4:7], s59 offen offset:1024 sc1
    ds_read_b128 v[96:99], v1 offset:8192
    v_mfma_f32_32x32x16_bf16 v[128:143], v[104:107], a[20:23], v[128:143]
    ds_read_b128 v[100:103], v1 offset:40960
    s_xor_b32 s59, s58, 14336
    s_waitcnt vmcnt(8)
    v_mfma_f32_32x32x16_bf16 v[112:127], v[108:111], a[24:27], v[112:127]
    buffer_load_dwordx4 a[56:59], v1, s[4:7], s59 offen offset:0 sc1
    ds_read_b128 v[104:107], v2 offset:4096
    s_waitcnt lgkmcnt(3)
    v_mfma_f32_32x32x16_bf16 v[128:143], v[80:83], a[24:27], v[128:143]
    ds_read_b128 v[108:111], v1 offset:9216
    ds_write_b128 v35, a[252:255] offset:36864
    v_mfma_f32_32x32x16_bf16 v[144:159], v[84:87], a[12:15], v[144:159]
    ds_read_b128 v[80:83], v1 offset:41984
    s_waitcnt vmcnt(8)
    v_mfma_f32_32x32x16_bf16 v[112:127], v[88:91], a[28:31], v[112:127]
    buffer_load_dwordx4 a[60:63], v1, s[4:7], s59 offen offset:1024 sc1
    ds_read_b128 v[84:87], v1 offset:10240
    v_mfma_f32_32x32x16_bf16 v[128:143], v[92:95], a[28:31], v[128:143]
    buffer_load_dwordx4 v[180:183], v1, s[4:7], s69 offen offset:1024 sc1
    ds_read_b128 v[88:91], v1 offset:43008
    s_xor_b32 s59, s58, 16384
    s_waitcnt vmcnt(9) lgkmcnt(4)
    v_mfma_f32_32x32x16_bf16 v[112:127], v[96:99], a[32:35], v[112:127]
    buffer_load_dwordx4 a[64:67], v1, s[4:7], s59 offen offset:0 sc1
    ds_read_b128 v[92:95], v2 offset:5120
    v_mfma_f32_32x32x16_bf16 v[128:143], v[100:103], a[32:35], v[128:143]
    ds_read_b128 v[96:99], v1 offset:11264
    v_mfma_f32_32x32x16_bf16 v[144:159], v[104:107], a[16:19], v[144:159]
    ds_read_b128 v[100:103], v1 offset:44032
    ds_write_b128 v35, v[224:227] offset:40960
    s_waitcnt vmcnt(9)
    v_mfma_f32_32x32x16_bf16 v[112:127], v[108:111], a[36:39], v[112:127]
    buffer_load_dwordx4 a[68:71], v1, s[4:7], s59 offen offset:1024 sc1
    ds_read_b128 v[104:107], v1 offset:12288
    s_waitcnt lgkmcnt(4)
    v_mfma_f32_32x32x16_bf16 v[128:143], v[80:83], a[36:39], v[128:143]
    ds_read_b128 v[108:111], v1 offset:45056
    s_xor_b32 s59, s58, 18432
    s_waitcnt vmcnt(9)
    v_mfma_f32_32x32x16_bf16 v[112:127], v[84:87], a[40:43], v[112:127]
    buffer_load_dwordx4 a[72:75], v1, s[4:7], s59 offen offset:0 sc1
    ds_read_b128 v[80:83], v2 offset:6144
    v_mfma_f32_32x32x16_bf16 v[128:143], v[88:91], a[40:43], v[128:143]
    buffer_load_dwordx4 v[184:187], v1, s[4:7], s69 offen offset:2048 sc1
    ds_read_b128 v[84:87], v1 offset:13312
    v_mfma_f32_32x32x16_bf16 v[144:159], v[92:95], a[20:23], v[144:159]
    ds_read_b128 v[88:91], v1 offset:46080
    s_waitcnt vmcnt(10) lgkmcnt(3)
    v_mfma_f32_32x32x16_bf16 v[112:127], v[96:99], a[44:47], v[112:127]
    buffer_load_dwordx4 a[76:79], v1, s[4:7], s59 offen offset:1024 sc1
    ds_read_b128 v[92:95], v1 offset:14336
    ds_write_b128 v35, v[228:231] offset:45056
    v_mfma_f32_32x32x16_bf16 v[128:143], v[100:103], a[44:47], v[128:143]
    ds_read_b128 v[96:99], v1 offset:47104
    s_xor_b32 s59, s58, 20480
    s_waitcnt vmcnt(10)
    v_mfma_f32_32x32x16_bf16 v[112:127], v[104:107], a[48:51], v[112:127]
    buffer_load_dwordx4 a[80:83], v1, s[4:7], s59 offen offset:0 sc1
    ds_read_b128 v[100:103], v2 offset:7168
    v_mfma_f32_32x32x16_bf16 v[128:143], v[108:111], a[48:51], v[128:143]
    ds_read_b128 v[104:107], v1 offset:15360
    s_waitcnt lgkmcnt(4)
    v_mfma_f32_32x32x16_bf16 v[144:159], v[80:83], a[24:27], v[144:159]
    ds_read_b128 v[108:111], v1 offset:48128
    s_waitcnt vmcnt(9)
    v_mfma_f32_32x32x16_bf16 v[112:127], v[84:87], a[52:55], v[112:127]
    buffer_load_dwordx4 a[84:87], v1, s[4:7], s59 offen offset:1024 sc1
    ds_read_b128 v[80:83], v1 offset:16384
    v_mfma_f32_32x32x16_bf16 v[128:143], v[88:91], a[52:55], v[128:143]
    buffer_load_dwordx4 v[188:191], v1, s[4:7], s69 offen offset:3072 sc1
    ds_read_b128 v[84:87], v1 offset:49152
    ds_write_b128 v35, v[232:235] offset:49152
    s_xor_b32 s59, s58, 22528
    s_waitcnt vmcnt(10)
    v_mfma_f32_32x32x16_bf16 v[112:127], v[92:95], a[56:59], v[112:127]
    buffer_load_dwordx4 a[88:91], v1, s[4:7], s59 offen offset:0 sc1
    ds_read_b128 v[88:91], v2 offset:8192
    s_waitcnt lgkmcnt(4)
    v_mfma_f32_32x32x16_bf16 v[128:143], v[96:99], a[56:59], v[128:143]
    ds_read_b128 v[92:95], v1 offset:17408
    v_mfma_f32_32x32x16_bf16 v[144:159], v[100:103], a[28:31], v[144:159]
    ds_read_b128 v[96:99], v1 offset:50176
    s_waitcnt vmcnt(10)
    v_mfma_f32_32x32x16_bf16 v[112:127], v[104:107], a[60:63], v[112:127]
    buffer_load_dwordx4 a[92:95], v1, s[4:7], s59 offen offset:1024 sc1
    ds_read_b128 v[100:103], v1 offset:18432
    v_mfma_f32_32x32x16_bf16 v[128:143], v[108:111], a[60:63], v[128:143]
    ds_read_b128 v[104:107], v1 offset:51200
    s_xor_b32 s59, s58, 24576
    s_waitcnt vmcnt(9) lgkmcnt(3)
    v_mfma_f32_32x32x16_bf16 v[112:127], v[80:83], a[64:67], v[112:127]
    buffer_load_dwordx4 a[96:99], v1, s[4:7], s59 offen offset:0 sc1
    ds_read_b128 v[108:111], v2 offset:9216
    ds_write_b128 v35, v[236:239] offset:53248
    v_mfma_f32_32x32x16_bf16 v[128:143], v[84:87], a[64:67], v[128:143]
    ds_read_b128 v[80:83], v1 offset:19456
    v_mfma_f32_32x32x16_bf16 v[144:159], v[88:91], a[32:35], v[144:159]
    ds_read_b128 v[84:87], v1 offset:52224
    s_waitcnt vmcnt(9)
    v_mfma_f32_32x32x16_bf16 v[112:127], v[92:95], a[68:71], v[112:127]
    buffer_load_dwordx4 a[100:103], v1, s[4:7], s59 offen offset:1024 sc1
    ds_read_b128 v[88:91], v1 offset:20480
    s_waitcnt lgkmcnt(4)
    v_mfma_f32_32x32x16_bf16 v[128:143], v[96:99], a[68:71], v[128:143]
    ds_read_b128 v[92:95], v1 offset:53248
    s_xor_b32 s59, s58, 26624
    s_waitcnt vmcnt(9)
    v_mfma_f32_32x32x16_bf16 v[112:127], v[100:103], a[72:75], v[112:127]
    buffer_load_dwordx4 a[104:107], v1, s[4:7], s59 offen offset:0 sc1
    ds_read_b128 v[96:99], v2 offset:10240
    v_mfma_f32_32x32x16_bf16 v[128:143], v[104:107], a[72:75], v[128:143]
    ds_read_b128 v[100:103], v1 offset:21504
    ds_write_b128 v35, v[240:243] offset:57344
    v_mfma_f32_32x32x16_bf16 v[144:159], v[108:111], a[36:39], v[144:159]
    ds_read_b128 v[104:107], v1 offset:54272
    s_waitcnt vmcnt(8) lgkmcnt(4)
    v_mfma_f32_32x32x16_bf16 v[112:127], v[80:83], a[76:79], v[112:127]
    buffer_load_dwordx4 a[108:111], v1, s[4:7], s59 offen offset:1024 sc1
    ds_read_b128 v[108:111], v1 offset:22528
    v_mfma_f32_32x32x16_bf16 v[128:143], v[84:87], a[76:79], v[128:143]
    ds_read_b128 v[80:83], v1 offset:55296
    s_xor_b32 s59, s58, 28672
    s_waitcnt vmcnt(8)
    v_mfma_f32_32x32x16_bf16 v[112:127], v[88:91], a[80:83], v[112:127]
    buffer_load_dwordx4 a[112:115], v1, s[4:7], s59 offen offset:0 sc1
    ds_read_b128 v[84:87], v2 offset:11264
    v_mfma_f32_32x32x16_bf16 v[128:143], v[92:95], a[80:83], v[128:143]
    ds_read_b128 v[88:91], v1 offset:23552
    s_waitcnt lgkmcnt(3)
    v_mfma_f32_32x32x16_bf16 v[144:159], v[96:99], a[40:43], v[144:159]
    ds_read_b128 v[92:95], v1 offset:56320
    ds_write_b128 v35, v[244:247] offset:61440
    s_waitcnt vmcnt(8)
    v_mfma_f32_32x32x16_bf16 v[112:127], v[100:103], a[84:87], v[112:127]
    buffer_load_dwordx4 a[116:119], v1, s[4:7], s59 offen offset:1024 sc1
    ds_read_b128 v[96:99], v1 offset:24576
    s_waitcnt vmcnt(8)
    v_add_f32 v176, v176, v184
    v_mfma_f32_32x32x16_bf16 v[128:143], v[104:107], a[84:87], v[128:143]
    ds_read_b128 v[100:103], v1 offset:57344
    s_xor_b32 s59, s58, 30720
    v_add_f32 v177, v177, v185
    v_add_f32 v178, v178, v186
    v_add_f32 v179, v179, v187
    v_add_f32 v180, v180, v188
    s_waitcnt vmcnt(7)
    v_mfma_f32_32x32x16_bf16 v[112:127], v[108:111], a[88:91], v[112:127]
    buffer_load_dwordx4 a[120:123], v1, s[4:7], s59 offen offset:0 sc1
    ds_read_b128 v[104:107], v2 offset:12288
    v_add_f32 v181, v181, v189
    s_waitcnt lgkmcnt(4)
    v_mfma_f32_32x32x16_bf16 v[128:143], v[80:83], a[88:91], v[128:143]
    ds_read_b128 v[108:111], v1 offset:25600
    v_add_f32 v182, v182, v190
    v_add_f32 v183, v183, v191
    v_add_f32 v176, v176, v180
    v_add_f32 v177, v177, v181
    v_add_f32 v178, v178, v182
    v_add_f32 v179, v179, v183
    v_mfma_f32_32x32x16_bf16 v[144:159], v[84:87], a[44:47], v[144:159]
    ds_read_b128 v[80:83], v1 offset:58368
    s_waitcnt vmcnt(7)
    v_mfma_f32_32x32x16_bf16 v[112:127], v[88:91], a[92:95], v[112:127]
    buffer_load_dwordx4 a[124:127], v1, s[4:7], s59 offen offset:1024 sc1
    ds_read_b128 v[84:87], v1 offset:26624
    s_add_u32 m0, s56, 131072
    s_add_u32 s60, s64, 131072
    v_mfma_f32_32x32x16_bf16 v[128:143], v[92:95], a[92:95], v[128:143]
    buffer_load_dwordx4 v1, s[8:11], s60 offen sc1 lds
    ds_read_b128 v[88:91], v1 offset:59392
    v_permlane32_swap_b32 v176, v178
    s_waitcnt vmcnt(8) lgkmcnt(3)
    v_mfma_f32_32x32x16_bf16 v[112:127], v[96:99], a[96:99], v[112:127]
    ds_read_b128 v[92:95], v2 offset:13312
    v_permlane32_swap_b32 v177, v179
    v_add_f32 v176, v176, v178
    v_add_f32 v177, v177, v179
    v_mfma_f32_32x32x16_bf16 v[128:143], v[100:103], a[96:99], v[128:143]
    ds_read_b128 v[96:99], v1 offset:27648
    v_permlane16_swap_b32 v176, v177
    v_add_f32 v176, v176, v177
    v_mul_f32 v176, 0x3b000000, v176
    v_mov_b32 v177, v176
    v_mfma_f32_32x32x16_bf16 v[144:159], v[104:107], a[48:51], v[144:159]
    ds_read_b128 v[100:103], v1 offset:60416
    v_permlane32_swap_b32 v176, v177
    v_fma_f32 v177, -v176, v176, v177
    v_max_f32 v177, 0, v177
    v_add_f32 v38, 0x3727c5ac, v177
    s_waitcnt vmcnt(7)
    v_mfma_f32_32x32x16_bf16 v[112:127], v[108:111], a[100:103], v[112:127]
    buffer_load_dwordx4 v1, s[8:11], s60 offen offset:1024 sc1 lds
    ds_read_b128 v[104:107], v1 offset:28672
    s_waitcnt lgkmcnt(3)
    v_mfma_f32_32x32x16_bf16 v[128:143], v[80:83], a[100:103], v[128:143]
    ds_read_b128 v[108:111], v1 offset:61440
    v_rsq_f32 v32, v38
    v_cvt_pk_bf16_f32 v40, -v176, -v176
    v_mov_b32 v45, v40
    v_mul_f32 v34, 0xc0135761, v32
    s_waitcnt vmcnt(7)
    v_mfma_f32_32x32x16_bf16 v[112:127], v[84:87], a[104:107], v[112:127]
    ds_read_b128 v[80:83], v2 offset:14336
    v_mul_f32 v178, v32, v32
    v_mul_f32 v178, 0x3d372713, v178
    v_mul_f32 v36, v178, v34
    s_add_u32 s68, s79, 131072
    v_mfma_f32_32x32x16_bf16 v[128:143], v[88:91], a[104:107], v[128:143]
    buffer_load_dwordx4 v1, s[8:11], s60 offen offset:2048 sc1 lds
    ds_read_b128 v[84:87], v1 offset:29696
    v_mfma_f32_32x32x16_bf16 v[144:159], v[92:95], a[52:55], v[144:159]
    s_cmp_eq_u32 s53, 0
    s_cbranch_scc1 L_dev_112
    buffer_store_dwordx4 v[72:75], v1, s[4:7], s68 offen offset:0
L_st_113:
    ds_read_b128 v[88:91], v1 offset:62464
    s_waitcnt vmcnt(8) lgkmcnt(3)
    v_mfma_f32_32x32x16_bf16 v[112:127], v[96:99], a[108:111], v[112:127]
    s_cmp_eq_u32 s53, 0
    s_cbranch_scc1 L_dev_114
    buffer_store_dwordx4 v[72:75], v1, s[4:7], s68 offen offset:1024
L_st_115:
    ds_read_b128 v[92:95], v1 offset:30720
    v_mfma_f32_32x32x16_bf16 v[128:143], v[100:103], a[108:111], v[128:143]
    ds_read_b128 v[96:99], v1 offset:63488
    s_waitcnt vmcnt(8)
    v_mfma_f32_32x32x16_bf16 v[112:127], v[104:107], a[112:115], v[112:127]
    buffer_load_dwordx4 v1, s[8:11], s60 offen offset:3072 sc1 lds
    ds_read_b128 v[100:103], v2 offset:15360
    v_mfma_f32_32x32x16_bf16 v[128:143], v[108:111], a[112:115], v[128:143]
    ds_read_b128 v[104:107], v1 offset:31744
    s_waitcnt lgkmcnt(3)
    v_mfma_f32_32x32x16_bf16 v[144:159], v[80:83], a[56:59], v[144:159]
    ds_read_b128 v[108:111], v1 offset:64512
    s_waitcnt vmcnt(8)
    v_mfma_f32_32x32x16_bf16 v[112:127], v[84:87], a[116:119], v[112:127]
    v_mfma_f32_32x32x16_bf16 v[128:143], v[88:91], a[116:119], v[128:143]
    s_add_u32 m0, s56, 147456
    s_add_u32 s60, s64, 147456
    s_waitcnt vmcnt(7)
    v_mfma_f32_32x32x16_bf16 v[112:127], v[92:95], a[120:123], v[112:127]
    buffer_load_dwordx4 v1, s[8:11], s60 offen sc1 lds
    ds_read_b128 v[88:91], v2 offset:16384
    s_waitcnt lgkmcnt(1)
    v_mfma_f32_32x32x16_bf16 v[128:143], v[96:99], a[120:123], v[128:143]
    ds_read_b128 v[92:95], v2 offset:17408
    v_mfma_f32_32x32x16_bf16 v[144:159], v[100:103], a[60:63], v[144:159]
    ds_read_b128 v[96:99], v2 offset:18432
    s_waitcnt vmcnt(7)
    v_mfma_f32_32x32x16_bf16 v[112:127], v[104:107], a[124:127], v[112:127]
    buffer_load_dwordx4 v1, s[8:11], s60 offen offset:1024 sc1 lds
    ds_read_b128 v[100:103], v2 offset:19456
    v_mfma_f32_32x32x16_bf16 v[128:143], v[108:111], a[124:127], v[128:143]
    ds_read_b128 v[104:107], v2 offset:20480
    v_mfma_f32_32x32x16_bf16 v[112:127], a[136:139], v[42:45], v[112:127]
    ds_read_b128 v[108:111], v2 offset:21504
    v_mfma_f32_32x32x16_bf16 v[128:143], a[140:143], v[40:43], v[128:143]
    ds_read_b128 v[80:83], v2 offset:22528
    s_waitcnt lgkmcnt(3)
    v_mfma_f32_32x32x16_bf16 v[144:159], v[88:91], a[64:67], v[144:159]
    buffer_load_dwordx4 v1, s[8:11], s60 offen offset:2048 sc1 lds
    ds_read_b128 v[84:87], v2 offset:23552
    v_mfma_f32_32x32x16_bf16 v[144:159], v[92:95], a[68:71], v[144:159]
    ds_read_b128 v[88:91], v2 offset:24576
    v_mfma_f32_32x32x16_bf16 v[144:159], v[96:99], a[72:75], v[144:159]
    ds_read_b128 v[92:95], v2 offset:25600
    s_nop 0
    v_mul_f32 v192, v112, v112
    v_mul_f32 v193, v113, v113
    v_mul_f32 v194, v114, v114
    v_mul_f32 v195, v115, v115
    v_fma_f32 v192, v192, v36, v34
L_page_8:
    s_cbranch_execz L_main
    v_fma_f32 v193, v193, v36, v34
    v_mfma_f32_32x32x16_bf16 v[144:159], v[100:103], a[76:79], v[144:159]
    ds_read_b128 v[96:99], v2 offset:26624
    v_fma_f32 v194, v194, v36, v34
    v_fma_f32 v195, v195, v36, v34
    v_mul_f32 v192, v192, v112
    v_mul_f32 v193, v193, v113
    v_mul_f32 v194, v194, v114
    s_waitcnt lgkmcnt(3)
    v_mfma_f32_32x32x16_bf16 v[144:159], v[104:107], a[80:83], v[144:159]
    buffer_load_dwordx4 v1, s[8:11], s60 offen offset:3072 sc1 lds
    ds_read_b128 v[100:103], v2 offset:27648
    v_mul_f32 v195, v195, v115
    v_mfma_f32_32x32x16_bf16 v[144:159], v[108:111], a[84:87], v[144:159]
    ds_read_b128 v[104:107], v2 offset:28672
    v_exp_f32 v192, v192
    v_mul_f32 v112, v112, v120
    v_exp_f32 v193, v193
    v_mul_f32 v113, v113, v121
    v_mfma_f32_32x32x16_bf16 v[144:159], v[80:83], a[88:91], v[144:159]
    ds_read_b128 v[108:111], v2 offset:29696
    v_exp_f32 v194, v194
    v_mul_f32 v114, v114, v122
    v_exp_f32 v195, v195
    v_mul_f32 v115, v115, v123
    v_mfma_f32_32x32x16_bf16 v[144:159], v[84:87], a[92:95], v[144:159]
    ds_read_b128 v[80:83], v2 offset:30720
    v_fma_f32 v192, v192, v38, v38
    v_fma_f32 v193, v193, v38, v38
    v_fma_f32 v194, v194, v38, v38
    v_fma_f32 v195, v195, v38, v38
    s_waitcnt lgkmcnt(3)
    v_mfma_f32_32x32x16_bf16 v[144:159], v[88:91], a[96:99], v[144:159]
    ds_read_b128 v[84:87], v2 offset:31744
    v_rcp_f32 v192, v192
    v_rcp_f32 v193, v193
    v_rcp_f32 v194, v194
    v_mfma_f32_32x32x16_bf16 v[144:159], v[92:95], a[100:103], v[144:159]
    s_barrier
    v_mfma_f32_32x32x16_bf16 v[144:159], v[96:99], a[104:107], v[144:159]
    ds_read_b128 v[92:95], v2 offset:32768
    v_rcp_f32 v195, v195
    v_mul_f32 v112, v112, v192
    v_mul_f32 v113, v113, v193
    v_mul_f32 v114, v114, v194
    v_mul_f32 v115, v115, v195
    v_mfma_f32_32x32x16_bf16 v[144:159], v[100:103], a[108:111], v[144:159]
    ds_read_b128 v[96:99], v2 offset:33792
    v_cvt_pk_bf16_f32 v176, v112, v113
    v_cvt_pk_bf16_f32 v177, v114, v115
    v_mul_f32 v196, v116, v116
    v_mul_f32 v197, v117, v117
    v_mul_f32 v198, v118, v118
    s_waitcnt lgkmcnt(2)
    v_mfma_f32_32x32x16_bf16 v[144:159], v[104:107], a[112:115], v[144:159]
    ds_read_b128 v[100:103], v2 offset:34816
    v_mul_f32 v199, v119, v119
    v_fma_f32 v196, v196, v36, v34
    v_fma_f32 v197, v197, v36, v34
    v_fma_f32 v198, v198, v36, v34
    v_fma_f32 v199, v199, v36, v34
    v_mul_f32 v196, v196, v116
    v_mfma_f32_32x32x16_bf16 v[144:159], v[108:111], a[116:119], v[144:159]
    ds_read_b128 v[104:107], v2 offset:35840
    v_mul_f32 v197, v197, v117
    v_mul_f32 v198, v198, v118
    v_mul_f32 v199, v199, v119
    v_exp_f32 v196, v196
    v_mul_f32 v116, v116, v124
    v_mfma_f32_32x32x16_bf16 v[144:159], v[80:83], a[120:123], v[144:159]
    ds_read_b128 v[108:111], v2 offset:36864
    v_exp_f32 v197, v197
    v_mul_f32 v117, v117, v125
    v_exp_f32 v198, v198
    v_mul_f32 v118, v118, v126
    v_mfma_f32_32x32x16_bf16 v[144:159], v[84:87], a[124:127], v[144:159]
    ds_read_b128 v[80:83], v2 offset:37888
    v_exp_f32 v199, v199
    v_mul_f32 v119, v119, v127
    v_fma_f32 v196, v196, v38, v38
    v_fma_f32 v197, v197, v38, v38
    v_fma_f32 v198, v198, v38, v38
    v_mfma_f32_32x32x16_bf16 v[144:159], a[138:141], v[42:45], v[144:159]
    ds_read_b128 v[84:87], v2 offset:38912
    s_barrier
    s_waitcnt lgkmcnt(3)
    v_mfma_f32_32x32x16_bf16 v[160:175], v[92:95], a[0:3], 0
    s_add_u32 m0, s56, 32768
    s_add_u32 s60, s64, 163840
    buffer_load_dwordx4 v1, s[8:11], s60 offen sc1 lds
    ds_read_b128 v[88:91], v2 offset:39936
    v_fma_f32 v199, v199, v38, v38
    v_mfma_f32_32x32x16_bf16 v[160:175], v[96:99], a[4:7], v[160:175]
    ds_read_b128 v[92:95], v2 offset:40960
    v_rcp_f32 v196, v196
    v_rcp_f32 v197, v197
    v_rcp_f32 v198, v198
    v_mfma_f32_32x32x16_bf16 v[160:175], v[100:103], a[8:11], v[160:175]
    ds_read_b128 v[96:99], v2 offset:41984
    v_rcp_f32 v199, v199
    v_mul_f32 v116, v116, v196
    v_mul_f32 v117, v117, v197
    v_mul_f32 v118, v118, v198
    v_mul_f32 v119, v119, v199
    v_mfma_f32_32x32x16_bf16 v[160:175], v[104:107], a[12:15], v[160:175]
    ds_read_b128 v[100:103], v2 offset:43008
    v_cvt_pk_bf16_f32 v178, v116, v117
    v_cvt_pk_bf16_f32 v179, v118, v119
    s_add_u32 s76, s75, 0
    s_waitcnt lgkmcnt(3)
    v_mfma_f32_32x32x16_bf16 v[160:175], v[108:111], a[16:19], v[160:175]
    buffer_load_dwordx4 v1, s[8:11], s60 offen offset:1024 sc1 lds
    ds_read_b128 v[104:107], v2 offset:44032
    v_mfma_f32_32x32x16_bf16 v[160:175], v[80:83], a[20:23], v[160:175]
    buffer_store_dwordx4 v[176:179], v1, s[4:7], s76 offen sc1
    ds_read_b128 v[108:111], v2 offset:45056
    v_mfma_f32_32x32x16_bf16 v[160:175], v[84:87], a[24:27], v[160:175]
    ds_read_b128 v[80:83], v2 offset:46080
    v_mul_f32 v192, v128, v128
    v_mul_f32 v193, v129, v129
    v_mul_f32 v194, v130, v130
    v_mul_f32 v195, v131, v131
    v_fma_f32 v192, v192, v36, v34
    v_fma_f32 v193, v193, v36, v34
    v_mfma_f32_32x32x16_bf16 v[160:175], v[88:91], a[28:31], v[160:175]
    ds_read_b128 v[84:87], v2 offset:47104
    v_fma_f32 v194, v194, v36, v34
    v_fma_f32 v195, v195, v36, v34
    v_mul_f32 v192, v192, v128
    v_mul_f32 v193, v193, v129
    v_mul_f32 v194, v194, v130
    s_waitcnt lgkmcnt(3)
    v_mfma_f32_32x32x16_bf16 v[160:175], v[92:95], a[32:35], v[160:175]
    buffer_load_dwordx4 v1, s[8:11], s60 offen offset:2048 sc1 lds
    ds_read_b128 v[88:91], v2 offset:48128
    v_mul_f32 v195, v195, v131
    v_mfma_f32_32x32x16_bf16 v[160:175], v[96:99], a[36:39], v[160:175]
    ds_read_b128 v[92:95], v2 offset:49152
    v_exp_f32 v192, v192
    v_mul_f32 v128, v128, v136
    v_exp_f32 v193, v193
    v_mul_f32 v129, v129, v137
    v_mfma_f32_32x32x16_bf16 v[160:175], v[100:103], a[40:43], v[160:175]
    ds_read_b128 v[96:99], v2 offset:50176
    v_exp_f32 v194, v194
    v_mul_f32 v130, v130, v138
    v_exp_f32 v195, v195
    v_mul_f32 v131, v131, v139
    v_mfma_f32_32x32x16_bf16 v[160:175], v[104:107], a[44:47], v[160:175]
    ds_read_b128 v[100:103], v2 offset:51200
    v_fma_f32 v192, v192, v38, v38
    v_fma_f32 v193, v193, v38, v38
    v_fma_f32 v194, v194, v38, v38
    v_fma_f32 v195, v195, v38, v38
    s_waitcnt lgkmcnt(3)
    v_mfma_f32_32x32x16_bf16 v[160:175], v[108:111], a[48:51], v[160:175]
    buffer_load_dwordx4 v1, s[8:11], s60 offen offset:3072 sc1 lds
    ds_read_b128 v[104:107], v2 offset:52224
    v_rcp_f32 v192, v192
    v_mfma_f32_32x32x16_bf16 v[160:175], v[80:83], a[52:55], v[160:175]
    ds_read_b128 v[108:111], v2 offset:53248
    v_rcp_f32 v193, v193
    v_rcp_f32 v194, v194
    v_rcp_f32 v195, v195
    v_mfma_f32_32x32x16_bf16 v[160:175], v[84:87], a[56:59], v[160:175]
    ds_read_b128 v[80:83], v2 offset:54272
    v_mul_f32 v128, v128, v192
    v_mul_f32 v129, v129, v193
    v_mul_f32 v130, v130, v194
    v_mul_f32 v131, v131, v195
    v_cvt_pk_bf16_f32 v180, v128, v129
    v_cvt_pk_bf16_f32 v181, v130, v131
    v_mfma_f32_32x32x16_bf16 v[160:175], v[88:91], a[60:63], v[160:175]
    ds_read_b128 v[84:87], v2 offset:55296
    s_add_u32 m0, s56, 49152
    s_add_u32 s60, s64, 180224
    v_mul_f32 v196, v132, v132
    v_mul_f32 v197, v133, v133
    v_mul_f32 v198, v134, v134
    s_waitcnt lgkmcnt(3)
    v_mfma_f32_32x32x16_bf16 v[160:175], v[92:95], a[64:67], v[160:175]
    buffer_load_dwordx4 v1, s[8:11], s60 offen sc1 lds
    ds_read_b128 v[88:91], v2 offset:56320
    v_mul_f32 v199, v135, v135
    v_fma_f32 v196, v196, v36, v34
    v_mfma_f32_32x32x16_bf16 v[160:175], v[96:99], a[68:71], v[160:175]
    ds_read_b128 v[92:95], v2 offset:57344
    v_fma_f32 v197, v197, v36, v34
    v_fma_f32 v198, v198, v36, v34
    v_fma_f32 v199, v199, v36, v34
    v_mul_f32 v196, v196, v132
    v_mul_f32 v197, v197, v133
    v_mul_f32 v198, v198, v134
    v_mfma_f32_32x32x16_bf16 v[160:175], v[100:103], a[72:75], v[160:175]
    ds_read_b128 v[96:99], v2 offset:58368
    v_mul_f32 v199, v199, v135
    v_exp_f32 v196, v196
    v_mul_f32 v132, v132, v140
    v_exp_f32 v197, v197
    v_mfma_f32_32x32x16_bf16 v[160:175], v[104:107], a[76:79], v[160:175]
    ds_read_b128 v[100:103], v2 offset:59392
    v_mul_f32 v133, v133, v141
    v_exp_f32 v198, v198
    v_mul_f32 v134, v134, v142
    s_waitcnt lgkmcnt(3)
    v_mfma_f32_32x32x16_bf16 v[160:175], v[108:111], a[80:83], v[160:175]
    buffer_load_dwordx4 v1, s[8:11], s60 offen offset:1024 sc1 lds
    ds_read_b128 v[104:107], v2 offset:60416
    v_exp_f32 v199, v199
    v_mfma_f32_32x32x16_bf16 v[160:175], v[80:83], a[84:87], v[160:175]
    ds_read_b128 v[108:111], v2 offset:61440
    v_mul_f32 v135, v135, v143
    v_fma_f32 v196, v196, v38, v38
    v_fma_f32 v197, v197, v38, v38
    v_fma_f32 v198, v198, v38, v38
    v_fma_f32 v199, v199, v38, v38
    v_mfma_f32_32x32x16_bf16 v[160:175], v[84:87], a[88:91], v[160:175]
    ds_read_b128 v[80:83], v2 offset:62464
    v_rcp_f32 v196, v196
    v_rcp_f32 v197, v197
    v_rcp_f32 v198, v198
    v_mfma_f32_32x32x16_bf16 v[160:175], v[88:91], a[92:95], v[160:175]
    ds_read_b128 v[84:87], v2 offset:63488
    v_rcp_f32 v199, v199
    v_mul_f32 v132, v132, v196
    v_mul_f32 v133, v133, v197
    v_mul_f32 v134, v134, v198
    s_waitcnt lgkmcnt(3)
    v_mfma_f32_32x32x16_bf16 v[160:175], v[92:95], a[96:99], v[160:175]
    buffer_load_dwordx4 v1, s[8:11], s60 offen offset:2048 sc1 lds
    ds_read_b128 v[88:91], v2 offset:64512
    v_mul_f32 v135, v135, v199
    v_cvt_pk_bf16_f32 v182, v132, v133
    v_mfma_f32_32x32x16_bf16 v[160:175], v[96:99], a[100:103], v[160:175]
    s_waitcnt vmcnt(8)
    s_barrier
    v_mfma_f32_32x32x16_bf16 v[160:175], v[100:103], a[104:107], v[160:175]
    ds_read_b128 v[96:99], v3 offset:0
    v_cvt_pk_bf16_f32 v183, v134, v135
    s_add_u32 s76, s75, 16384
    v_mfma_f32_32x32x16_bf16 v[160:175], v[104:107], a[108:111], v[160:175]
    buffer_store_dwordx4 v[180:183], v1, s[4:7], s76 offen sc1
    ds_read_b128 v[100:103], v3 offset:1024
    s_waitcnt lgkmcnt(2)
    v_mfma_f32_32x32x16_bf16 v[160:175], v[108:111], a[112:115], v[160:175]
    buffer_load_dwordx4 v1, s[8:11], s60 offen offset:3072 sc1 lds
    ds_read_b128 v[104:107], v3 offset:2048
    v_mul_f32 v192, v144, v144
    v_mul_f32 v193, v145, v145
    v_mfma_f32_32x32x16_bf16 v[160:175], v[80:83], a[116:119], v[160:175]
    ds_read_b128 v[108:111], v3 offset:3072
    v_mul_f32 v194, v146, v146
    v_mul_f32 v195, v147, v147
    v_fma_f32 v192, v192, v36, v34
    v_fma_f32 v193, v193, v36, v34
    v_fma_f32 v194, v194, v36, v34
    v_fma_f32 v195, v195, v36, v34
    v_mfma_f32_32x32x16_bf16 v[160:175], v[84:87], a[120:123], v[160:175]
    ds_read_b128 v[80:83], v3 offset:4096
    s_add_u32 m0, s56, 65536
    s_add_u32 s60, s64, 196608
    v_mul_f32 v192, v192, v144
    v_mul_f32 v193, v193, v145
    v_mul_f32 v194, v194, v146
    v_mul_f32 v195, v195, v147
    v_mfma_f32_32x32x16_bf16 v[160:175], v[88:91], a[124:127], v[160:175]
    buffer_load_dwordx4 v1, s[8:11], s60 offen sc1 lds
    ds_read_b128 v[84:87], v3 offset:5120
    v_exp_f32 v192, v192
    v_mfma_f32_32x32x16_bf16 v[160:175], a[142:145], v[40:43], v[160:175]
    ds_read_b128 v[88:91], v3 offset:6144
    s_waitcnt lgkmcnt(3)
    v_mfma_f32_32x32x16_bf16 v[112:127], v[96:99], a[0:3], 0
    ds_read_b128 v[92:95], v3 offset:7168
    v_mul_f32 v144, v144, v152
    v_exp_f32 v193, v193
    v_mul_f32 v145, v145, v153
    v_exp_f32 v194, v194
    v_mfma_f32_32x32x16_bf16 v[112:127], v[100:103], a[4:7], v[112:127]
    ds_read_b128 v[96:99], v3 offset:8192
    v_mul_f32 v146, v146, v154
    v_exp_f32 v195, v195
    v_mul_f32 v147, v147, v155
    v_fma_f32 v192, v192, v38, v38
    v_fma_f32 v193, v193, v38, v38
    v_mfma_f32_32x32x16_bf16 v[112:127], v[104:107], a[8:11], v[112:127]
    buffer_load_dwordx4 v1, s[8:11], s60 offen offset:1024 sc1 lds
    ds_read_b128 v[100:103], v3 offset:9216
    v_fma_f32 v194, v194, v38, v38
    v_fma_f32 v195, v195, v38, v38
    v_mfma_f32_32x32x16_bf16 v[112:127], v[108:111], a[12:15], v[112:127]
    ds_read_b128 v[104:107], v3 offset:10240
    v_rcp_f32 v192, v192
    v_rcp_f32 v193, v193
    s_waitcnt lgkmcnt(3)
    v_mfma_f32_32x32x16_bf16 v[112:127], v[80:83], a[16:19], v[112:127]
    ds_read_b128 v[108:111], v3 offset:11264
    v_rcp_f32 v194, v194
    v_rcp_f32 v195, v195
    v_mul_f32 v144, v144, v192
    v_mul_f32 v145, v145, v193
    v_mfma_f32_32x32x16_bf16 v[112:127], v[84:87], a[20:23], v[112:127]
    ds_read_b128 v[80:83], v3 offset:12288
    v_mul_f32 v146, v146, v194
    v_mul_f32 v147, v147, v195
    v_cvt_pk_bf16_f32 v184, v144, v145
    v_cvt_pk_bf16_f32 v185, v146, v147
    v_mul_f32 v196, v148, v148
    v_mul_f32 v197, v149, v149
    v_mfma_f32_32x32x16_bf16 v[112:127], v[88:91], a[24:27], v[112:127]
    buffer_load_dwordx4 v1, s[8:11], s60 offen offset:2048 sc1 lds
    ds_read_b128 v[84:87], v3 offset:13312
    v_mul_f32 v198, v150, v150
    v_mul_f32 v199, v151, v151
    v_mfma_f32_32x32x16_bf16 v[112:127], v[92:95], a[28:31], v[112:127]
    ds_read_b128 v[88:91], v3 offset:14336
    v_fma_f32 v196, v196, v36, v34
    v_fma_f32 v197, v197, v36, v34
    v_fma_f32 v198, v198, v36, v34
    v_fma_f32 v199, v199, v36, v34
    v_mul_f32 v196, v196, v148
    s_waitcnt lgkmcnt(3)
    v_mfma_f32_32x32x16_bf16 v[112:127], v[96:99], a[32:35], v[112:127]
    ds_read_b128 v[92:95], v3 offset:15360
    v_mul_f32 v197, v197, v149
    v_mul_f32 v198, v198, v150
    v_mul_f32 v199, v199, v151
    v_exp_f32 v196, v196
    v_mul_f32 v148, v148, v156
    v_mfma_f32_32x32x16_bf16 v[112:127], v[100:103], a[36:39], v[112:127]
    ds_read_b128 v[96:99], v3 offset:16384
    v_exp_f32 v197, v197
    v_mul_f32 v149, v149, v157
    v_exp_f32 v198, v198
    v_mul_f32 v150, v150, v158
    v_mfma_f32_32x32x16_bf16 v[112:127], v[104:107], a[40:43], v[112:127]
    buffer_load_dwordx4 v1, s[8:11], s60 offen offset:3072 sc1 lds
    ds_read_b128 v[100:103], v3 offset:17408
    v_exp_f32 v199, v199
    v_mfma_f32_32x32x16_bf16 v[112:127], v[108:111], a[44:47], v[112:127]
    ds_read_b128 v[104:107], v3 offset:18432
    v_mul_f32_e64 v151, v151, v159
    v_fma_f32 v196, v196, v38, v38
    v_fma_f32 v197, v197, v38, v38
    v_fma_f32 v198, v198, v38, v38
    v_fma_f32 v199, v199, v38, v38
    s_waitcnt lgkmcnt(3)
    v_mfma_f32_32x32x16_bf16 v[112:127], v[80:83], a[48:51], v[112:127]
    ds_read_b128 v[108:111], v3 offset:19456
    v_rcp_f32 v196, v196
    v_rcp_f32 v197, v197
    v_rcp_f32 v198, v198
    v_mfma_f32_32x32x16_bf16 v[112:127], v[84:87], a[52:55], v[112:127]
    ds_read_b128 v[80:83], v3 offset:20480
    s_add_u32 m0, s56, 81920
    s_add_u32 s60, s64, 212992
    v_rcp_f32 v199, v199
    v_mul_f32 v148, v148, v196
    v_mul_f32 v149, v149, v197
    v_mfma_f32_32x32x16_bf16 v[112:127], v[88:91], a[56:59], v[112:127]
    buffer_load_dwordx4 v1, s[8:11], s60 offen sc1 lds
    ds_read_b128 v[84:87], v3 offset:21504
    v_mul_f32 v150, v150, v198
    v_mul_f32 v151, v151, v199
    v_mfma_f32_32x32x16_bf16 v[112:127], v[92:95], a[60:63], v[112:127]
    ds_read_b128 v[88:91], v3 offset:22528
    v_cvt_pk_bf16_f32 v186, v148, v149
    v_cvt_pk_bf16_f32 v187, v150, v151
    s_add_u32 s76, s75, 32768
    s_waitcnt lgkmcnt(3)
    v_mfma_f32_32x32x16_bf16 v[112:127], v[96:99], a[64:67], v[112:127]
    buffer_store_dwordx4 v[184:187], v1, s[4:7], s76 offen sc1
    ds_read_b128 v[92:95], v3 offset:23552
    v_mfma_f32_32x32x16_bf16 v[112:127], v[100:103], a[68:71], v[112:127]
    ds_read_b128 v[96:99], v3 offset:24576
    v_mul_f32 v192, v160, v160
    v_mul_f32 v193, v161, v161
    v_mul_f32 v194, v162, v162
    v_mul_f32 v195, v163, v163
    v_fma_f32 v192, v192, v36, v34
    v_fma_f32 v193, v193, v36, v34
    v_mfma_f32_32x32x16_bf16 v[112:127], v[104:107], a[72:75], v[112:127]
    buffer_load_dwordx4 v1, s[8:11], s60 offen offset:1024 sc1 lds
    ds_read_b128 v[100:103], v3 offset:25600
    v_fma_f32 v194, v194, v36, v34
    v_fma_f32 v195, v195, v36, v34
    v_mfma_f32_32x32x16_bf16 v[112:127], v[108:111], a[76:79], v[112:127]
    ds_read_b128 v[104:107], v3 offset:26624
    v_mul_f32 v192, v192, v160
    v_mul_f32 v193, v193, v161
    v_mul_f32 v194, v194, v162
    v_mul_f32 v195, v195, v163
    s_waitcnt lgkmcnt(3)
    v_mfma_f32_32x32x16_bf16 v[112:127], v[80:83], a[80:83], v[112:127]
    ds_read_b128 v[108:111], v3 offset:27648
    v_exp_f32 v192, v192
    v_mul_f32 v160, v160, v168
    v_exp_f32 v193, v193
    v_mul_f32 v161, v161, v169
    v_mfma_f32_32x32x16_bf16 v[112:127], v[84:87], a[84:87], v[112:127]
    ds_read_b128 v[80:83], v3 offset:28672
    v_exp_f32 v194, v194
    v_mul_f32 v162, v162, v170
    v_exp_f32 v195, v195
    v_mul_f32 v163, v163, v171
    v_mfma_f32_32x32x16_bf16 v[112:127], v[88:91], a[88:91], v[112:127]
    buffer_load_dwordx4 v1, s[8:11], s60 offen offset:2048 sc1 lds
    ds_read_b128 v[84:87], v3 offset:29696
    v_fma_f32 v192, v192, v38, v38
    v_fma_f32 v193, v193, v38, v38
    v_mfma_f32_32x32x16_bf16 v[112:127], v[92:95], a[92:95], v[112:127]
    ds_read_b128 v[88:91], v3 offset:30720
    v_fma_f32 v194, v194, v38, v38
    v_fma_f32 v195, v195, v38, v38
    v_rcp_f32 v192, v192
    s_waitcnt lgkmcnt(3)
    v_mfma_f32_32x32x16_bf16 v[112:127], v[96:99], a[96:99], v[112:127]
    ds_read_b128 v[92:95], v3 offset:31744
    v_rcp_f32 v193, v193
    v_rcp_f32 v194, v194
    v_rcp_f32 v195, v195
    v_mfma_f32_32x32x16_bf16 v[112:127], v[100:103], a[100:103], v[112:127]
    s_waitcnt vmcnt(8)
    s_barrier
    v_mfma_f32_32x32x16_bf16 v[112:127], v[104:107], a[104:107], v[112:127]
    buffer_load_dwordx4 v1, s[8:11], s60 offen offset:3072 sc1 lds
    ds_read_b128 v[100:103], v1 offset:32768
    v_mul_f32 v160, v160, v192
    v_mul_f32 v161, v161, v193
    v_mfma_f32_32x32x16_bf16 v[112:127], v[108:111], a[108:111], v[112:127]
    ds_read_b128 v[104:107], v1 offset:33792
    v_mul_f32 v162, v162, v194
    v_mul_f32 v163, v163, v195
    v_cvt_pk_bf16_f32 v188, v160, v161
    v_cvt_pk_bf16_f32 v189, v162, v163
    v_mul_f32 v196, v164, v164
    s_waitcnt lgkmcnt(2)
    v_mfma_f32_32x32x16_bf16 v[112:127], v[80:83], a[112:115], v[112:127]
    ds_read_b128 v[108:111], v1 offset:34816
    v_mul_f32 v197, v165, v165
    v_mul_f32 v198, v166, v166
    v_mul_f32 v199, v167, v167
    v_fma_f32 v196, v196, v36, v34
    v_fma_f32 v197, v197, v36, v34
    v_fma_f32 v198, v198, v36, v34
    v_mfma_f32_32x32x16_bf16 v[112:127], v[84:87], a[116:119], v[112:127]
    ds_read_b128 v[80:83], v1 offset:35840
    v_fma_f32 v199, v199, v36, v34
    v_mul_f32 v196, v196, v164
    v_mul_f32 v197, v197, v165
    v_mul_f32 v198, v198, v166
    v_mul_f32 v199, v199, v167
    v_mfma_f32_32x32x16_bf16 v[112:127], v[88:91], a[120:123], v[112:127]
    ds_read_b128 v[84:87], v1 offset:36864
    v_exp_f32 v196, v196
    v_mul_f32 v164, v164, v172
    v_exp_f32 v197, v197
    v_mul_f32 v165, v165, v173
    v_mfma_f32_32x32x16_bf16 v[112:127], v[92:95], a[124:127], v[112:127]
    ds_read_b128 v[88:91], v1 offset:37888
    v_exp_f32 v198, v198
    v_mul_f32 v166, v166, v174
    v_exp_f32 v199, v199
    v_mul_f32 v167, v167, v175
    v_mfma_f32_32x32x16_bf16 v[112:127], a[140:143], v[42:45], v[112:127]
    ds_read_b128 v[92:95], v1 offset:38912
    v_add_u32 v28, 13, v24
    s_mov_b64 exec, 1
    s_cmp_eq_u32 s53, 0
    s_cbranch_scc1 L_dev_116
    buffer_store_dword v28, off, s[8:11], s82
L_sg_117:
    s_mov_b64 exec, -1
    s_waitcnt lgkmcnt(3)
    v_mfma_f32_32x32x16_bf16 v[128:143], v[100:103], a[0:3], 0
    ds_read_b128 v[96:99], v1 offset:39936
    v_fma_f32 v196, v196, v38, v38
    v_fma_f32 v197, v197, v38, v38
    v_fma_f32 v198, v198, v38, v38
    v_fma_f32 v199, v199, v38, v38
    v_rcp_f32 v196, v196
    v_mfma_f32_32x32x16_bf16 v[128:143], v[104:107], a[4:7], v[128:143]
    ds_read_b128 v[100:103], v1 offset:40960
    v_rcp_f32 v197, v197
    v_rcp_f32 v198, v198
    v_rcp_f32 v199, v199
    v_mfma_f32_32x32x16_bf16 v[128:143], v[108:111], a[8:11], v[128:143]
    ds_read_b128 v[104:107], v1 offset:41984
    v_mul_f32 v164, v164, v196
    v_mul_f32 v165, v165, v197
    v_mul_f32 v166, v166, v198
    v_mul_f32 v167, v167, v199
    v_cvt_pk_bf16_f32 v190, v164, v165
    v_cvt_pk_bf16_f32 v191, v166, v167
    v_mfma_f32_32x32x16_bf16 v[128:143], v[80:83], a[12:15], v[128:143]
    ds_read_b128 v[108:111], v1 offset:43008
    s_add_u32 s76, s75, 49152
    s_waitcnt lgkmcnt(3)
    v_mfma_f32_32x32x16_bf16 v[128:143], v[84:87], a[16:19], v[128:143]
    buffer_store_dwordx4 v[188:191], v1, s[4:7], s76 offen sc1
    ds_read_b128 v[80:83], v1 offset:44032
    v_mfma_f32_32x32x16_bf16 v[128:143], v[88:91], a[20:23], v[128:143]
    ds_read_b128 v[84:87], v1 offset:45056
    v_mul_f32 v192, v112, v112
    v_mul_f32 v193, v113, v113
    v_mul_f32 v194, v114, v114
    v_mul_f32 v195, v115, v115
    v_fma_f32 v192, v192, v36, v34
    v_fma_f32 v193, v193, v36, v34
    v_mfma_f32_32x32x16_bf16 v[128:143], v[92:95], a[24:27], v[128:143]
    ds_read_b128 v[88:91], v1 offset:46080
    v_fma_f32 v194, v194, v36, v34
    v_fma_f32 v195, v195, v36, v34
    v_mul_f32 v192, v192, v112
    v_mul_f32 v193, v193, v113
    v_mul_f32 v194, v194, v114
    v_mul_f32 v195, v195, v115
    v_mfma_f32_32x32x16_bf16 v[128:143], v[96:99], a[28:31], v[128:143]
    ds_read_b128 v[92:95], v1 offset:47104
    v_exp_f32 v192, v192
    v_mul_f32 v112, v112, v120
    v_exp_f32 v193, v193
    s_waitcnt lgkmcnt(3)
    v_mfma_f32_32x32x16_bf16 v[128:143], v[100:103], a[32:35], v[128:143]
    ds_read_b128 v[96:99], v1 offset:48128
    v_mul_f32 v113, v113, v121
    v_exp_f32 v194, v194
    v_mul_f32 v114, v114, v122
    v_exp_f32 v195, v195
    v_mfma_f32_32x32x16_bf16 v[128:143], v[104:107], a[36:39], v[128:143]
    ds_read_b128 v[100:103], v1 offset:49152
    v_mul_f32_e64 v115, v115, v123
    v_fma_f32 v192, v192, v38, v38
    v_fma_f32 v193, v193, v38, v38
    v_fma_f32 v194, v194, v38, v38
    v_fma_f32 v195, v195, v38, v38
    v_mfma_f32_32x32x16_bf16 v[128:143], v[108:111], a[40:43], v[128:143]
    ds_read_b128 v[104:107], v1 offset:50176
    v_rcp_f32 v192, v192
    v_rcp_f32 v193, v193
    v_rcp_f32 v194, v194
    v_mfma_f32_32x32x16_bf16 v[128:143], v[80:83], a[44:47], v[128:143]
    ds_read_b128 v[108:111], v1 offset:51200
    v_rcp_f32 v195, v195
    v_mul_f32 v112, v112, v192
    v_mul_f32 v113, v113, v193
    v_mul_f32 v114, v114, v194
    s_waitcnt lgkmcnt(3)
    v_mfma_f32_32x32x16_bf16 v[128:143], v[84:87], a[48:51], v[128:143]
    ds_read_b128 v[80:83], v1 offset:52224
    v_mul_f32 v115, v115, v195
    v_cvt_pk_bf16_f32 v200, v112, v113
    v_cvt_pk_bf16_f32 v201, v114, v115
    v_mul_f32 v196, v116, v116
    v_mul_f32 v197, v117, v117
    v_mul_f32 v198, v118, v118
    v_mfma_f32_32x32x16_bf16 v[128:143], v[88:91], a[52:55], v[128:143]
    ds_read_b128 v[84:87], v1 offset:53248
    v_mul_f32_e64 v199, v119, v119
    v_fma_f32 v196, v196, v36, v34
    v_fma_f32 v197, v197, v36, v34
    v_fma_f32 v198, v198, v36, v34
    v_fma_f32 v199, v199, v36, v34
    v_mul_f32 v196, v196, v116
    v_mfma_f32_32x32x16_bf16 v[128:143], v[92:95], a[56:59], v[128:143]
    ds_read_b128 v[88:91], v1 offset:54272
    v_mul_f32 v197, v197, v117
    v_mul_f32 v198, v198, v118
    v_mul_f32 v199, v199, v119
    v_exp_f32 v196, v196
    v_mul_f32 v116, v116, v124
    v_mfma_f32_32x32x16_bf16 v[128:143], v[96:99], a[60:63], v[128:143]
    ds_read_b128 v[92:95], v1 offset:55296
    v_exp_f32 v197, v197
    v_mul_f32 v117, v117, v125
    v_exp_f32 v198, v198
    s_waitcnt lgkmcnt(3)
    v_mfma_f32_32x32x16_bf16 v[128:143], v[100:103], a[64:67], v[128:143]
    ds_read_b128 v[96:99], v1 offset:56320
    v_mul_f32 v118, v118, v126
    v_exp_f32 v199, v199
    v_mul_f32 v119, v119, v127
    v_fma_f32 v196, v196, v38, v38
    v_fma_f32 v197, v197, v38, v38
    v_mfma_f32_32x32x16_bf16 v[128:143], v[104:107], a[68:71], v[128:143]
    ds_read_b128 v[100:103], v1 offset:57344
    v_fma_f32 v198, v198, v38, v38
    v_fma_f32 v199, v199, v38, v38
    v_rcp_f32 v196, v196
    v_rcp_f32 v197, v197
    v_mfma_f32_32x32x16_bf16 v[128:143], v[108:111], a[72:75], v[128:143]
    ds_read_b128 v[104:107], v1 offset:58368
    v_rcp_f32 v198, v198
    v_rcp_f32 v199, v199
    v_mul_f32 v116, v116, v196
    v_mul_f32 v117, v117, v197
    v_mfma_f32_32x32x16_bf16 v[128:143], v[80:83], a[76:79], v[128:143]
    ds_read_b128 v[108:111], v1 offset:59392
    v_mul_f32 v118, v118, v198
    v_mul_f32 v119, v119, v199
    v_cvt_pk_bf16_f32 v202, v116, v117
    v_cvt_pk_bf16_f32 v203, v118, v119
    s_add_u32 s76, s75, 65536
    s_waitcnt lgkmcnt(3)
    v_mfma_f32_32x32x16_bf16 v[128:143], v[84:87], a[80:83], v[128:143]
    buffer_store_dwordx4 v[200:203], v1, s[4:7], s76 offen sc1
    ds_read_b128 v[80:83], v1 offset:60416
    v_mfma_f32_32x32x16_bf16 v[128:143], v[88:91], a[84:87], v[128:143]
    ds_read_b128 v[84:87], v1 offset:61440
    v_mfma_f32_32x32x16_bf16 v[128:143], v[92:95], a[88:91], v[128:143]
    ds_read_b128 v[88:91], v1 offset:62464
    ds_write_b128 v33, a[216:219] offset:0
    v_mfma_f32_32x32x16_bf16 v[128:143], v[96:99], a[92:95], v[128:143]
    ds_read_b128 v[92:95], v1 offset:63488
    s_waitcnt lgkmcnt(4)
    v_mfma_f32_32x32x16_bf16 v[128:143], v[100:103], a[96:99], v[128:143]
    ds_read_b128 v[96:99], v1 offset:64512
    ds_write_b128 v33, a[220:223] offset:4096
    v_mfma_f32_32x32x16_bf16 v[128:143], v[104:107], a[100:103], v[128:143]
    s_waitcnt vmcnt(3)
    s_barrier
    v_mfma_f32_32x32x16_bf16 v[128:143], v[108:111], a[104:107], v[128:143]
    s_add_u32 m0, s56, 147456
    s_add_u32 s60, s63, 81920
    buffer_load_dwordx4 v1, s[8:11], s60 offen sc1 lds
    ds_read_b128 v[104:107], v2 offset:0
    ds_write_b128 v33, a[224:227] offset:8192
    v_mfma_f32_32x32x16_bf16 v[128:143], v[80:83], a[108:111], v[128:143]
    ds_read_b128 v[108:111], v2 offset:1024
    s_waitcnt lgkmcnt(4)
    v_mfma_f32_32x32x16_bf16 v[128:143], v[84:87], a[112:115], v[128:143]
    ds_read_b128 v[80:83], v2 offset:2048
    ds_write_b128 v33, a[228:231] offset:12288
    v_mfma_f32_32x32x16_bf16 v[128:143], v[88:91], a[116:119], v[128:143]
    buffer_load_dwordx4 v1, s[8:11], s60 offen offset:1024 sc1 lds
    ds_read_b128 v[84:87], v2 offset:3072
    v_mfma_f32_32x32x16_bf16 v[128:143], v[92:95], a[120:123], v[128:143]
    ds_read_b128 v[88:91], v2 offset:4096
    ds_write_b128 v33, a[232:235] offset:16384
    v_mfma_f32_32x32x16_bf16 v[128:143], v[96:99], a[124:127], v[128:143]
    ds_read_b128 v[92:95], v2 offset:5120
    v_mfma_f32_32x32x16_bf16 v[128:143], a[144:147], v[40:43], v[128:143]
    ds_read_b128 v[96:99], v2 offset:6144
    s_waitcnt lgkmcnt(4)
    v_mfma_f32_32x32x16_bf16 v[144:159], v[104:107], a[0:3], 0
    buffer_load_dwordx4 v1, s[8:11], s60 offen offset:2048 sc1 lds
    ds_read_b128 v[100:103], v2 offset:7168
    ds_write_b128 v33, a[236:239] offset:20480
    v_mfma_f32_32x32x16_bf16 v[144:159], v[108:111], a[4:7], v[144:159]
    ds_read_b128 v[104:107], v2 offset:8192
L_page_9:
    s_cbranch_execz L_main
    buffer_load_dword v26, v5, s[8:11], s81 offen sc1
    v_add_u32 v28, 15, v24
    s_mov_b64 exec, 1
    s_cmp_eq_u32 s53, 0
    s_cbranch_scc1 L_dev_118
    s_waitcnt vmcnt(5)
    buffer_store_dword v28, off, s[8:11], s82
L_sg_119:
    s_mov_b64 exec, -1
    v_mfma_f32_32x32x16_bf16 v[144:159], v[80:83], a[8:11], v[144:159]
    ds_read_b128 v[108:111], v2 offset:9216
    v_mul_f32 v192, v128, v128
    v_mul_f32 v193, v129, v129
    v_mul_f32 v194, v130, v130
    v_mul_f32 v195, v131, v131
    v_fma_f32 v192, v192, v36, v34
    v_fma_f32 v193, v193, v36, v34
    v_mfma_f32_32x32x16_bf16 v[144:159], v[84:87], a[12:15], v[144:159]
    ds_read_b128 v[80:83], v2 offset:10240
    v_fma_f32 v194, v194, v36, v34
    v_fma_f32 v195, v195, v36, v34
    v_mul_f32 v192, v192, v128
    v_mul_f32 v193, v193, v129
    v_mul_f32 v194, v194, v130
    s_waitcnt lgkmcnt(4)
    v_mfma_f32_32x32x16_bf16 v[144:159], v[88:91], a[16:19], v[144:159]
    buffer_load_dwordx4 v1, s[8:11], s60 offen offset:3072 sc1 lds
    ds_read_b128 v[84:87], v2 offset:11264
    v_mul_f32 v195, v195, v131
    v_mfma_f32_32x32x16_bf16 v[144:159], v[92:95], a[20:23], v[144:159]
    ds_read_b128 v[88:91], v2 offset:12288
    v_exp_f32 v192, v192
    v_mul_f32 v128, v128, v136
    v_exp_f32 v193, v193
    v_mul_f32 v129, v129, v137
    v_mfma_f32_32x32x16_bf16 v[144:159], v[96:99], a[24:27], v[144:159]
    ds_read_b128 v[92:95], v2 offset:13312
    v_exp_f32 v194, v194
    v_mul_f32 v130, v130, v138
    v_exp_f32 v195, v195
    v_mul_f32 v131, v131, v139
    v_mfma_f32_32x32x16_bf16 v[144:159], v[100:103], a[28:31], v[144:159]
    ds_read_b128 v[96:99], v2 offset:14336
    v_fma_f32 v192, v192, v38, v38
    v_fma_f32 v193, v193, v38, v38
    v_fma_f32 v194, v194, v38, v38
    v_fma_f32 v195, v195, v38, v38
    s_waitcnt lgkmcnt(3)
    v_mfma_f32_32x32x16_bf16 v[144:159], v[104:107], a[32:35], v[144:159]
    ds_read_b128 v[100:103], v2 offset:15360
    v_rcp_f32 v192, v192
    v_rcp_f32 v193, v193
    v_rcp_f32 v194, v194
    v_mfma_f32_32x32x16_bf16 v[144:159], v[108:111], a[36:39], v[144:159]
    ds_read_b128 v[104:107], v2 offset:16384
    v_rcp_f32 v195, v195
    v_mul_f32 v128, v128, v192
    v_mul_f32 v129, v129, v193
    v_mul_f32 v130, v130, v194
    v_mul_f32 v131, v131, v195
    v_mfma_f32_32x32x16_bf16 v[144:159], v[80:83], a[40:43], v[144:159]
    ds_read_b128 v[108:111], v2 offset:17408
    ds_write_b128 v33, a[240:243] offset:24576
    v_cvt_pk_bf16_f32 v204, v128, v129
    v_cvt_pk_bf16_f32 v205, v130, v131
    v_mul_f32 v196, v132, v132
    v_mul_f32 v197, v133, v133
    v_mul_f32 v198, v134, v134
    v_mfma_f32_32x32x16_bf16 v[144:159], v[84:87], a[44:47], v[144:159]
    ds_read_b128 v[80:83], v2 offset:18432
    v_mul_f32 v199, v135, v135
    v_fma_f32 v196, v196, v36, v34
    v_fma_f32 v197, v197, v36, v34
    v_fma_f32 v198, v198, v36, v34
    v_fma_f32 v199, v199, v36, v34
    s_waitcnt lgkmcnt(4)
    v_mfma_f32_32x32x16_bf16 v[144:159], v[88:91], a[48:51], v[144:159]
    ds_read_b128 v[84:87], v2 offset:19456
    ds_write_b128 v33, a[244:247] offset:28672
    v_mul_f32 v196, v196, v132
    v_mul_f32 v197, v197, v133
    v_mul_f32 v198, v198, v134
    v_mul_f32 v199, v199, v135
    v_mfma_f32_32x32x16_bf16 v[144:159], v[92:95], a[52:55], v[144:159]
    ds_read_b128 v[88:91], v2 offset:20480
    v_exp_f32 v196, v196
    v_mul_f32 v132, v132, v140
    v_exp_f32 v197, v197
    v_mul_f32 v133, v133, v141
    v_mfma_f32_32x32x16_bf16 v[144:159], v[96:99], a[56:59], v[144:159]
    ds_read_b128 v[92:95], v2 offset:21504
    v_exp_f32 v198, v198
    v_mul_f32 v134, v134, v142
    v_exp_f32 v199, v199
    v_mul_f32 v135, v135, v143
    v_mfma_f32_32x32x16_bf16 v[144:159], v[100:103], a[60:63], v[144:159]
    ds_read_b128 v[96:99], v2 offset:22528
    v_fma_f32 v196, v196, v38, v38
    v_fma_f32 v197, v197, v38, v38
    v_fma_f32 v198, v198, v38, v38
    v_fma_f32 v199, v199, v38, v38
    s_waitcnt lgkmcnt(4)
    v_mfma_f32_32x32x16_bf16 v[144:159], v[104:107], a[64:67], v[144:159]
    ds_read_b128 v[100:103], v2 offset:23552
    v_rcp_f32 v196, v196
    v_rcp_f32 v197, v197
    v_rcp_f32 v198, v198
    v_mfma_f32_32x32x16_bf16 v[144:159], v[108:111], a[68:71], v[144:159]
    ds_read_b128 v[104:107], v2 offset:24576
    v_rcp_f32 v199, v199
    v_mul_f32 v132, v132, v196
    v_mul_f32 v133, v133, v197
    v_mul_f32 v134, v134, v198
    v_mul_f32 v135, v135, v199
    v_mfma_f32_32x32x16_bf16 v[144:159], v[80:83], a[72:75], v[144:159]
    ds_read_b128 v[108:111], v2 offset:25600
    v_cvt_pk_bf16_f32 v206, v132, v133
    v_cvt_pk_bf16_f32 v207, v134, v135
    s_add_u32 s76, s75, 81920
    v_mfma_f32_32x32x16_bf16 v[144:159], v[84:87], a[76:79], v[144:159]
    buffer_store_dwordx4 v[204:207], v1, s[4:7], s76 offen sc1
    ds_read_b128 v[80:83], v2 offset:26624
    s_waitcnt lgkmcnt(3)
    v_mfma_f32_32x32x16_bf16 v[144:159], v[88:91], a[80:83], v[144:159]
    ds_read_b128 v[84:87], v2 offset:27648
    s_waitcnt vmcnt(3)
    s_add_u32 s57, s44, 13
L_chk_121:
    v_cmp_gt_u32 vcc, s57, v26
    s_nop 0
    s_cbranch_vccnz L_spin_120
    v_mfma_f32_32x32x16_bf16 v[144:159], v[92:95], a[84:87], v[144:159]
    ds_read_b128 v[88:91], v2 offset:28672
    s_xor_b32 s59, s75, 1024
    v_mfma_f32_32x32x16_bf16 v[144:159], v[96:99], a[88:91], v[144:159]
    buffer_load_dwordx4 a[4:7], v1, s[4:7], s59 offen sc1
    ds_read_b128 v[92:95], v2 offset:29696
    s_xor_b32 s59, s75, 2048
    v_mfma_f32_32x32x16_bf16 v[144:159], v[100:103], a[92:95], v[144:159]
    buffer_load_dwordx4 a[8:11], v1, s[4:7], s59 offen sc1
    ds_read_b128 v[96:99], v2 offset:30720
    s_xor_b32 s59, s75, 3072
    s_waitcnt lgkmcnt(3)
    v_mfma_f32_32x32x16_bf16 v[144:159], v[104:107], a[96:99], v[144:159]
    buffer_load_dwordx4 a[12:15], v1, s[4:7], s59 offen sc1
    ds_read_b128 v[100:103], v2 offset:31744
    s_xor_b32 s59, s75, 4096
    v_mfma_f32_32x32x16_bf16 v[144:159], v[108:111], a[100:103], v[144:159]
    buffer_load_dwordx4 a[16:19], v1, s[4:7], s59 offen sc1
    s_xor_b32 s59, s75, 5120
    s_barrier
    v_mfma_f32_32x32x16_bf16 v[144:159], v[80:83], a[104:107], v[144:159]
    buffer_load_dwordx4 a[20:23], v1, s[4:7], s59 offen sc1
    s_xor_b32 s59, s75, 6144
    v_mfma_f32_32x32x16_bf16 v[144:159], v[84:87], a[108:111], v[144:159]
    buffer_load_dwordx4 a[24:27], v1, s[4:7], s59 offen sc1
    s_xor_b32 s59, s75, 7168
    buffer_load_dword v27, v5, s[8:11], s81 offen sc1
    s_waitcnt lgkmcnt(0)
    v_mfma_f32_32x32x16_bf16 v[144:159], v[88:91], a[112:115], v[144:159]
    buffer_load_dwordx4 a[28:31], v1, s[4:7], s59 offen sc1
    s_xor_b32 s59, s75, 17408
    v_mfma_f32_32x32x16_bf16 v[144:159], v[92:95], a[116:119], v[144:159]
    buffer_load_dwordx4 a[36:39], v1, s[4:7], s59 offen sc1
    v_mfma_f32_32x32x16_bf16 v[144:159], v[96:99], a[120:123], v[144:159]
    v_mfma_f32_32x32x16_bf16 v[144:159], v[100:103], a[124:127], v[144:159]
    v_mfma_f32_32x32x16_bf16 v[144:159], a[142:145], v[42:45], v[144:159]
    ds_read_b128 v[80:83], v1 offset:0
    ds_read_b128 v[84:87], v1 offset:1024
    ds_read_b128 v[88:91], v1 offset:2048
    ds_read_b128 v[92:95], v1 offset:3072
    ds_read_b128 v[96:99], v1 offset:4096
    ds_read_b128 v[100:103], v1 offset:5120
    s_nop 5
    v_mul_f32 v192, v144, v144
    v_mul_f32 v193, v145, v145
    v_mul_f32 v194, v146, v146
    v_mul_f32 v195, v147, v147
    v_fma_f32 v192, v192, v36, v34
    v_fma_f32 v193, v193, v36, v34
    v_fma_f32 v194, v194, v36, v34
    v_fma_f32 v195, v195, v36, v34
    v_mul_f32 v192, v192, v144
    v_mul_f32 v193, v193, v145
    v_mul_f32 v194, v194, v146
    v_mul_f32 v195, v195, v147
    v_exp_f32 v192, v192
    v_mul_f32 v144, v144, v152
    v_exp_f32 v193, v193
    v_mul_f32 v145, v145, v153
    v_exp_f32 v194, v194
    v_mul_f32 v146, v146, v154
    v_exp_f32 v195, v195
    v_mul_f32 v147, v147, v155
    v_fma_f32 v192, v192, v38, v38
    v_fma_f32 v193, v193, v38, v38
    v_fma_f32 v194, v194, v38, v38
    v_fma_f32 v195, v195, v38, v38
    v_rcp_f32 v192, v192
    v_rcp_f32 v193, v193
    v_rcp_f32 v194, v194
    v_rcp_f32 v195, v195
    v_mul_f32 v144, v144, v192
    v_mul_f32 v145, v145, v193
    v_mul_f32 v146, v146, v194
    v_mul_f32 v147, v147, v195
    s_waitcnt lgkmcnt(4)
    v_mfma_f32_32x32x16_bf16 v[112:127], v[84:87], v[176:179], 0
    s_xor_b32 s59, s75, 18432
    buffer_load_dwordx4 a[40:43], v1, s[4:7], s59 offen sc1
    ds_read_b128 v[104:107], v1 offset:6144
    v_cvt_pk_bf16_f32 v208, v144, v145
    v_cvt_pk_bf16_f32 v209, v146, v147
    v_mfma_f32_32x32x16_bf16 v[48:63], v[80:83], v[176:179], v[48:63]
    ds_read_b128 v[108:111], v1 offset:7168
    ds_write_b128 v35, a[152:155] offset:32768
    s_xor_b32 s59, s75, 19456
    v_mul_f32 v196, v148, v148
    v_mul_f32 v197, v149, v149
    v_mul_f32 v198, v150, v150
    v_mul_f32 v199, v151, v151
    v_fma_f32 v196, v196, v36, v34
    s_waitcnt vmcnt(9) lgkmcnt(5)
    v_mfma_f32_32x32x16_bf16 v[112:127], v[92:95], a[4:7], v[112:127]
    buffer_load_dwordx4 a[44:47], v1, s[4:7], s59 offen sc1
    ds_read_b128 v[80:83], v1 offset:8192
    v_fma_f32 v197, v197, v36, v34
    v_fma_f32 v198, v198, v36, v34
    v_mfma_f32_32x32x16_bf16 v[48:63], v[88:91], a[4:7], v[48:63]
    ds_read_b128 v[84:87], v1 offset:9216
    ds_write_b128 v35, a[156:159] offset:36864
    s_xor_b32 s59, s75, 20480
    v_fma_f32 v199, v199, v36, v34
    v_mul_f32 v196, v196, v148
    v_mul_f32 v197, v197, v149
    v_mul_f32 v198, v198, v150
    v_mul_f32 v199, v199, v151
    s_waitcnt vmcnt(9) lgkmcnt(6)
    v_mfma_f32_32x32x16_bf16 v[112:127], v[100:103], a[8:11], v[112:127]
    buffer_load_dwordx4 a[48:51], v1, s[4:7], s59 offen sc1
    ds_read_b128 v[88:91], v1 offset:10240
    v_exp_f32 v196, v196
    v_mfma_f32_32x32x16_bf16 v[48:63], v[96:99], a[8:11], v[48:63]
    ds_read_b128 v[92:95], v1 offset:11264
    ds_write_b128 v35, a[160:163] offset:40960
    s_xor_b32 s59, s75, 21504
    v_mul_f32 v148, v148, v156
    v_exp_f32 v197, v197
    v_mul_f32 v149, v149, v157
    s_waitcnt vmcnt(9) lgkmcnt(7)
    v_mfma_f32_32x32x16_bf16 v[112:127], v[108:111], a[12:15], v[112:127]
    buffer_load_dwordx4 a[52:55], v1, s[4:7], s59 offen sc1
    ds_read_b128 v[96:99], v1 offset:12288
    v_exp_f32 v198, v198
    v_mfma_f32_32x32x16_bf16 v[48:63], v[104:107], a[12:15], v[48:63]
    ds_read_b128 v[100:103], v1 offset:13312
    ds_write_b128 v35, a[164:167] offset:45056
    s_xor_b32 s59, s75, 22528
    s_waitcnt vmcnt(9) lgkmcnt(7)
    v_add_u32 v28, 17, v24
    s_mov_b64 exec, 1
    s_cmp_eq_u32 s53, 0
    s_cbranch_scc1 L_dev_122
    buffer_store_dword v28, off, s[8:11], s82
L_sg_123:
    s_mov_b64 exec, -1
    v_mfma_f32_32x32x16_bf16 v[112:127], v[84:87], a[16:19], v[112:127]
    buffer_load_dwordx4 a[56:59], v1, s[4:7], s59 offen sc1
    ds_read_b128 v[104:107], v1 offset:14336
    v_mul_f32 v150, v150, v158
    v_mfma_f32_32x32x16_bf16 v[48:63], v[80:83], a[16:19], v[48:63]
    ds_read_b128 v[108:111], v1 offset:15360
    ds_write_b128 v35, a[168:171] offset:49152
    s_xor_b32 s59, s75, 23552
    v_exp_f32 v199, v199
    v_mul_f32 v151, v151, v159
    v_fma_f32 v196, v196, v38, v38
    v_fma_f32 v197, v197, v38, v38
    s_waitcnt vmcnt(10) lgkmcnt(7)
    v_mfma_f32_32x32x16_bf16 v[112:127], v[92:95], a[20:23], v[112:127]
    buffer_load_dwordx4 a[60:63], v1, s[4:7], s59 offen sc1
    ds_read_b128 v[80:83], v1 offset:16384
    v_fma_f32 v198, v198, v38, v38
    v_fma_f32 v199, v199, v38, v38
    v_mfma_f32_32x32x16_bf16 v[48:63], v[88:91], a[20:23], v[48:63]
    ds_read_b128 v[84:87], v1 offset:17408
    ds_write_b128 v35, a[172:175] offset:53248
    v_rcp_f32 v196, v196
    v_rcp_f32 v197, v197
    v_rcp_f32 v198, v198
    s_waitcnt vmcnt(10) lgkmcnt(7)
    v_mfma_f32_32x32x16_bf16 v[112:127], v[100:103], a[24:27], v[112:127]
    ds_read_b128 v[88:91], v1 offset:18432
    v_rcp_f32 v199, v199
    v_mul_f32 v148, v148, v196
    v_mul_f32 v149, v149, v197
    v_mul_f32 v150, v150, v198
    v_mul_f32 v151, v151, v199
    v_cvt_pk_bf16_f32 v210, v148, v149
    v_cvt_pk_bf16_f32 v211, v150, v151
    v_mfma_f32_32x32x16_bf16 v[48:63], v[96:99], a[24:27], v[48:63]
    ds_read_b128 v[92:95], v1 offset:19456
    ds_write_b128 v35, a[176:179] offset:57344
    s_xor_b32 s59, s75, 33792
    s_waitcnt vmcnt(8) lgkmcnt(7)
    s_add_u32 s57, s44, 15
L_chk_125:
    v_cmp_gt_u32 vcc, s57, v27
    s_nop 0
    s_cbranch_vccnz L_spin_124
    v_mfma_f32_32x32x16_bf16 v[112:127], v[108:111], a[28:31], v[112:127]
    buffer_load_dwordx4 a[4:7], v1, s[4:7], s59 offen sc1
    ds_read_b128 v[96:99], v1 offset:20480
    s_add_u32 s76, s75, 98304
    v_mfma_f32_32x32x16_bf16 v[48:63], v[104:107], a[28:31], v[48:63]
    buffer_store_dwordx4 v[208:211], v1, s[4:7], s76 offen sc1
    ds_read_b128 v[100:103], v1 offset:21504
    ds_write_b128 v35, a[180:183] offset:61440
    s_xor_b32 s59, s75, 34816
    s_waitcnt lgkmcnt(7)
    v_mfma_f32_32x32x16_bf16 v[112:127], v[84:87], v[180:183], v[112:127]
    buffer_load_dwordx4 a[8:11], v1, s[4:7], s59 offen sc1
    ds_read_b128 v[104:107], v1 offset:22528
    v_mfma_f32_32x32x16_bf16 v[48:63], v[80:83], v[180:183], v[48:63]
    ds_read_b128 v[108:111], v1 offset:23552
    s_xor_b32 s59, s75, 35840
    s_waitcnt vmcnt(10) lgkmcnt(6)
    v_mfma_f32_32x32x16_bf16 v[112:127], v[92:95], a[36:39], v[112:127]
    buffer_load_dwordx4 a[12:15], v1, s[4:7], s59 offen sc1
    ds_read_b128 v[80:83], v1 offset:24576
    v_mfma_f32_32x32x16_bf16 v[48:63], v[88:91], a[36:39], v[48:63]
    ds_read_b128 v[84:87], v1 offset:25600
    s_xor_b32 s59, s75, 36864
    s_waitcnt vmcnt(10) lgkmcnt(5)
    v_mfma_f32_32x32x16_bf16 v[112:127], v[100:103], a[40:43], v[112:127]
    buffer_load_dwordx4 a[16:19], v1, s[4:7], s59 offen sc1
    ds_read_b128 v[88:91], v1 offset:26624
    v_mfma_f32_32x32x16_bf16 v[48:63], v[96:99], a[40:43], v[48:63]
    ds_read_b128 v[92:95], v1 offset:27648
    ds_write_b128 v37, a[184:187] offset:0
    s_xor_b32 s59, s75, 37888
    s_waitcnt vmcnt(10) lgkmcnt(5)
    v_mfma_f32_32x32x16_bf16 v[112:127], v[108:111], a[44:47], v[112:127]
    buffer_load_dwordx4 a[20:23], v1, s[4:7], s59 offen sc1
    ds_read_b128 v[96:99], v1 offset:28672
    v_mfma_f32_32x32x16_bf16 v[48:63], v[104:107], a[44:47], v[48:63]
    ds_read_b128 v[100:103], v1 offset:29696
    s_xor_b32 s59, s75, 38912
    s_waitcnt vmcnt(10) lgkmcnt(5)
    s_barrier
    v_mfma_f32_32x32x16_bf16 v[112:127], v[84:87], a[48:51], v[112:127]
    buffer_load_dwordx4 a[24:27], v1, s[4:7], s59 offen sc1
    ds_read_b128 v[104:107], v1 offset:30720
    v_mfma_f32_32x32x16_bf16 v[48:63], v[80:83], a[48:51], v[48:63]
    ds_read_b128 v[108:111], v1 offset:31744
    ds_write_b128 v37, a[188:191] offset:4096
    s_xor_b32 s59, s75, 39936
    s_waitcnt vmcnt(10) lgkmcnt(6)
    buffer_load_dword v26, v5, s[8:11], s81 offen sc1
    v_mfma_f32_32x32x16_bf16 v[112:127], v[92:95], a[52:55], v[112:127]
    buffer_load_dwordx4 a[28:31], v1, s[4:7], s59 offen sc1
    ds_read_b128 v[80:83], v2 offset:32768
    v_mfma_f32_32x32x16_bf16 v[48:63], v[88:91], a[52:55], v[48:63]
    ds_read_b128 v[84:87], v2 offset:33792
    s_waitcnt vmcnt(10) lgkmcnt(5)
    v_mfma_f32_32x32x16_bf16 v[112:127], v[100:103], a[56:59], v[112:127]
    ds_read_b128 v[88:91], v2 offset:34816
    v_mfma_f32_32x32x16_bf16 v[48:63], v[96:99], a[56:59], v[48:63]
    ds_read_b128 v[92:95], v2 offset:35840
    ds_write_b128 v37, a[192:195] offset:8192
    s_xor_b32 s59, s75, 50176
    s_waitcnt vmcnt(9) lgkmcnt(6)
    v_mfma_f32_32x32x16_bf16 v[112:127], v[108:111], a[60:63], v[112:127]
    buffer_load_dwordx4 a[36:39], v1, s[4:7], s59 offen sc1
    ds_read_b128 v[96:99], v2 offset:36864
    v_mfma_f32_32x32x16_bf16 v[48:63], v[104:107], a[60:63], v[48:63]
    ds_read_b128 v[100:103], v2 offset:37888
    s_xor_b32 s59, s75, 51200
    s_waitcnt lgkmcnt(5)
    v_mfma_f32_32x32x16_bf16 v[112:127], v[84:87], v[184:187], v[112:127]
    buffer_load_dwordx4 a[40:43], v1, s[4:7], s59 offen sc1
    ds_read_b128 v[104:107], v2 offset:38912
    v_mfma_f32_32x32x16_bf16 v[48:63], v[80:83], v[184:187], v[48:63]
    ds_read_b128 v[108:111], v2 offset:39936
    ds_write_b128 v37, a[196:199] offset:12288
    s_xor_b32 s59, s75, 52224
    s_waitcnt vmcnt(10) lgkmcnt(6)
    v_mfma_f32_32x32x16_bf16 v[112:127], v[92:95], a[4:7], v[112:127]
    buffer_load_dwordx4 a[44:47], v1, s[4:7], s59 offen sc1
    ds_read_b128 v[80:83], v2 offset:40960
    v_mfma_f32_32x32x16_bf16 v[48:63], v[88:91], a[4:7], v[48:63]
    ds_read_b128 v[84:87], v2 offset:41984
    s_xor_b32 s59, s75, 53248
    s_waitcnt vmcnt(9) lgkmcnt(5)
    v_mfma_f32_32x32x16_bf16 v[112:127], v[100:103], a[8:11], v[112:127]
    buffer_load_dwordx4 a[48:51], v1, s[4:7], s59 offen sc1
    ds_read_b128 v[88:91], v2 offset:43008
    v_mfma_f32_32x32x16_bf16 v[48:63], v[96:99], a[8:11], v[48:63]
    ds_read_b128 v[92:95], v2 offset:44032
    ds_write_b128 v33, a[200:203] offset:32768
    s_xor_b32 s59, s75, 54272
    s_waitcnt vmcnt(9) lgkmcnt(6)
    v_mfma_f32_32x32x16_bf16 v[112:127], v[108:111], a[12:15], v[112:127]
    buffer_load_dwordx4 a[52:55], v1, s[4:7], s59 offen sc1
    ds_read_b128 v[96:99], v2 offset:45056
    v_mfma_f32_32x32x16_bf16 v[48:63], v[104:107], a[12:15], v[48:63]
    ds_read_b128 v[100:103], v2 offset:46080
    s_xor_b32 s59, s75, 55296
    s_waitcnt vmcnt(9) lgkmcnt(5)
    v_add_u32 v28, 18, v24
    s_mov_b64 exec, 1
    s_cmp_eq_u32 s53, 0
    s_cbranch_scc1 L_dev_126
    buffer_store_dword v28, off, s[8:11], s82
L_sg_127:
    s_mov_b64 exec, -1
    v_mfma_f32_32x32x16_bf16 v[112:127], v[84:87], a[16:19], v[112:127]
    buffer_load_dwordx4 a[56:59], v1, s[4:7], s59 offen sc1
    ds_read_b128 v[104:107], v2 offset:47104
    v_mfma_f32_32x32x16_bf16 v[48:63], v[80:83], a[16:19], v[48:63]
    ds_read_b128 v[108:111], v2 offset:48128
    ds_write_b128 v33, a[204:207] offset:36864
    s_xor_b32 s59, s75, 56320
    s_waitcnt vmcnt(10) lgkmcnt(6)
    v_mfma_f32_32x32x16_bf16 v[112:127], v[92:95], a[20:23], v[112:127]
    buffer_load_dwordx4 a[60:63], v1, s[4:7], s59 offen sc1
    ds_read_b128 v[80:83], v2 offset:49152
    v_mfma_f32_32x32x16_bf16 v[48:63], v[88:91], a[20:23], v[48:63]
    ds_read_b128 v[84:87], v2 offset:50176
    s_waitcnt vmcnt(10) lgkmcnt(5)
    v_mfma_f32_32x32x16_bf16 v[112:127], v[100:103], a[24:27], v[112:127]
    ds_read_b128 v[88:91], v2 offset:51200
    v_mfma_f32_32x32x16_bf16 v[48:63], v[96:99], a[24:27], v[48:63]
    ds_read_b128 v[92:95], v2 offset:52224
    ds_write_b128 v33, a[208:211] offset:40960
    s_xor_b32 s59, s75, 66560
    s_waitcnt vmcnt(8) lgkmcnt(6)
    s_add_u32 s57, s44, 17
L_chk_129:
    v_cmp_gt_u32 vcc, s57, v26
    s_nop 0
    s_cbranch_vccnz L_spin_128
    v_mfma_f32_32x32x16_bf16 v[112:127], v[108:111], a[28:31], v[112:127]
    buffer_load_dwordx4 a[4:7], v1, s[4:7], s59 offen sc1
    ds_read_b128 v[96:99], v2 offset:53248
    v_mfma_f32_32x32x16_bf16 v[48:63], v[104:107], a[28:31], v[48:63]
    ds_read_b128 v[100:103], v2 offset:54272
    s_xor_b32 s59, s75, 67584
    s_waitcnt lgkmcnt(5)
    v_mfma_f32_32x32x16_bf16 v[112:127], v[84:87], v[188:191], v[112:127]
    buffer_load_dwordx4 a[8:11], v1, s[4:7], s59 offen sc1
    ds_read_b128 v[104:107], v2 offset:55296
    v_mfma_f32_32x32x16_bf16 v[48:63], v[80:83], v[188:191], v[48:63]
    ds_read_b128 v[108:111], v2 offset:56320
    ds_write_b128 v33, a[212:215] offset:45056
    s_xor_b32 s59, s75, 68608
    s_waitcnt vmcnt(9) lgkmcnt(6)
    v_mfma_f32_32x32x16_bf16 v[112:127], v[92:95], a[36:39], v[112:127]
    buffer_load_dwordx4 a[12:15], v1, s[4:7], s59 offen sc1
    ds_read_b128 v[80:83], v2 offset:57344
    v_mfma_f32_32x32x16_bf16 v[48:63], v[88:91], a[36:39], v[48:63]
    ds_read_b128 v[84:87], v2 offset:58368
    s_xor_b32 s59, s75, 69632
    s_waitcnt vmcnt(9) lgkmcnt(5)
    v_mfma_f32_32x32x16_bf16 v[112:127], v[100:103], a[40:43], v[112:127]
    buffer_load_dwordx4 a[16:19], v1, s[4:7], s59 offen sc1
    ds_read_b128 v[88:91], v2 offset:59392
    v_mfma_f32_32x32x16_bf16 v[48:63], v[96:99], a[40:43], v[48:63]
    ds_read_b128 v[92:95], v2 offset:60416
    s_xor_b32 s59, s75, 70656
    s_waitcnt vmcnt(9) lgkmcnt(5)
    v_mfma_f32_32x32x16_bf16 v[112:127], v[108:111], a[44:47], v[112:127]
    buffer_load_dwordx4 a[20:23], v1, s[4:7], s59 offen sc1
    ds_read_b128 v[96:99], v2 offset:61440
    v_mfma_f32_32x32x16_bf16 v[48:63], v[104:107], a[44:47], v[48:63]
    ds_read_b128 v[100:103], v2 offset:62464
    s_xor_b32 s59, s75, 71680
    s_waitcnt vmcnt(9) lgkmcnt(4)
    s_barrier
    v_mfma_f32_32x32x16_bf16 v[112:127], v[84:87], a[48:51], v[112:127]
    buffer_load_dwordx4 a[24:27], v1, s[4:7], s59 offen sc1
    ds_read_b128 v[104:107], v2 offset:63488
    v_mfma_f32_32x32x16_bf16 v[48:63], v[80:83], a[48:51], v[48:63]
    ds_read_b128 v[108:111], v2 offset:64512
    s_xor_b32 s59, s75, 72704
    s_waitcnt vmcnt(9) lgkmcnt(4)
    buffer_load_dword v27, v5, s[8:11], s81 offen sc1
    v_mfma_f32_32x32x16_bf16 v[112:127], v[92:95], a[52:55], v[112:127]
    buffer_load_dwordx4 a[28:31], v1, s[4:7], s59 offen sc1
    ds_read_b128 v[80:83], v3 offset:0
    v_mfma_f32_32x32x16_bf16 v[48:63], v[88:91], a[52:55], v[48:63]
    ds_read_b128 v[84:87], v3 offset:1024
    s_waitcnt vmcnt(9) lgkmcnt(4)
    v_mfma_f32_32x32x16_bf16 v[112:127], v[100:103], a[56:59], v[112:127]
    ds_read_b128 v[88:91], v3 offset:2048
    v_mfma_f32_32x32x16_bf16 v[48:63], v[96:99], a[56:59], v[48:63]
    ds_read_b128 v[92:95], v3 offset:3072
    s_xor_b32 s59, s75, 82944
    s_waitcnt vmcnt(8) lgkmcnt(4)
    v_mfma_f32_32x32x16_bf16 v[112:127], v[108:111], a[60:63], v[112:127]
    buffer_load_dwordx4 a[36:39], v1, s[4:7], s59 offen sc1
    ds_read_b128 v[96:99], v3 offset:4096
    v_mfma_f32_32x32x16_bf16 v[48:63], v[104:107], a[60:63], v[48:63]
    ds_read_b128 v[100:103], v3 offset:5120
    s_xor_b32 s59, s75, 83968
    s_waitcnt lgkmcnt(4)
    v_mfma_f32_32x32x16_bf16 v[112:127], v[84:87], v[200:203], v[112:127]
    buffer_load_dwordx4 a[40:43], v1, s[4:7], s59 offen sc1
    ds_read_b128 v[104:107], v3 offset:6144
    v_mfma_f32_32x32x16_bf16 v[48:63], v[80:83], v[200:203], v[48:63]
    ds_read_b128 v[108:111], v3 offset:7168
    s_xor_b32 s59, s75, 84992
    s_waitcnt vmcnt(9) lgkmcnt(4)
    v_mfma_f32_32x32x16_bf16 v[112:127], v[92:95], a[4:7], v[112:127]
    buffer_load_dwordx4 a[44:47], v1, s[4:7], s59 offen sc1
    ds_read_b128 v[80:83], v3 offset:8192
    v_mfma_f32_32x32x16_bf16 v[48:63], v[88:91], a[4:7], v[48:63]
    ds_read_b128 v[84:87], v3 offset:9216
    s_xor_b32 s59, s75, 86016
    s_waitcnt vmcnt(9) lgkmcnt(4)
    v_mfma_f32_32x32x16_bf16 v[112:127], v[100:103], a[8:11], v[112:127]
    buffer_load_dwordx4 a[48:51], v1, s[4:7], s59 offen sc1
    ds_read_b128 v[88:91], v3 offset:10240
    v_mfma_f32_32x32x16_bf16 v[48:63], v[96:99], a[8:11], v[48:63]
    ds_read_b128 v[92:95], v3 offset:11264
    s_xor_b32 s59, s75, 87040
    s_waitcnt vmcnt(9) lgkmcnt(4)
    v_mfma_f32_32x32x16_bf16 v[112:127], v[108:111], a[12:15], v[112:127]
    buffer_load_dwordx4 a[52:55], v1, s[4:7], s59 offen sc1
    ds_read_b128 v[96:99], v3 offset:12288
    v_mfma_f32_32x32x16_bf16 v[48:63], v[104:107], a[12:15], v[48:63]
    ds_read_b128 v[100:103], v3 offset:13312
    s_xor_b32 s59, s75, 88064
    s_waitcnt vmcnt(9) lgkmcnt(4)
    v_mfma_f32_32x32x16_bf16 v[112:127], v[84:87], a[16:19], v[112:127]
    buffer_load_dwordx4 a[56:59], v1, s[4:7], s59 offen sc1
    ds_read_b128 v[104:107], v3 offset:14336
    v_mfma_f32_32x32x16_bf16 v[48:63], v[80:83], a[16:19], v[48:63]
    ds_read_b128 v[108:111], v3 offset:15360
    s_xor_b32 s59, s75, 89088
    s_waitcnt vmcnt(9) lgkmcnt(4)
    v_mfma_f32_32x32x16_bf16 v[112:127], v[92:95], a[20:23], v[112:127]
    buffer_load_dwordx4 a[60:63], v1, s[4:7], s59 offen sc1
    ds_read_b128 v[80:83], v3 offset:16384
    v_mfma_f32_32x32x16_bf16 v[48:63], v[88:91], a[20:23], v[48:63]
    ds_read_b128 v[84:87], v3 offset:17408
    s_waitcnt vmcnt(9) lgkmcnt(4)
    v_mfma_f32_32x32x16_bf16 v[112:127], v[100:103], a[24:27], v[112:127]
    ds_read_b128 v[88:91], v3 offset:18432
    v_mfma_f32_32x32x16_bf16 v[48:63], v[96:99], a[24:27], v[48:63]
    ds_read_b128 v[92:95], v3 offset:19456
    s_xor_b32 s59, s75, 99328
    s_waitcnt vmcnt(7) lgkmcnt(4)
    s_add_u32 s57, s44, 18
L_chk_131:
    v_cmp_gt_u32 vcc, s57, v27
    s_nop 0
    s_cbranch_vccnz L_spin_130
    v_mfma_f32_32x32x16_bf16 v[112:127], v[108:111], a[28:31], v[112:127]
    buffer_load_dwordx4 a[4:7], v1, s[4:7], s59 offen sc1
    ds_read_b128 v[96:99], v3 offset:20480
    v_mfma_f32_32x32x16_bf16 v[48:63], v[104:107], a[28:31], v[48:63]
    ds_read_b128 v[100:103], v3 offset:21504
    s_xor_b32 s59, s75, 100352
    s_waitcnt lgkmcnt(4)
    v_mfma_f32_32x32x16_bf16 v[112:127], v[84:87], v[204:207], v[112:127]
    buffer_load_dwordx4 a[8:11], v1, s[4:7], s59 offen sc1
    ds_read_b128 v[104:107], v3 offset:22528
    v_mfma_f32_32x32x16_bf16 v[48:63], v[80:83], v[204:207], v[48:63]
    ds_read_b128 v[108:111], v3 offset:23552
    s_xor_b32 s59, s75, 101376
    s_waitcnt vmcnt(8) lgkmcnt(4)
    v_lshrrev_b32 v217, 6, v1
    v_bfe_u32 v218, v1, 4, 2
    v_bfe_u32 v216, v217, 1, 2
    v_xor_b32 v216, v216, v218
    v_lshlrev_b32 v216, 4, v216
    v_lshl_add_u32 v216, v217, 6, v216
    v_mfma_f32_32x32x16_bf16 v[112:127], v[92:95], a[36:39], v[112:127]
    buffer_load_dwordx4 a[12:15], v1, s[4:7], s59 offen sc1
    ds_read_b128 v[80:83], v3 offset:24576
    v_mfma_f32_32x32x16_bf16 v[48:63], v[88:91], a[36:39], v[48:63]
    ds_read_b128 v[84:87], v3 offset:25600
    s_xor_b32 s59, s75, 102400
    s_waitcnt vmcnt(8) lgkmcnt(4)
    s_lshr_b32 s57, s56, 1
    s_add_u32 s57, s57, 65536
    v_add_u32 v216, s57, v216
    v_subrev_u32 v9, 32768, v9
    v_subrev_u32 v10, 32768, v10
    v_lshlrev_b32 v217, 10, v217
    v_lshl_add_u32 v217, v218, 4, v217
    v_mfma_f32_32x32x16_bf16 v[112:127], v[100:103], a[40:43], v[112:127]
    buffer_load_dwordx4 a[16:19], v1, s[4:7], s59 offen sc1
    ds_read_b128 v[88:91], v3 offset:26624
    v_mfma_f32_32x32x16_bf16 v[48:63], v[96:99], a[40:43], v[48:63]
    ds_read_b128 v[92:95], v3 offset:27648
    s_xor_b32 s59, s75, 103424
    s_waitcnt vmcnt(8) lgkmcnt(4)
    v_mfma_f32_32x32x16_bf16 v[112:127], v[108:111], a[44:47], v[112:127]
    buffer_load_dwordx4 a[20:23], v1, s[4:7], s59 offen sc1
    ds_read_b128 v[96:99], v3 offset:28672
    v_mfma_f32_32x32x16_bf16 v[48:63], v[104:107], a[44:47], v[48:63]
    ds_read_b128 v[100:103], v3 offset:29696
    s_xor_b32 s59, s75, 104448
    s_waitcnt vmcnt(8) lgkmcnt(4)
    v_mfma_f32_32x32x16_bf16 v[112:127], v[84:87], a[48:51], v[112:127]
    buffer_load_dwordx4 a[24:27], v1, s[4:7], s59 offen sc1
    ds_read_b128 v[104:107], v3 offset:30720
    v_mfma_f32_32x32x16_bf16 v[48:63], v[80:83], a[48:51], v[48:63]
    ds_read_b128 v[108:111], v3 offset:31744
    s_xor_b32 s59, s75, 105472
    s_waitcnt vmcnt(8) lgkmcnt(4)
    v_mfma_f32_32x32x16_bf16 v[112:127], v[92:95], a[52:55], v[112:127]
    buffer_load_dwordx4 a[28:31], v1, s[4:7], s59 offen sc1
L_page_10:
    s_cbranch_execz L_main
    ds_read_b128 v[80:83], v1 offset:32768
    v_mfma_f32_32x32x16_bf16 v[48:63], v[88:91], a[52:55], v[48:63]
    ds_read_b128 v[84:87], v1 offset:33792
    s_waitcnt vmcnt(8) lgkmcnt(4)
    v_mfma_f32_32x32x16_bf16 v[112:127], v[100:103], a[56:59], v[112:127]
    ds_read_b128 v[88:91], v1 offset:34816
    v_mfma_f32_32x32x16_bf16 v[48:63], v[96:99], a[56:59], v[48:63]
    ds_read_b128 v[92:95], v1 offset:35840
    s_waitcnt vmcnt(7) lgkmcnt(4)
    v_mfma_f32_32x32x16_bf16 v[112:127], v[108:111], a[60:63], v[112:127]
    ds_read_b128 v[96:99], v1 offset:36864
    v_mfma_f32_32x32x16_bf16 v[48:63], v[104:107], a[60:63], v[48:63]
    ds_read_b128 v[100:103], v1 offset:37888
    s_waitcnt lgkmcnt(4)
    v_mfma_f32_32x32x16_bf16 v[112:127], v[84:87], v[208:211], v[112:127]
    ds_read_b128 v[104:107], v1 offset:38912
    v_mfma_f32_32x32x16_bf16 v[48:63], v[80:83], v[208:211], v[48:63]
    ds_read_b128 v[108:111], v1 offset:39936
    s_waitcnt vmcnt(6) lgkmcnt(4)
    v_mfma_f32_32x32x16_bf16 v[112:127], v[92:95], a[4:7], v[112:127]
    ds_read_b128 v[80:83], v1 offset:40960
    v_mfma_f32_32x32x16_bf16 v[48:63], v[88:91], a[4:7], v[48:63]
    ds_read_b128 v[84:87], v1 offset:41984
    s_waitcnt vmcnt(5) lgkmcnt(4)
    v_mfma_f32_32x32x16_bf16 v[112:127], v[100:103], a[8:11], v[112:127]
    ds_read_b128 v[88:91], v1 offset:43008
    ds_read_b128 v[92:95], v1 offset:44032
    s_waitcnt vmcnt(4) lgkmcnt(4)
    v_mfma_f32_32x32x16_bf16 v[112:127], v[108:111], a[12:15], v[112:127]
    ds_read_b128 v[100:103], v1 offset:46080
    s_waitcnt vmcnt(3) lgkmcnt(3)
    v_mfma_f32_32x32x16_bf16 v[112:127], v[84:87], a[16:19], v[112:127]
    ds_read_b128 v[108:111], v1 offset:48128
    s_waitcnt vmcnt(2) lgkmcnt(2)
    v_mfma_f32_32x32x16_bf16 v[112:127], v[92:95], a[20:23], v[112:127]
    s_waitcnt vmcnt(1) lgkmcnt(1)
    v_mfma_f32_32x32x16_bf16 v[112:127], v[100:103], a[24:27], v[112:127]
    s_waitcnt vmcnt(0) lgkmcnt(0)
    v_mfma_f32_32x32x16_bf16 v[112:127], v[108:111], a[28:31], v[112:127]
    ds_read_b128 v[92:95], v1 offset:45056
    ds_read_b128 v[100:103], v1 offset:47104
    s_nop 3
    v_mfma_f32_32x32x16_bf16 v[48:63], v[96:99], a[8:11], v[48:63]
    s_xor_b32 s59, s68, 2048
    s_nop 3
    v_cvt_pk_bf16_f32 v72, v112, v113
    v_cvt_pk_bf16_f32 v73, v114, v115
    v_cvt_pk_bf16_f32 v74, v116, v117
    v_cvt_pk_bf16_f32 v75, v118, v119
    v_min_u32 v72, -2, v72
    v_min_u32 v73, -2, v73
    v_min_u32 v74, -2, v74
    v_min_u32_e64 v75, -2, v75
    v_cvt_pk_bf16_f32 v76, v120, v121
    v_cvt_pk_bf16_f32 v77, v122, v123
    v_cvt_pk_bf16_f32 v78, v124, v125
    v_cvt_pk_bf16_f32 v79, v126, v127
    v_min_u32 v76, -2, v76
    v_min_u32 v77, -2, v77
    v_min_u32 v78, -2, v78
    v_min_u32 v79, -2, v79
    s_cmp_eq_u32 s53, 0
    s_cbranch_scc1 L_dev_132
    buffer_store_dwordx4 v[72:75], v1, s[4:7], s59 offen offset:0
    buffer_store_dwordx4 v[76:79], v1, s[4:7], s59 offen offset:1024
L_st_133:
    v_mfma_f32_32x32x16_bf16 v[48:63], v[104:107], a[12:15], v[48:63]
    v_mfma_f32_32x32x16_bf16 v[48:63], v[80:83], a[16:19], v[48:63]
    v_mfma_f32_32x32x16_bf16 v[48:63], v[88:91], a[20:23], v[48:63]
    s_waitcnt lgkmcnt(0)
    v_mfma_f32_32x32x16_bf16 v[48:63], v[92:95], a[24:27], v[48:63]
    v_mfma_f32_32x32x16_bf16 v[48:63], v[100:103], a[28:31], v[48:63]
L_swap_134:
    buffer_load_dwordx4 v[176:179], v1, s[4:7], s68 offen offset:0 sc1
    buffer_load_dwordx4 v[180:183], v1, s[4:7], s68 offen offset:1024 sc1
    s_sub_u32 s54, s54, 1
    s_cbranch_scc1 L_abort
L_swapc_135:
    s_waitcnt vmcnt(0)
    v_max3_u32 v184, v176, v177, v178
    v_max3_u32 v185, v179, v180, v181
    v_max3_u32 v184, v182, v183, v184
    v_max_u32 v184, v184, v185
    v_cmp_eq_u32 vcc, -1, v184
    s_nop 0
    s_cbranch_vccnz L_swap_134
    v_dot2_f32_bf16 v48, v176, s87, v48
    v_dot2_f32_bf16 v49, v176, s88, v49
    v_dot2_f32_bf16 v50, v177, s87, v50
    v_dot2_f32_bf16 v51, v177, s88, v51
    v_dot2_f32_bf16 v52, v178, s87, v52
    v_dot2_f32_bf16 v53, v178, s88, v53
    v_dot2_f32_bf16 v54, v179, s87, v54
    v_dot2_f32_bf16 v55, v179, s88, v55
    v_dot2_f32_bf16 v56, v180, s87, v56
    v_dot2_f32_bf16 v57, v180, s88, v57
    v_dot2_f32_bf16 v58, v181, s87, v58
    v_dot2_f32_bf16 v59, v181, s88, v59
    v_dot2_f32_bf16 v60, v182, s87, v60
    v_dot2_f32_bf16 v61, v182, s88, v61
    v_dot2_f32_bf16 v62, v183, s87, v62
    v_dot2_f32_bf16 v63, v183, s88, v63
    v_cvt_pk_bf16_f32 v64, v48, v49
    v_cvt_pk_bf16_f32 v65, v50, v51
    v_cvt_pk_bf16_f32 v66, v52, v53
    v_cvt_pk_bf16_f32 v67, v54, v55
    v_cvt_pk_bf16_f32 v68, v56, v57
    v_cvt_pk_bf16_f32 v69, v58, v59
    v_cvt_pk_bf16_f32 v70, v60, v61
    v_cvt_pk_bf16_f32 v71, v62, v63
    ds_write_b128 v9, v[64:67]
    ds_write_b128 v10, v[68:71]
    s_waitcnt lgkmcnt(0)
    ds_read_b128 v[64:67], v216
    ds_read_b128 v[68:71], v216 offset:1024
    s_add_u32 s57, s70, 16384
    s_waitcnt lgkmcnt(1)
    buffer_store_dwordx4 v[64:67], v217, s[40:43], s70 offen
    s_waitcnt lgkmcnt(0)
    buffer_store_dwordx4 v[68:71], v217, s[40:43], s57 offen
    s_cmp_lg_u32 s77, 0
    s_cbranch_scc1 L_done
    s_mov_b64 exec, 1
    buffer_store_dwordx2 v[24:25], off, s[8:11], 0 offset:0
    s_mov_b64 exec, -1
L_done:
L_abort:
    s_endpgm
L_spin_9:
    buffer_load_dwordx2 v[26:27], v220, s[8:11], s93 offen sc1
    s_waitcnt vmcnt(0)
    s_sub_u32 s54, s54, 1
    s_cbranch_scc0 L_chk_10
    s_endpgm
L_spin_11:
    buffer_load_dwordx2 v[28:29], v216, s[8:11], s94 offen sc1
    s_waitcnt vmcnt(0)
    s_sub_u32 s54, s54, 1
    s_cbranch_scc0 L_chk_12
    s_endpgm
L_late_17_a:
    s_mov_b32 s90, 0xff
    v_mov_b32 v112, 0
    v_mov_b32 v113, 0
    v_mov_b32 v114, 0
    v_mov_b32 v115, 0
    v_mov_b32 v116, 0
    v_mov_b32 v117, 0
    v_mov_b32 v118, 0
    v_mov_b32 v119, 0
    s_branch L_late_17_b
L_late_17:
    s_sub_u32 s54, s54, 1
    s_cbranch_scc1 L_abort
    s_waitcnt vmcnt(0)
L_late_17_b:
    s_bitcmp1_b32 s90, 0
    s_cbranch_scc0 L_next_19
    v_max3_u32 v216, v128, v129, v130
    v_max3_u32 v216, v131, v132, v216
    v_max3_u32 v216, v133, v134, v216
    v_max_u32 v216, v135, v216
    v_cmp_eq_u32 vcc, -1, v216
    s_nop 0
    s_cbranch_vccnz L_again_20
    v_mfma_f32_32x32x16_bf16 v[112:127], a[148:151], v[128:131], v[112:127]
    v_mfma_f32_32x32x16_bf16 v[112:127], a[148:151], v[132:135], v[112:127]
    s_bitset0_b32 s90, 0
    s_cmp_eq_u32 s90, 0
    s_cbranch_scc1 L_summed_18_w
    s_branch L_next_19
L_again_20:
    s_add_u32 s57, s50, 2
    s_and_b32 s57, s57, 14
    s_mul_i32 s57, s57, 640
    s_add_u32 s59, s57, s89
    buffer_load_dwordx4 v[128:131], v16, s[8:11], s59 offen offset:0 sc1
    buffer_load_dwordx4 v[132:135], v16, s[8:11], s59 offen offset:640 sc1
L_next_19:
    s_bitcmp1_b32 s90, 1
    s_cbranch_scc0 L_next_21
    v_max3_u32 v216, v136, v137, v138
    v_max3_u32 v216, v139, v140, v216
    v_max3_u32 v216, v141, v142, v216
    v_max_u32 v216, v143, v216
    v_cmp_eq_u32 vcc, -1, v216
    s_nop 0
    s_cbranch_vccnz L_again_22
    v_mfma_f32_32x32x16_bf16 v[112:127], a[148:151], v[136:139], v[112:127]
    v_mfma_f32_32x32x16_bf16 v[112:127], a[148:151], v[140:143], v[112:127]
    s_bitset0_b32 s90, 1
    s_cmp_eq_u32 s90, 0
    s_cbranch_scc1 L_summed_18_w
    s_branch L_next_21
L_again_22:
    s_add_u32 s57, s50, 4
    s_and_b32 s57, s57, 14
    s_mul_i32 s57, s57, 640
    s_add_u32 s59, s57, s89
    buffer_load_dwordx4 v[136:139], v16, s[8:11], s59 offen offset:0 sc1
    buffer_load_dwordx4 v[140:143], v16, s[8:11], s59 offen offset:640 sc1
L_next_21:
    s_bitcmp1_b32 s90, 2
    s_cbranch_scc0 L_next_23
    v_max3_u32 v216, v176, v177, v178
    v_max3_u32 v216, v179, v180, v216
    v_max3_u32 v216, v181, v182, v216
    v_max_u32 v216, v183, v216
    v_cmp_eq_u32 vcc, -1, v216
    s_nop 0
    s_cbranch_vccnz L_again_24
    v_mfma_f32_32x32x16_bf16 v[112:127], a[148:151], v[176:179], v[112:127]
    v_mfma_f32_32x32x16_bf16 v[112:127], a[148:151], v[180:183], v[112:127]
    s_bitset0_b32 s90, 2
    s_cmp_eq_u32 s90, 0
    s_cbranch_scc1 L_summed_18_w
    s_branch L_next_23
L_again_24:
    s_add_u32 s57, s50, 6
    s_and_b32 s57, s57, 14
    s_mul_i32 s57, s57, 640
    s_add_u32 s59, s57, s89
    buffer_load_dwordx4 v[176:179], v16, s[8:11], s59 offen offset:0 sc1
    buffer_load_dwordx4 v[180:183], v16, s[8:11], s59 offen offset:640 sc1
L_next_23:
    s_bitcmp1_b32 s90, 3
    s_cbranch_scc0 L_next_25
    v_max3_u32 v216, v184, v185, v186
    v_max3_u32 v216, v187, v188, v216
    v_max3_u32 v216, v189, v190, v216
    v_max_u32 v216, v191, v216
    v_cmp_eq_u32 vcc, -1, v216
    s_nop 0
    s_cbranch_vccnz L_again_26
    v_mfma_f32_32x32x16_bf16 v[112:127], a[148:151], v[184:187], v[112:127]
    v_mfma_f32_32x32x16_bf16 v[112:127], a[148:151], v[188:191], v[112:127]
    s_bitset0_b32 s90, 3
    s_cmp_eq_u32 s90, 0
    s_cbranch_scc1 L_summed_18_w
    s_branch L_next_25
L_again_26:
    s_add_u32 s57, s50, 8
    s_and_b32 s57, s57, 14
    s_mul_i32 s57, s57, 640
    s_add_u32 s59, s57, s89
    buffer_load_dwordx4 v[184:187], v16, s[8:11], s59 offen offset:0 sc1
    buffer_load_dwordx4 v[188:191], v16, s[8:11], s59 offen offset:640 sc1
L_next_25:
    s_bitcmp1_b32 s90, 4
    s_cbranch_scc0 L_next_27
    v_max3_u32 v216, v192, v193, v194
    v_max3_u32 v216, v195, v196, v216
    v_max3_u32 v216, v197, v198, v216
    v_max_u32 v216, v199, v216
    v_cmp_eq_u32 vcc, -1, v216
    s_nop 0
    s_cbranch_vccnz L_again_28
    v_mfma_f32_32x32x16_bf16 v[112:127], a[148:151], v[192:195], v[112:127]
    v_mfma_f32_32x32x16_bf16 v[112:127], a[148:151], v[196:199], v[112:127]
    s_bitset0_b32 s90, 4
    s_cmp_eq_u32 s90, 0
    s_cbranch_scc1 L_summed_18_w
    s_branch L_next_27
L_again_28:
    s_add_u32 s57, s50, 10
    s_and_b32 s57, s57, 14
    s_mul_i32 s57, s57, 640
    s_add_u32 s59, s57, s89
    buffer_load_dwordx4 v[192:195], v16, s[8:11], s59 offen offset:0 sc1
    buffer_load_dwordx4 v[196:199], v16, s[8:11], s59 offen offset:640 sc1
L_next_27:
    s_bitcmp1_b32 s90, 5
    s_cbranch_scc0 L_next_29
    v_max3_u32 v216, v200, v201, v202
    v_max3_u32 v216, v203, v204, v216
    v_max3_u32 v216, v205, v206, v216
    v_max_u32 v216, v207, v216
    v_cmp_eq_u32 vcc, -1, v216
    s_nop 0
    s_cbranch_vccnz L_again_30
    v_mfma_f32_32x32x16_bf16 v[112:127], a[148:151], v[200:203], v[112:127]
    v_mfma_f32_32x32x16_bf16 v[112:127], a[148:151], v[204:207], v[112:127]
    s_bitset0_b32 s90, 5
    s_cmp_eq_u32 s90, 0
    s_cbranch_scc1 L_summed_18_w
    s_branch L_next_29
L_again_30:
    s_add_u32 s57, s50, 12
    s_and_b32 s57, s57, 14
    s_mul_i32 s57, s57, 640
    s_add_u32 s59, s57, s89
    buffer_load_dwordx4 v[200:203], v16, s[8:11], s59 offen offset:0 sc1
    buffer_load_dwordx4 v[204:207], v16, s[8:11], s59 offen offset:640 sc1
L_next_29:
    s_bitcmp1_b32 s90, 6
    s_cbranch_scc0 L_next_31
    v_max3_u32 v216, v48, v49, v50
    v_max3_u32 v216, v51, v52, v216
    v_max3_u32 v216, v53, v54, v216
    v_max_u32 v216, v55, v216
    v_cmp_eq_u32 vcc, -1, v216
    s_nop 0
    s_cbranch_vccnz L_again_32
    v_mfma_f32_32x32x16_bf16 v[112:127], a[148:151], v[48:51], v[112:127]
    v_mfma_f32_32x32x16_bf16 v[112:127], a[148:151], v[52:55], v[112:127]
    s_bitset0_b32 s90, 6
    s_cmp_eq_u32 s90, 0
    s_cbranch_scc1 L_summed_18_w
    s_branch L_next_31
L_again_32:
    s_add_u32 s57, s50, 14
    s_and_b32 s57, s57, 14
    s_mul_i32 s57, s57, 640
    s_add_u32 s59, s57, s89
    buffer_load_dwordx4 v[48:51], v16, s[8:11], s59 offen offset:0 sc1
    buffer_load_dwordx4 v[52:55], v16, s[8:11], s59 offen offset:640 sc1
L_next_31:
    s_bitcmp1_b32 s90, 7
    s_cbranch_scc0 L_next_33
    v_max3_u32 v216, v56, v57, v58
    v_max3_u32 v216, v59, v60, v216
    v_max3_u32 v216, v61, v62, v216
    v_max_u32 v216, v63, v216
    v_cmp_eq_u32 vcc, -1, v216
    s_nop 0
    s_cbranch_vccnz L_again_34
    v_mfma_f32_32x32x16_bf16 v[112:127], a[148:151], v[56:59], v[112:127]
    v_mfma_f32_32x32x16_bf16 v[112:127], a[148:151], v[60:63], v[112:127]
    s_bitset0_b32 s90, 7
    s_cmp_eq_u32 s90, 0
    s_cbranch_scc1 L_summed_18_w
    s_branch L_next_33
L_again_34:
    s_add_u32 s57, s50, 16
    s_and_b32 s57, s57, 14
    s_mul_i32 s57, s57, 640
    s_add_u32 s59, s57, s89
    buffer_load_dwordx4 v[56:59], v16, s[8:11], s59 offen offset:0 sc1
    buffer_load_dwordx4 v[60:63], v16, s[8:11], s59 offen offset:640 sc1
L_next_33:
    s_branch L_late_17
L_summed_18_w:
    s_nop 8
    v_cvt_pk_bf16_f32 v80, v112, v113
    v_cvt_pk_bf16_f32 v81, v114, v115
    v_cvt_pk_bf16_f32 v82, v116, v117
    v_cvt_pk_bf16_f32 v83, v118, v119
    s_branch L_summed_18
L_dev_35:
    s_waitcnt vmcnt(0)
    buffer_atomic_swap v28, off, s[8:11], s82 sc1
    s_branch L_sg_36
L_dev_40:
    s_waitcnt vmcnt(0)
    buffer_atomic_swap v28, off, s[8:11], s84 sc1
    s_branch L_sg_41
L_dev_44:
    buffer_store_dwordx4 v[72:75], v1, s[4:7], s68 offen offset:0 sc1
    s_branch L_st_45
L_dev_46:
    buffer_store_dwordx4 v[72:75], v1, s[4:7], s68 offen offset:1024 sc1
    s_branch L_st_47
L_dev_48:
    s_waitcnt vmcnt(0)
    buffer_atomic_swap v28, off, s[8:11], s82 sc1
    s_branch L_sg_49
L_dev_50:
    s_waitcnt vmcnt(0)
    buffer_atomic_swap v28, off, s[8:11], s82 sc1
    s_branch L_sg_51
L_spin_52:
    buffer_load_dword v26, v5, s[8:11], s81 offen sc1
    s_waitcnt vmcnt(0)
    s_sub_u32 s54, s54, 1
    s_cbranch_scc0 L_chk_53
    s_endpgm
L_spin_54:
    buffer_load_dword v27, v5, s[8:11], s81 offen sc1
    s_waitcnt vmcnt(0)
    s_sub_u32 s54, s54, 1
    s_cbranch_scc0 L_chk_55
    s_endpgm
L_dev_56:
    s_waitcnt vmcnt(0)
    buffer_atomic_swap v28, off, s[8:11], s82 sc1
    s_branch L_sg_57
L_dev_58:
    s_waitcnt vmcnt(0)
    buffer_atomic_swap v28, off, s[8:11], s82 sc1
    s_branch L_sg_59
L_spin_60:
    buffer_load_dword v26, v5, s[8:11], s81 offen sc1
    s_waitcnt vmcnt(0)
    s_sub_u32 s54, s54, 1
    s_cbranch_scc0 L_chk_61
    s_endpgm
L_spin_63:
    buffer_load_dword v27, v5, s[8:11], s81 offen sc1
    s_waitcnt vmcnt(0)
    s_sub_u32 s54, s54, 1
    s_cbranch_scc0 L_chk_64
    s_endpgm
L_dev_65:
    buffer_store_dwordx4 v[72:75], v1, s[4:7], s59 offen offset:0 sc1
    buffer_store_dwordx4 v[76:79], v1, s[4:7], s59 offen offset:1024 sc1
    s_branch L_st_66
L_dev_69:
    buffer_store_dwordx4 v[64:67], v1, s[4:7], s68 offen sc1
    buffer_store_dwordx4 v[68:71], v1, s[4:7], s68 offen offset:1024 sc1
    s_branch L_st_70
L_dev_71:
    buffer_store_dword v176, v39, s[4:7], s80 offen sc1
    s_branch L_st_72
L_dev_73:
    s_waitcnt vmcnt(0)
    buffer_atomic_swap v28, off, s[8:11], s82 sc1
    s_branch L_sg_74
L_late_79_a:
    s_mov_b32 s90, 0xff
    v_mov_b32 v112, 0
    v_mov_b32 v113, 0
    v_mov_b32 v114, 0
    v_mov_b32 v115, 0
    v_mov_b32 v116, 0
    v_mov_b32 v117, 0
    v_mov_b32 v118, 0
    v_mov_b32 v119, 0
    s_branch L_late_79_b
L_late_79:
    s_sub_u32 s54, s54, 1
    s_cbranch_scc1 L_abort
    s_waitcnt vmcnt(0)
L_late_79_b:
    s_bitcmp1_b32 s90, 0
    s_cbranch_scc0 L_next_81
    v_max3_u32 v216, v128, v129, v130
    v_max3_u32 v216, v131, v132, v216
    v_max3_u32 v216, v133, v134, v216
    v_max_u32 v216, v135, v216
    v_cmp_eq_u32 vcc, -1, v216
    s_nop 0
    s_cbranch_vccnz L_again_82
    v_mfma_f32_32x32x16_bf16 v[112:127], a[148:151], v[128:131], v[112:127]
    v_mfma_f32_32x32x16_bf16 v[112:127], a[148:151], v[132:135], v[112:127]
    s_bitset0_b32 s90, 0
    s_cmp_eq_u32 s90, 0
    s_cbranch_scc1 L_summed_80_w
    s_branch L_next_81
L_again_82:
    s_add_u32 s57, s50, 2
    s_and_b32 s57, s57, 14
    s_mul_i32 s57, s57, 640
    s_add_u32 s59, s57, s89
    buffer_load_dwordx4 v[128:131], v16, s[8:11], s59 offen offset:0 sc1
    buffer_load_dwordx4 v[132:135], v16, s[8:11], s59 offen offset:640 sc1
L_next_81:
    s_bitcmp1_b32 s90, 1
    s_cbranch_scc0 L_next_83
    v_max3_u32 v216, v136, v137, v138
    v_max3_u32 v216, v139, v140, v216
    v_max3_u32 v216, v141, v142, v216
    v_max_u32 v216, v143, v216
    v_cmp_eq_u32 vcc, -1, v216
    s_nop 0
    s_cbranch_vccnz L_again_84
    v_mfma_f32_32x32x16_bf16 v[112:127], a[148:151], v[136:139], v[112:127]
    v_mfma_f32_32x32x16_bf16 v[112:127], a[148:151], v[140:143], v[112:127]
    s_bitset0_b32 s90, 1
    s_cmp_eq_u32 s90, 0
    s_cbranch_scc1 L_summed_80_w
    s_branch L_next_83
L_again_84:
    s_add_u32 s57, s50, 4
    s_and_b32 s57, s57, 14
    s_mul_i32 s57, s57, 640
    s_add_u32 s59, s57, s89
    buffer_load_dwordx4 v[136:139], v16, s[8:11], s59 offen offset:0 sc1
    buffer_load_dwordx4 v[140:143], v16, s[8:11], s59 offen offset:640 sc1
L_next_83:
    s_bitcmp1_b32 s90, 2
    s_cbranch_scc0 L_next_85
    v_max3_u32 v216, v176, v177, v178
    v_max3_u32 v216, v179, v180, v216
    v_max3_u32 v216, v181, v182, v216
    v_max_u32 v216, v183, v216
    v_cmp_eq_u32 vcc, -1, v216
    s_nop 0
    s_cbranch_vccnz L_again_86
    v_mfma_f32_32x32x16_bf16 v[112:127], a[148:151], v[176:179], v[112:127]
    v_mfma_f32_32x32x16_bf16 v[112:127], a[148:151], v[180:183], v[112:127]
    s_bitset0_b32 s90, 2
    s_cmp_eq_u32 s90, 0
    s_cbranch_scc1 L_summed_80_w
    s_branch L_next_85
L_again_86:
    s_add_u32 s57, s50, 6
    s_and_b32 s57, s57, 14
    s_mul_i32 s57, s57, 640
    s_add_u32 s59, s57, s89
    buffer_load_dwordx4 v[176:179], v16, s[8:11], s59 offen offset:0 sc1
    buffer_load_dwordx4 v[180:183], v16, s[8:11], s59 offen offset:640 sc1
L_next_85:
    s_bitcmp1_b32 s90, 3
    s_cbranch_scc0 L_next_87
    v_max3_u32 v216, v184, v185, v186
    v_max3_u32 v216, v187, v188, v216
    v_max3_u32 v216, v189, v190, v216
    v_max_u32 v216, v191, v216
    v_cmp_eq_u32 vcc, -1, v216
    s_nop 0
    s_cbranch_vccnz L_again_88
    v_mfma_f32_32x32x16_bf16 v[112:127], a[148:151], v[184:187], v[112:127]
    v_mfma_f32_32x32x16_bf16 v[112:127], a[148:151], v[188:191], v[112:127]
    s_bitset0_b32 s90, 3
    s_cmp_eq_u32 s90, 0
    s_cbranch_scc1 L_summed_80_w
    s_branch L_next_87
L_again_88:
    s_add_u32 s57, s50, 8
    s_and_b32 s57, s57, 14
    s_mul_i32 s57, s57, 640
    s_add_u32 s59, s57, s89
    buffer_load_dwordx4 v[184:187], v16, s[8:11], s59 offen offset:0 sc1
    buffer_load_dwordx4 v[188:191], v16, s[8:11], s59 offen offset:640 sc1
L_next_87:
    s_bitcmp1_b32 s90, 4
    s_cbranch_scc0 L_next_89
    v_max3_u32 v216, v192, v193, v194
    v_max3_u32 v216, v195, v196, v216
    v_max3_u32 v216, v197, v198, v216
    v_max_u32 v216, v199, v216
    v_cmp_eq_u32 vcc, -1, v216
    s_nop 0
    s_cbranch_vccnz L_again_90
    v_mfma_f32_32x32x16_bf16 v[112:127], a[148:151], v[192:195], v[112:127]
    v_mfma_f32_32x32x16_bf16 v[112:127], a[148:151], v[196:199], v[112:127]
    s_bitset0_b32 s90, 4
    s_cmp_eq_u32 s90, 0
    s_cbranch_scc1 L_summed_80_w
    s_branch L_next_89
L_again_90:
    s_add_u32 s57, s50, 10
    s_and_b32 s57, s57, 14
    s_mul_i32 s57, s57, 640
    s_add_u32 s59, s57, s89
    buffer_load_dwordx4 v[192:195], v16, s[8:11], s59 offen offset:0 sc1
    buffer_load_dwordx4 v[196:199], v16, s[8:11], s59 offen offset:640 sc1
L_next_89:
    s_bitcmp1_b32 s90, 5
    s_cbranch_scc0 L_next_91
    v_max3_u32 v216, v200, v201, v202
    v_max3_u32 v216, v203, v204, v216
    v_max3_u32 v216, v205, v206, v216
    v_max_u32 v216, v207, v216
    v_cmp_eq_u32 vcc, -1, v216
    s_nop 0
    s_cbranch_vccnz L_again_92
    v_mfma_f32_32x32x16_bf16 v[112:127], a[148:151], v[200:203], v[112:127]
    v_mfma_f32_32x32x16_bf16 v[112:127], a[148:151], v[204:207], v[112:127]
    s_bitset0_b32 s90, 5
    s_cmp_eq_u32 s90, 0
    s_cbranch_scc1 L_summed_80_w
    s_branch L_next_91
L_again_92:
    s_add_u32 s57, s50, 12
    s_and_b32 s57, s57, 14
    s_mul_i32 s57, s57, 640
    s_add_u32 s59, s57, s89
    buffer_load_dwordx4 v[200:203], v16, s[8:11], s59 offen offset:0 sc1
    buffer_load_dwordx4 v[204:207], v16, s[8:11], s59 offen offset:640 sc1
L_next_91:
    s_bitcmp1_b32 s90, 6
    s_cbranch_scc0 L_next_93
    v_max3_u32 v216, v48, v49, v50
    v_max3_u32 v216, v51, v52, v216
    v_max3_u32 v216, v53, v54, v216
    v_max_u32 v216, v55, v216
    v_cmp_eq_u32 vcc, -1, v216
    s_nop 0
    s_cbranch_vccnz L_again_94
    v_mfma_f32_32x32x16_bf16 v[112:127], a[148:151], v[48:51], v[112:127]
    v_mfma_f32_32x32x16_bf16 v[112:127], a[148:151], v[52:55], v[112:127]
    s_bitset0_b32 s90, 6
    s_cmp_eq_u32 s90, 0
    s_cbranch_scc1 L_summed_80_w
    s_branch L_next_93
L_again_94:
    s_add_u32 s57, s50, 14
    s_and_b32 s57, s57, 14
    s_mul_i32 s57, s57, 640
    s_add_u32 s59, s57, s89
    buffer_load_dwordx4 v[48:51], v16, s[8:11], s59 offen offset:0 sc1
    buffer_load_dwordx4 v[52:55], v16, s[8:11], s59 offen offset:640 sc1
L_next_93:
    s_bitcmp1_b32 s90, 7
    s_cbranch_scc0 L_next_95
    v_max3_u32 v216, v56, v57, v58
    v_max3_u32 v216, v59, v60, v216
    v_max3_u32 v216, v61, v62, v216
    v_max_u32 v216, v63, v216
    v_cmp_eq_u32 vcc, -1, v216
    s_nop 0
    s_cbranch_vccnz L_again_96
    v_mfma_f32_32x32x16_bf16 v[112:127], a[148:151], v[56:59], v[112:127]
    v_mfma_f32_32x32x16_bf16 v[112:127], a[148:151], v[60:63], v[112:127]
    s_bitset0_b32 s90, 7
    s_cmp_eq_u32 s90, 0
    s_cbranch_scc1 L_summed_80_w
    s_branch L_next_95
L_again_96:
    s_add_u32 s57, s50, 16
    s_and_b32 s57, s57, 14
    s_mul_i32 s57, s57, 640
    s_add_u32 s59, s57, s89
    buffer_load_dwordx4 v[56:59], v16, s[8:11], s59 offen offset:0 sc1
    buffer_load_dwordx4 v[60:63], v16, s[8:11], s59 offen offset:640 sc1
L_next_95:
    s_branch L_late_79
L_summed_80_w:
    s_nop 8
    v_cvt_pk_bf16_f32 v80, v112, v113
    v_cvt_pk_bf16_f32 v81, v114, v115
    v_cvt_pk_bf16_f32 v82, v116, v117
    v_cvt_pk_bf16_f32 v83, v118, v119
    s_branch L_summed_80
L_dev_97:
    buffer_store_dwordx4 v[96:99], v1, s[4:7], s68 offen sc1
    buffer_store_dwordx4 v[100:103], v1, s[4:7], s68 offen offset:1024 sc1
    s_branch L_st_98
L_dev_99:
    s_waitcnt vmcnt(0)
    buffer_atomic_swap v28, off, s[8:11], s82 sc1
    s_branch L_sg_100
L_dev_104:
    buffer_store_dwordx4 v[64:67], v1, s[4:7], s68 offen sc1
    buffer_store_dwordx4 v[68:71], v1, s[4:7], s68 offen offset:1024 sc1
    s_branch L_st_105
L_dev_106:
    buffer_store_dword v176, v39, s[4:7], s73 offen sc1
    s_branch L_st_107
L_dev_108:
    s_waitcnt vmcnt(0)
    buffer_atomic_swap v28, off, s[8:11], s84 sc1
    s_branch L_sg_109
L_dev_112:
    buffer_store_dwordx4 v[72:75], v1, s[4:7], s68 offen offset:0 sc1
    s_branch L_st_113
L_dev_114:
    buffer_store_dwordx4 v[72:75], v1, s[4:7], s68 offen offset:1024 sc1
    s_branch L_st_115
L_dev_116:
    s_waitcnt vmcnt(0)
    buffer_atomic_swap v28, off, s[8:11], s82 sc1
    s_branch L_sg_117
L_dev_118:
    s_waitcnt vmcnt(0)
    buffer_atomic_swap v28, off, s[8:11], s82 sc1
    s_branch L_sg_119
L_spin_120:
    buffer_load_dword v26, v5, s[8:11], s81 offen sc1
    s_waitcnt vmcnt(0)
    s_sub_u32 s54, s54, 1
    s_cbranch_scc0 L_chk_121
    s_endpgm
L_dev_122:
    s_waitcnt vmcnt(0)
    buffer_atomic_swap v28, off, s[8:11], s82 sc1
    s_branch L_sg_123
L_spin_124:
    buffer_load_dword v27, v5, s[8:11], s81 offen sc1
    s_waitcnt vmcnt(0)
    s_sub_u32 s54, s54, 1
    s_cbranch_scc0 L_chk_125
    s_endpgm
L_dev_126:
    s_waitcnt vmcnt(0)
    buffer_atomic_swap v28, off, s[8:11], s82 sc1
    s_branch L_sg_127
L_spin_128:
    buffer_load_dword v26, v5, s[8:11], s81 offen sc1
    s_waitcnt vmcnt(0)
    s_sub_u32 s54, s54, 1
    s_cbranch_scc0 L_chk_129
    s_endpgm
L_spin_130:
    buffer_load_dword v27, v5, s[8:11], s81 offen sc1
    s_waitcnt vmcnt(0)
    s_sub_u32 s54, s54, 1
    s_cbranch_scc0 L_chk_131
    s_endpgm
L_dev_132:
    buffer_store_dwordx4 v[72:75], v1, s[4:7], s59 offen offset:0 sc1
    buffer_store_dwordx4 v[76:79], v1, s[4:7], s59 offen offset:1024 sc1
    s_branch L_st_133
L_code_end:
.section .rodata,"a"
.p2align 6
.amdhsa_kernel interleave_layers__linear_kernel_hedgehog__glu_gated_geglu__prompt_kernel
  .amdhsa_next_free_vgpr 512
  .amdhsa_next_free_sgpr 102
  .amdhsa_accum_offset 256
  .amdhsa_group_segment_fixed_size 0
  .amdhsa_kernarg_size 88
  .amdhsa_user_sgpr_count 2
  .amdhsa_user_sgpr_kernarg_segment_ptr 1
  .amdhsa_system_sgpr_workgroup_id_x 1
.end_amdhsa_kernel
```
